```python
import torch

def _softmax(x, axis=-1):
    return torch.softmax(x, dim=axis)

def _gelu(x):
    return torch.nn.functional.gelu(x, approximate='tanh')

def _silu(x):
    return torch.nn.functional.silu(x)

def _sigmoid(x):
    return torch.sigmoid(x)

def _layernorm(x, axis=-1, eps=1e-05):
    m = x.mean(dim=axis, keepdim=True)
    v = x.var(dim=axis, keepdim=True, unbiased=False)
    return (x - m) / torch.sqrt(v + eps)

def _scatter_add(tgt, idx, src, axis=0):
    return tgt.clone().index_add_(axis, idx, src)

def _segment_sum(src, seg, n):
    out = torch.zeros((n,) + src.shape[1:], dtype=src.dtype)
    return out.index_add_(0, seg, src)

def _pad(x, pw):
    flat = tuple((v for pair in reversed(pw) for v in pair))
    return torch.nn.functional.pad(x, flat)
kernel_name = 'sequential_preLN__memory_aug_recurrent_mem_tr__glu_gated_bilinear__prompt'

def setup_inputs():

    _w = lambda a: (lambda t: t.to(torch.bfloat16) if t.is_floating_point() else t)(torch.as_tensor(a))

    def _A_setup():
        B, S, Dm = (1, 2048, 640)
        H, Dh = (32, 192)
        M, seg = (8, 32)
        seg = min(seg, S)
        S = S // seg * seg
        return {'x': _w((lambda *s: torch.randn(*s, dtype=torch.bfloat16) * 0.05)(B, S, Dm)), 'mem0': _w((lambda *s: torch.randn(*s, dtype=torch.bfloat16) * 0.2)(B, M, Dm)), 'Wq': _w((lambda *s: torch.randn(*s, dtype=torch.bfloat16) * 1.6)(Dm, H, Dh) * Dm ** (-0.5)), 'Wk': _w((lambda *s: torch.randn(*s, dtype=torch.bfloat16) * 1.6)(Dm, H, Dh) * Dm ** (-0.5)), 'Wv': _w((lambda *s: torch.randn(*s, dtype=torch.bfloat16) * 0.2)(Dm, H, Dh) * Dm ** (-0.5)), 'Wo': _w((lambda *s: torch.randn(*s, dtype=torch.bfloat16) * 0.2)(H, Dh, Dm) * (H * Dh) ** (-0.5)), 'seg_len': seg}
    _A_in = _A_setup()

    def _B_setup():
        B, S, D, F = (1, 2048, 640, 1536)
        return {'x': _w((lambda *s: torch.randn(*s, dtype=torch.bfloat16) * 0.05)(B, S, D)), 'w_gate': _w((lambda *s: torch.randn(*s, dtype=torch.bfloat16) * 0.2)(D, F) * D ** (-0.5)), 'w_up': _w((lambda *s: torch.randn(*s, dtype=torch.bfloat16) * 0.2)(D, F) * D ** (-0.5)), 'w_down': _w((lambda *s: torch.randn(*s, dtype=torch.bfloat16) * 0.2)(F, D) * F ** (-0.5))}
    _B_in = _B_setup()
    return {'A_x': _A_in['x'], 'A_mem0': _A_in['mem0'], 'A_Wq': _A_in['Wq'], 'A_Wk': _A_in['Wk'], 'A_Wv': _A_in['Wv'], 'A_Wo': _A_in['Wo'], 'A_seg_len': _A_in['seg_len'], 'B_x': _B_in['x'], 'B_w_gate': _B_in['w_gate'], 'B_w_up': _B_in['w_up'], 'B_w_down': _B_in['w_down']}

def reference(A_x, A_mem0, A_Wq, A_Wk, A_Wv, A_Wo, A_seg_len, B_x, B_w_gate, B_w_up, B_w_down):

    def _A_ref(x, mem0, Wq, Wk, Wv, Wo, seg_len):
        B, S, Dm = x.shape
        H, Dh = (Wq.shape[1], Wq.shape[2])
        M = mem0.shape[1]
        scale = Dh ** (-0.5)
        n_seg = S // seg_len
        L = M + seg_len
        idx = torch.arange(L)
        mask = (idx[:, None] < M) | (idx[:, None] >= idx[None, :])
        mem = mem0
        outs = []
        for s in range(n_seg):
            xs = x[:, s * seg_len:(s + 1) * seg_len, :].clone()
            h = torch.concatenate([mem, xs], axis=1)
            q = torch.einsum('btd,dhe->bhte', h, Wq)
            k = torch.einsum('btd,dhe->bhte', h, Wk)
            v = torch.einsum('btd,dhe->bhte', h, Wv)
            scores = torch.einsum('bhqe,bhke->bhqk', q, k) * scale
            scores = torch.where(mask[None, None], scores, -1000000000.0)
            p = _softmax(scores, axis=-1)
            o = torch.einsum('bhqk,bhke->bhqe', p, v)
            o = torch.einsum('bhte,hed->btd', o, Wo)
            mem = o[:, :M, :].clone()
            outs.append(o[:, M:, :])
        return torch.concatenate(outs, axis=1)

    def _B_ref(x, w_gate, w_up, w_down):
        g = torch.einsum('bsd,df->bsf', x, w_gate)
        u = torch.einsum('bsd,df->bsf', x, w_up)
        h = g * u
        return torch.einsum('bsf,fd->bsd', h, w_down)
    x = A_x
    h = x + _A_ref(_layernorm(x, axis=-1), A_mem0, A_Wq, A_Wk, A_Wv, A_Wo, A_seg_len)
    h2 = h + _B_ref(_layernorm(h, axis=-1), B_w_gate, B_w_up, B_w_down)
    return h2
```

```asm
; @launch kernel=ln1_kernel grid=(512,1,1) block=(256,1,1) lds=0
; @launch kernel=chain_kernel grid=(256,1,1) block=(512,1,1) lds=163840
; @launch kernel=xo_kernel grid=(256,1,1) block=(512,1,1) lds=163840
.amdgcn_target "amdgcn-amd-amdhsa--gfx950"
.text
.globl ln1_kernel
.p2align 8
.type ln1_kernel,@function
ln1_kernel:
    s_cmp_ge_u32 s2, 512
    s_cbranch_scc1 L_done_1
    s_load_dwordx2 s[4:5], s[0:1], 0
    s_load_dwordx2 s[6:7], s[0:1], 104
    v_lshrrev_b32 v1, 6, v0
    v_and_b32 v2, 63, v0
    s_lshl_b32 s3, s2, 2
    v_add_u32 v1, s3, v1
    v_mul_u32_u24 v3, 1280, v1
    v_lshl_add_u32 v3, v2, 2, v3
    s_waitcnt lgkmcnt(0)
    s_mov_b32 s8, s4
    s_and_b32 s9, s5, 0xffff
    s_mov_b32 s10, 2621440
    s_mov_b32 s11, 0x20000
    s_mov_b32 s12, s6
    s_and_b32 s13, s7, 0xffff
    s_mov_b32 s14, 268435456
    s_mov_b32 s15, 0x20000
    s_mov_b32 s16, 0
    s_mov_b32 s17, 0
    buffer_load_dword v4, v3, s[8:11], s16 offen offset:0
    buffer_load_dword v5, v3, s[8:11], s16 offen offset:256
    buffer_load_dword v6, v3, s[8:11], s16 offen offset:512
    buffer_load_dword v7, v3, s[8:11], s16 offen offset:768
    buffer_load_dword v8, v3, s[8:11], s16 offen offset:1024
    s_mul_i32 s18, s2, 16384
    s_add_u32 s18, s18, 134217728
    v_lshlrev_b32 v40, 4, v0
    v_mov_b32 v44, 0
    v_mov_b32 v45, 0
    v_mov_b32 v46, 0
    v_mov_b32 v47, 0
    buffer_store_dwordx4 v[44:47], v40, s[12:15], s18 offen
    s_add_u32 s18, s18, 4096
    buffer_store_dwordx4 v[44:47], v40, s[12:15], s18 offen
    s_add_u32 s18, s18, 4096
    buffer_store_dwordx4 v[44:47], v40, s[12:15], s18 offen
    s_add_u32 s18, s18, 4096
    buffer_store_dwordx4 v[44:47], v40, s[12:15], s18 offen
    s_waitcnt vmcnt(4)
    v_lshlrev_b32 v10, 16, v4
    v_and_b32 v11, 0xffff0000, v4
    v_lshlrev_b32 v12, 16, v5
    v_and_b32 v13, 0xffff0000, v5
    v_lshlrev_b32 v14, 16, v6
    v_and_b32 v15, 0xffff0000, v6
    v_lshlrev_b32 v16, 16, v7
    v_and_b32 v17, 0xffff0000, v7
    v_lshlrev_b32 v18, 16, v8
    v_and_b32 v19, 0xffff0000, v8
    v_add_f32 v20, v10, v11
    v_add_f32 v20, v20, v12
    v_add_f32 v20, v20, v13
    v_add_f32 v20, v20, v14
    v_add_f32 v20, v20, v15
    v_add_f32 v20, v20, v16
    v_add_f32 v20, v20, v17
    v_add_f32 v20, v20, v18
    v_add_f32 v20, v20, v19
    s_nop 1
    v_add_f32_dpp v20, v20, v20 row_shr:1 row_mask:0xf bank_mask:0xf bound_ctrl:0
    s_nop 1
    v_add_f32_dpp v20, v20, v20 row_shr:2 row_mask:0xf bank_mask:0xf bound_ctrl:0
    s_nop 1
    v_add_f32_dpp v20, v20, v20 row_shr:4 row_mask:0xf bank_mask:0xf bound_ctrl:0
    s_nop 1
    v_add_f32_dpp v20, v20, v20 row_shr:8 row_mask:0xf bank_mask:0xf bound_ctrl:0
    s_nop 1
    v_add_f32_dpp v20, v20, v20 row_bcast:15 row_mask:0xa bank_mask:0xf
    s_nop 1
    v_add_f32_dpp v20, v20, v20 row_bcast:31 row_mask:0xc bank_mask:0xf
    s_nop 1
    v_readlane_b32 s20, v20, 63
    s_nop 3
    v_mov_b32 v21, 0x3acccccd
    v_mov_b32 v22, 0x44200000
    v_rcp_f32 v23, v22
    s_nop 0
    v_mul_f32 v24, s20, v23
    v_fma_f32 v25, -v24, v22, s20
    v_fma_f32 v24, v25, v23, v24
    v_sub_f32 v26, v10, v24
    v_mul_f32 v20, v26, v26
    v_sub_f32 v26, v11, v24
    v_fma_f32 v20, v26, v26, v20
    v_sub_f32 v26, v12, v24
    v_fma_f32 v20, v26, v26, v20
    v_sub_f32 v26, v13, v24
    v_fma_f32 v20, v26, v26, v20
    v_sub_f32 v26, v14, v24
    v_fma_f32 v20, v26, v26, v20
    v_sub_f32 v26, v15, v24
    v_fma_f32 v20, v26, v26, v20
    v_sub_f32 v26, v16, v24
    v_fma_f32 v20, v26, v26, v20
    v_sub_f32 v26, v17, v24
    v_fma_f32 v20, v26, v26, v20
    v_sub_f32 v26, v18, v24
    v_fma_f32 v20, v26, v26, v20
    v_sub_f32 v26, v19, v24
    v_fma_f32 v20, v26, v26, v20
    s_nop 1
    v_add_f32_dpp v20, v20, v20 row_shr:1 row_mask:0xf bank_mask:0xf bound_ctrl:0
    s_nop 1
    v_add_f32_dpp v20, v20, v20 row_shr:2 row_mask:0xf bank_mask:0xf bound_ctrl:0
    s_nop 1
    v_add_f32_dpp v20, v20, v20 row_shr:4 row_mask:0xf bank_mask:0xf bound_ctrl:0
    s_nop 1
    v_add_f32_dpp v20, v20, v20 row_shr:8 row_mask:0xf bank_mask:0xf bound_ctrl:0
    s_nop 1
    v_add_f32_dpp v20, v20, v20 row_bcast:15 row_mask:0xa bank_mask:0xf
    s_nop 1
    v_add_f32_dpp v20, v20, v20 row_bcast:31 row_mask:0xc bank_mask:0xf
    s_nop 1
    v_readlane_b32 s21, v20, 63
    s_nop 3
    v_mul_f32 v27, s21, v23
    v_fma_f32 v25, -v27, v22, s21
    v_fma_f32 v27, v25, v23, v27
    v_cvt_pk_bf16_f32 v28, v24, v27
    s_nop 0
    v_lshlrev_b32 v24, 16, v28
    v_and_b32 v27, 0xffff0000, v28
    v_add_f32 v27, 0x3727c5ac, v27
    v_cvt_pk_bf16_f32 v28, v27, v27
    s_nop 0
    v_lshlrev_b32 v27, 16, v28
    v_sqrt_f32 v27, v27
    s_nop 0
    v_cvt_pk_bf16_f32 v28, v27, v27
    s_nop 0
    v_lshlrev_b32 v27, 16, v28
    v_rcp_f32 v29, v27
    s_nop 0
    v_sub_f32 v30, v10, v24
    v_sub_f32 v31, v11, v24
    v_cvt_pk_bf16_f32 v32, v30, v31
    s_nop 0
    v_lshlrev_b32 v30, 16, v32
    v_and_b32 v31, 0xffff0000, v32
    v_mul_f32 v33, v30, v29
    v_mul_f32 v34, v31, v29
    v_fma_f32 v35, -v33, v27, v30
    v_fma_f32 v36, -v34, v27, v31
    v_fma_f32 v33, v35, v29, v33
    v_fma_f32 v34, v36, v29, v34
    v_cvt_pk_bf16_f32 v4, v33, v34
    v_sub_f32 v30, v12, v24
    v_sub_f32 v31, v13, v24
    v_cvt_pk_bf16_f32 v32, v30, v31
    s_nop 0
    v_lshlrev_b32 v30, 16, v32
    v_and_b32 v31, 0xffff0000, v32
    v_mul_f32 v33, v30, v29
    v_mul_f32 v34, v31, v29
    v_fma_f32 v35, -v33, v27, v30
    v_fma_f32 v36, -v34, v27, v31
    v_fma_f32 v33, v35, v29, v33
    v_fma_f32 v34, v36, v29, v34
    v_cvt_pk_bf16_f32 v5, v33, v34
    v_sub_f32 v30, v14, v24
    v_sub_f32 v31, v15, v24
    v_cvt_pk_bf16_f32 v32, v30, v31
    s_nop 0
    v_lshlrev_b32 v30, 16, v32
    v_and_b32 v31, 0xffff0000, v32
    v_mul_f32 v33, v30, v29
    v_mul_f32 v34, v31, v29
    v_fma_f32 v35, -v33, v27, v30
    v_fma_f32 v36, -v34, v27, v31
    v_fma_f32 v33, v35, v29, v33
    v_fma_f32 v34, v36, v29, v34
    v_cvt_pk_bf16_f32 v6, v33, v34
    v_sub_f32 v30, v16, v24
    v_sub_f32 v31, v17, v24
    v_cvt_pk_bf16_f32 v32, v30, v31
    s_nop 0
    v_lshlrev_b32 v30, 16, v32
    v_and_b32 v31, 0xffff0000, v32
    v_mul_f32 v33, v30, v29
    v_mul_f32 v34, v31, v29
    v_fma_f32 v35, -v33, v27, v30
    v_fma_f32 v36, -v34, v27, v31
    v_fma_f32 v33, v35, v29, v33
    v_fma_f32 v34, v36, v29, v34
    v_cvt_pk_bf16_f32 v7, v33, v34
    v_sub_f32 v30, v18, v24
    v_sub_f32 v31, v19, v24
    v_cvt_pk_bf16_f32 v32, v30, v31
    s_nop 0
    v_lshlrev_b32 v30, 16, v32
    v_and_b32 v31, 0xffff0000, v32
    v_mul_f32 v33, v30, v29
    v_mul_f32 v34, v31, v29
    v_fma_f32 v35, -v33, v27, v30
    v_fma_f32 v36, -v34, v27, v31
    v_fma_f32 v33, v35, v29, v33
    v_fma_f32 v34, v36, v29, v34
    v_cvt_pk_bf16_f32 v8, v33, v34
    s_nop 1
    buffer_store_dword v4, v3, s[12:15], s17 offen offset:0
    buffer_store_dword v5, v3, s[12:15], s17 offen offset:256
    buffer_store_dword v6, v3, s[12:15], s17 offen offset:512
    buffer_store_dword v7, v3, s[12:15], s17 offen offset:768
    buffer_store_dword v8, v3, s[12:15], s17 offen offset:1024
L_done_1:
    s_endpgm
.section .rodata,"a"
.p2align 6
.amdhsa_kernel ln1_kernel
  .amdhsa_next_free_vgpr 52
  .amdhsa_next_free_sgpr 40
  .amdhsa_accum_offset 52
  .amdhsa_group_segment_fixed_size 0
  .amdhsa_kernarg_size 112
  .amdhsa_user_sgpr_count 2
  .amdhsa_user_sgpr_kernarg_segment_ptr 1
  .amdhsa_system_sgpr_workgroup_id_x 1
.end_amdhsa_kernel
.text
.globl chain_kernel
.p2align 8
.type chain_kernel,@function
chain_kernel:
    s_cmp_ge_u32 s2, 256
    s_cbranch_scc1 L_bail_3
    s_load_dwordx2 s[6:7], s[0:1], 104
    s_load_dwordx4 s[36:39], s[0:1], 16
    s_load_dwordx4 s[40:43], s[0:1], 32
    s_load_dwordx2 s[44:45], s[0:1], 8
    s_load_dwordx2 s[4:5], s[0:1], 96
    v_and_b32 v1, 63, v0
    v_lshrrev_b32 v2, 6, v0
    s_nop 0
    v_readfirstlane_b32 s46, v2
    s_mov_b32 s50, 1033096506
    s_mov_b32 s51, 1069066811
    v_and_b32 v8, 15, v1
    v_lshrrev_b32 v9, 4, v1
    v_and_b32 v10, 7, v8
    s_waitcnt lgkmcnt(0)
    s_mov_b32 s8, s6
    s_and_b32 s9, s7, 0xffff
    s_mov_b32 s10, 268435456
    s_mov_b32 s11, 0x20000
    s_mov_b32 s12, s36
    s_and_b32 s13, s37, 0xffff
    s_mov_b32 s14, 7864320
    s_mov_b32 s15, 0x20000
    s_mov_b32 s16, s38
    s_and_b32 s17, s39, 0xffff
    s_mov_b32 s18, 7864320
    s_mov_b32 s19, 0x20000
    s_mov_b32 s20, s40
    s_and_b32 s21, s41, 0xffff
    s_mov_b32 s22, 7864320
    s_mov_b32 s23, 0x20000
    s_mov_b32 s24, s42
    s_and_b32 s25, s43, 0xffff
    s_mov_b32 s26, 7864320
    s_mov_b32 s27, 0x20000
    s_mov_b32 s28, s44
    s_and_b32 s29, s45, 0xffff
    s_mov_b32 s30, 10240
    s_mov_b32 s31, 0x20000
    s_mov_b32 s32, s4
    s_and_b32 s33, s5, 0xffff
    s_mov_b32 s34, 256
    s_mov_b32 s35, 0x20000
    s_cmp_lg_u32 s46, 0
    s_cbranch_scc1 L_role_done_4
    s_getreg_b32 s56, hwreg(HW_REG_XCC_ID)
    s_and_b32 s56, s56, 7
    s_lshl_b32 s57, s56, 2
    s_mov_b64 exec, 1
    v_mov_b32 v3, 1
    v_mov_b32 v4, s57
    v_mov_b32 v5, 1
    v_mov_b32 v6, 64
    buffer_atomic_add v3, v4, s[32:35], 0 offen sc0
    s_waitcnt vmcnt(0)
    buffer_atomic_add v5, v6, s[32:35], 0 offen
    s_mov_b64 exec, -1
    v_readfirstlane_b32 s58, v3
    s_cmp_lt_u32 s58, 32
    s_cbranch_scc1 L_have_5
    v_min_u32 v4, 8, v1
    v_lshlrev_b32 v4, 2, v4
    v_cmp_le_u32 vcc, 8, v1
    v_mov_b32 v5, 64
    v_cndmask_b32 v4, v4, v5, vcc
    v_mov_b32 v6, 32
    v_mov_b32 v7, 256
    v_cndmask_b32 v6, v6, v7, vcc
    s_mov_b32 s60, 0
L_rpoll_6:
    buffer_load_dword v3, v4, s[32:35], 0 offen sc1
    s_waitcnt vmcnt(0)
    v_readlane_b32 s61, v3, 8
    s_cmp_eq_u32 s61, 256
    s_cbranch_scc1 L_rok_7
    s_sleep 2
    s_add_u32 s60, s60, 1
    s_cmp_lt_u32 s60, 262144
    s_cbranch_scc1 L_rpoll_6
L_rok_7:
    buffer_load_dword v3, v4, s[32:35], 0 offen sc1
    s_waitcnt vmcnt(0)
    v_cmp_ne_u32 vcc, v3, v6
    s_mov_b64 exec, 1
    v_mov_b32 v5, 1
    v_mov_b32 v6, 68
    buffer_atomic_add v5, v6, s[32:35], 0 offen sc0
    s_waitcnt vmcnt(0)
    s_mov_b64 exec, -1
    v_readfirstlane_b32 s60, v5
    s_mov_b32 s56, 0
L_xl_8:
    s_nop 3
    v_readlane_b32 s58, v3, s56
    s_min_u32 s63, s58, 32
    s_sub_u32 s63, 32, s63
    s_add_u32 s58, s58, s60
    s_cmp_lt_u32 s60, s63
    s_cbranch_scc1 L_have_5
    s_sub_u32 s60, s60, s63
    s_add_u32 s56, s56, 1
    s_cmp_lt_u32 s56, 8
    s_cbranch_scc1 L_xl_8
    s_branch L_done_2
L_have_5:
    s_lshl_b32 s61, s56, 4
    s_add_u32 s61, s61, s58
    s_add_u32 s63, s61, 112
    s_cmp_lt_u32 s58, 16
    s_cselect_b32 s61, s61, s63
    v_mov_b32 v3, s61
    v_mov_b32 v4, 0
    ds_write_b32 v4, v3
L_role_done_4:
    s_waitcnt lgkmcnt(0)
    s_barrier
    v_mov_b32 v4, 0
    ds_read_b32 v3, v4
    s_waitcnt lgkmcnt(0)
    v_readfirstlane_b32 s61, v3
    s_barrier
    s_and_b32 s73, s61, 0xffff
    s_cmp_ge_u32 s73, 128
    s_cbranch_scc1 L_worker_9
    s_lshr_b32 s47, s73, 2
    s_and_b32 s48, s73, 3
    s_lshr_b32 s74, s73, 4
    s_and_b32 s75, s47, 3
    s_and_b32 s76, s46, 3
    s_lshr_b32 s77, s46, 2
    v_cmp_gt_u32 vcc, 8, v8
    s_mov_b64 s[52:53], vcc
    v_cmp_gt_u32 vcc, 32, v1
    s_mov_b64 s[54:55], vcc
    s_lshl_b32 s57, s46, 10
    s_mul_i32 s56, s47, 384
    s_mul_i32 s58, s48, 96
    s_add_u32 s56, s56, s58
    v_mov_b32 v7, 715827883
    v_add_u32 v3, 0, v0
    v_mul_hi_u32 v4, v3, v7
    v_mul_u32_u24 v5, 6, v4
    v_sub_u32 v5, v3, v5
    v_mul_u32_u24 v6, 12288, v4
    v_lshl_add_u32 v44, v5, 4, v6
    s_add_u32 m0, s57, 0
    s_nop 0
    buffer_load_dwordx4 v44, s[12:15], s56 offen lds
    v_add_u32 v3, 512, v0
    v_mul_hi_u32 v4, v3, v7
    v_mul_u32_u24 v5, 6, v4
    v_sub_u32 v5, v3, v5
    v_mul_u32_u24 v6, 12288, v4
    v_lshl_add_u32 v45, v5, 4, v6
    s_add_u32 m0, s57, 8192
    s_nop 0
    buffer_load_dwordx4 v45, s[12:15], s56 offen lds
    v_add_u32 v3, 1024, v0
    v_mul_hi_u32 v4, v3, v7
    v_mul_u32_u24 v5, 6, v4
    v_sub_u32 v5, v3, v5
    v_mul_u32_u24 v6, 12288, v4
    v_lshl_add_u32 v46, v5, 4, v6
    s_add_u32 m0, s57, 16384
    s_nop 0
    buffer_load_dwordx4 v46, s[12:15], s56 offen lds
    v_add_u32 v3, 1536, v0
    v_mul_hi_u32 v4, v3, v7
    v_mul_u32_u24 v5, 6, v4
    v_sub_u32 v5, v3, v5
    v_mul_u32_u24 v6, 12288, v4
    v_lshl_add_u32 v47, v5, 4, v6
    s_add_u32 m0, s57, 24576
    s_nop 0
    buffer_load_dwordx4 v47, s[12:15], s56 offen lds
    v_add_u32 v3, 2048, v0
    v_mul_hi_u32 v4, v3, v7
    v_mul_u32_u24 v5, 6, v4
    v_sub_u32 v5, v3, v5
    v_mul_u32_u24 v6, 12288, v4
    v_lshl_add_u32 v48, v5, 4, v6
    s_add_u32 m0, s57, 32768
    s_nop 0
    buffer_load_dwordx4 v48, s[12:15], s56 offen lds
    v_add_u32 v3, 2560, v0
    v_mul_hi_u32 v4, v3, v7
    v_mul_u32_u24 v5, 6, v4
    v_sub_u32 v5, v3, v5
    v_mul_u32_u24 v6, 12288, v4
    v_lshl_add_u32 v49, v5, 4, v6
    s_add_u32 m0, s57, 40960
    s_nop 0
    buffer_load_dwordx4 v49, s[12:15], s56 offen lds
    v_add_u32 v3, 3072, v0
    v_mul_hi_u32 v4, v3, v7
    v_mul_u32_u24 v5, 6, v4
    v_sub_u32 v5, v3, v5
    v_mul_u32_u24 v6, 12288, v4
    v_lshl_add_u32 v50, v5, 4, v6
    s_add_u32 m0, s57, 49152
    s_nop 0
    buffer_load_dwordx4 v50, s[12:15], s56 offen lds
    s_cmp_ge_u32 s46, 4
    s_cbranch_scc1 L_wd_10
    v_add_u32 v3, 3584, v0
    v_mul_hi_u32 v4, v3, v7
    v_mul_u32_u24 v5, 6, v4
    v_sub_u32 v5, v3, v5
    v_mul_u32_u24 v6, 12288, v4
    v_lshl_add_u32 v51, v5, 4, v6
    s_add_u32 m0, s57, 57344
    s_nop 0
    buffer_load_dwordx4 v51, s[12:15], s56 offen lds
L_wd_10:
    s_lshl_b32 s57, s46, 10
    s_mul_i32 s56, s47, 384
    s_mul_i32 s58, s48, 96
    s_add_u32 s56, s56, s58
    v_mov_b32 v7, 715827883
    v_add_u32 v3, 0, v0
    v_mul_hi_u32 v4, v3, v7
    v_mul_u32_u24 v5, 6, v4
    v_sub_u32 v5, v3, v5
    v_mul_u32_u24 v6, 12288, v4
    v_lshl_add_u32 v44, v5, 4, v6
    s_add_u32 m0, s57, 61440
    s_nop 0
    buffer_load_dwordx4 v44, s[16:19], s56 offen lds
    v_add_u32 v3, 512, v0
    v_mul_hi_u32 v4, v3, v7
    v_mul_u32_u24 v5, 6, v4
    v_sub_u32 v5, v3, v5
    v_mul_u32_u24 v6, 12288, v4
    v_lshl_add_u32 v45, v5, 4, v6
    s_add_u32 m0, s57, 69632
    s_nop 0
    buffer_load_dwordx4 v45, s[16:19], s56 offen lds
    v_add_u32 v3, 1024, v0
    v_mul_hi_u32 v4, v3, v7
    v_mul_u32_u24 v5, 6, v4
    v_sub_u32 v5, v3, v5
    v_mul_u32_u24 v6, 12288, v4
    v_lshl_add_u32 v46, v5, 4, v6
    s_add_u32 m0, s57, 77824
    s_nop 0
    buffer_load_dwordx4 v46, s[16:19], s56 offen lds
    v_add_u32 v3, 1536, v0
    v_mul_hi_u32 v4, v3, v7
    v_mul_u32_u24 v5, 6, v4
    v_sub_u32 v5, v3, v5
    v_mul_u32_u24 v6, 12288, v4
    v_lshl_add_u32 v47, v5, 4, v6
    s_add_u32 m0, s57, 86016
    s_nop 0
    buffer_load_dwordx4 v47, s[16:19], s56 offen lds
    v_add_u32 v3, 2048, v0
    v_mul_hi_u32 v4, v3, v7
    v_mul_u32_u24 v5, 6, v4
    v_sub_u32 v5, v3, v5
    v_mul_u32_u24 v6, 12288, v4
    v_lshl_add_u32 v48, v5, 4, v6
    s_add_u32 m0, s57, 94208
    s_nop 0
    buffer_load_dwordx4 v48, s[16:19], s56 offen lds
    v_add_u32 v3, 2560, v0
    v_mul_hi_u32 v4, v3, v7
    v_mul_u32_u24 v5, 6, v4
    v_sub_u32 v5, v3, v5
    v_mul_u32_u24 v6, 12288, v4
    v_lshl_add_u32 v49, v5, 4, v6
    s_add_u32 m0, s57, 102400
    s_nop 0
    buffer_load_dwordx4 v49, s[16:19], s56 offen lds
    v_add_u32 v3, 3072, v0
    v_mul_hi_u32 v4, v3, v7
    v_mul_u32_u24 v5, 6, v4
    v_sub_u32 v5, v3, v5
    v_mul_u32_u24 v6, 12288, v4
    v_lshl_add_u32 v50, v5, 4, v6
    s_add_u32 m0, s57, 110592
    s_nop 0
    buffer_load_dwordx4 v50, s[16:19], s56 offen lds
    s_cmp_ge_u32 s46, 4
    s_cbranch_scc1 L_wd_11
    v_add_u32 v3, 3584, v0
    v_mul_hi_u32 v4, v3, v7
    v_mul_u32_u24 v5, 6, v4
    v_sub_u32 v5, v3, v5
    v_mul_u32_u24 v6, 12288, v4
    v_lshl_add_u32 v51, v5, 4, v6
    s_add_u32 m0, s57, 118784
    s_nop 0
    buffer_load_dwordx4 v51, s[16:19], s56 offen lds
L_wd_11:
    v_lshrrev_b32 v3, 2, v8
    v_lshl_add_u32 v3, v9, 3, v3
    v_mul_u32_u24 v2, 96, v3
    v_and_b32 v3, 3, v1
    v_lshl_add_u32 v2, v3, 3, v2
    s_mul_i32 s56, s76, 15360
    v_add_u32 v2, s56, v2
    s_mul_i32 s56, s77, 61440
    v_add_u32 v2, s56, v2
    s_waitcnt vmcnt(0)
    s_barrier
    ds_read_b64_tr_b16 v[44:45], v2 offset:0
    ds_read_b64_tr_b16 v[46:47], v2 offset:384
    ds_read_b64_tr_b16 v[48:49], v2 offset:3072
    ds_read_b64_tr_b16 v[50:51], v2 offset:3456
    ds_read_b64_tr_b16 v[52:53], v2 offset:6144
    ds_read_b64_tr_b16 v[54:55], v2 offset:6528
    ds_read_b64_tr_b16 v[56:57], v2 offset:9216
    ds_read_b64_tr_b16 v[58:59], v2 offset:9600
    ds_read_b64_tr_b16 v[60:61], v2 offset:12288
    ds_read_b64_tr_b16 v[62:63], v2 offset:12672
    s_waitcnt lgkmcnt(0)
    v_accvgpr_write_b32 a0, v44
    v_accvgpr_write_b32 a1, v45
    v_accvgpr_write_b32 a2, v46
    v_accvgpr_write_b32 a3, v47
    v_accvgpr_write_b32 a12, v48
    v_accvgpr_write_b32 a13, v49
    v_accvgpr_write_b32 a14, v50
    v_accvgpr_write_b32 a15, v51
    v_accvgpr_write_b32 a24, v52
    v_accvgpr_write_b32 a25, v53
    v_accvgpr_write_b32 a26, v54
    v_accvgpr_write_b32 a27, v55
    v_accvgpr_write_b32 a36, v56
    v_accvgpr_write_b32 a37, v57
    v_accvgpr_write_b32 a38, v58
    v_accvgpr_write_b32 a39, v59
    v_accvgpr_write_b32 a48, v60
    v_accvgpr_write_b32 a49, v61
    v_accvgpr_write_b32 a50, v62
    v_accvgpr_write_b32 a51, v63
    ds_read_b64_tr_b16 v[44:45], v2 offset:32
    ds_read_b64_tr_b16 v[46:47], v2 offset:416
    ds_read_b64_tr_b16 v[48:49], v2 offset:3104
    ds_read_b64_tr_b16 v[50:51], v2 offset:3488
    ds_read_b64_tr_b16 v[52:53], v2 offset:6176
    ds_read_b64_tr_b16 v[54:55], v2 offset:6560
    ds_read_b64_tr_b16 v[56:57], v2 offset:9248
    ds_read_b64_tr_b16 v[58:59], v2 offset:9632
    ds_read_b64_tr_b16 v[60:61], v2 offset:12320
    ds_read_b64_tr_b16 v[62:63], v2 offset:12704
    s_waitcnt lgkmcnt(0)
    v_accvgpr_write_b32 a4, v44
    v_accvgpr_write_b32 a5, v45
    v_accvgpr_write_b32 a6, v46
    v_accvgpr_write_b32 a7, v47
    v_accvgpr_write_b32 a16, v48
    v_accvgpr_write_b32 a17, v49
    v_accvgpr_write_b32 a18, v50
    v_accvgpr_write_b32 a19, v51
    v_accvgpr_write_b32 a28, v52
    v_accvgpr_write_b32 a29, v53
    v_accvgpr_write_b32 a30, v54
    v_accvgpr_write_b32 a31, v55
    v_accvgpr_write_b32 a40, v56
    v_accvgpr_write_b32 a41, v57
    v_accvgpr_write_b32 a42, v58
    v_accvgpr_write_b32 a43, v59
    v_accvgpr_write_b32 a52, v60
    v_accvgpr_write_b32 a53, v61
    v_accvgpr_write_b32 a54, v62
    v_accvgpr_write_b32 a55, v63
    ds_read_b64_tr_b16 v[44:45], v2 offset:64
    ds_read_b64_tr_b16 v[46:47], v2 offset:448
    ds_read_b64_tr_b16 v[48:49], v2 offset:3136
    ds_read_b64_tr_b16 v[50:51], v2 offset:3520
    ds_read_b64_tr_b16 v[52:53], v2 offset:6208
    ds_read_b64_tr_b16 v[54:55], v2 offset:6592
    ds_read_b64_tr_b16 v[56:57], v2 offset:9280
    ds_read_b64_tr_b16 v[58:59], v2 offset:9664
    ds_read_b64_tr_b16 v[60:61], v2 offset:12352
    ds_read_b64_tr_b16 v[62:63], v2 offset:12736
    s_waitcnt lgkmcnt(0)
    v_accvgpr_write_b32 a8, v44
    v_accvgpr_write_b32 a9, v45
    v_accvgpr_write_b32 a10, v46
    v_accvgpr_write_b32 a11, v47
    v_accvgpr_write_b32 a20, v48
    v_accvgpr_write_b32 a21, v49
    v_accvgpr_write_b32 a22, v50
    v_accvgpr_write_b32 a23, v51
    v_accvgpr_write_b32 a32, v52
    v_accvgpr_write_b32 a33, v53
    v_accvgpr_write_b32 a34, v54
    v_accvgpr_write_b32 a35, v55
    v_accvgpr_write_b32 a44, v56
    v_accvgpr_write_b32 a45, v57
    v_accvgpr_write_b32 a46, v58
    v_accvgpr_write_b32 a47, v59
    v_accvgpr_write_b32 a56, v60
    v_accvgpr_write_b32 a57, v61
    v_accvgpr_write_b32 a58, v62
    v_accvgpr_write_b32 a59, v63
    s_barrier
    s_lshl_b32 s57, s46, 10
    s_mul_i32 s56, s47, 384
    s_mul_i32 s58, s48, 96
    s_add_u32 s56, s56, s58
    v_mov_b32 v7, 715827883
    v_add_u32 v3, 0, v0
    v_mul_hi_u32 v4, v3, v7
    v_mul_u32_u24 v5, 6, v4
    v_sub_u32 v5, v3, v5
    v_mul_u32_u24 v6, 12288, v4
    v_lshl_add_u32 v44, v5, 4, v6
    s_add_u32 m0, s57, 0
    s_nop 0
    buffer_load_dwordx4 v44, s[20:23], s56 offen lds
    v_add_u32 v3, 512, v0
    v_mul_hi_u32 v4, v3, v7
    v_mul_u32_u24 v5, 6, v4
    v_sub_u32 v5, v3, v5
    v_mul_u32_u24 v6, 12288, v4
    v_lshl_add_u32 v45, v5, 4, v6
    s_add_u32 m0, s57, 8192
    s_nop 0
    buffer_load_dwordx4 v45, s[20:23], s56 offen lds
    v_add_u32 v3, 1024, v0
    v_mul_hi_u32 v4, v3, v7
    v_mul_u32_u24 v5, 6, v4
    v_sub_u32 v5, v3, v5
    v_mul_u32_u24 v6, 12288, v4
    v_lshl_add_u32 v46, v5, 4, v6
    s_add_u32 m0, s57, 16384
    s_nop 0
    buffer_load_dwordx4 v46, s[20:23], s56 offen lds
    v_add_u32 v3, 1536, v0
    v_mul_hi_u32 v4, v3, v7
    v_mul_u32_u24 v5, 6, v4
    v_sub_u32 v5, v3, v5
    v_mul_u32_u24 v6, 12288, v4
    v_lshl_add_u32 v47, v5, 4, v6
    s_add_u32 m0, s57, 24576
    s_nop 0
    buffer_load_dwordx4 v47, s[20:23], s56 offen lds
    v_add_u32 v3, 2048, v0
    v_mul_hi_u32 v4, v3, v7
    v_mul_u32_u24 v5, 6, v4
    v_sub_u32 v5, v3, v5
    v_mul_u32_u24 v6, 12288, v4
    v_lshl_add_u32 v48, v5, 4, v6
    s_add_u32 m0, s57, 32768
    s_nop 0
    buffer_load_dwordx4 v48, s[20:23], s56 offen lds
    v_add_u32 v3, 2560, v0
    v_mul_hi_u32 v4, v3, v7
    v_mul_u32_u24 v5, 6, v4
    v_sub_u32 v5, v3, v5
    v_mul_u32_u24 v6, 12288, v4
    v_lshl_add_u32 v49, v5, 4, v6
    s_add_u32 m0, s57, 40960
    s_nop 0
    buffer_load_dwordx4 v49, s[20:23], s56 offen lds
    v_add_u32 v3, 3072, v0
    v_mul_hi_u32 v4, v3, v7
    v_mul_u32_u24 v5, 6, v4
    v_sub_u32 v5, v3, v5
    v_mul_u32_u24 v6, 12288, v4
    v_lshl_add_u32 v50, v5, 4, v6
    s_add_u32 m0, s57, 49152
    s_nop 0
    buffer_load_dwordx4 v50, s[20:23], s56 offen lds
    s_cmp_ge_u32 s46, 4
    s_cbranch_scc1 L_wd_12
    v_add_u32 v3, 3584, v0
    v_mul_hi_u32 v4, v3, v7
    v_mul_u32_u24 v5, 6, v4
    v_sub_u32 v5, v3, v5
    v_mul_u32_u24 v6, 12288, v4
    v_lshl_add_u32 v51, v5, 4, v6
    s_add_u32 m0, s57, 57344
    s_nop 0
    buffer_load_dwordx4 v51, s[20:23], s56 offen lds
L_wd_12:
    s_lshl_b32 s57, s46, 10
    s_mul_i32 s56, s73, 61440
    v_add_u32 v3, 0, v0
    v_lshlrev_b32 v44, 4, v3
    s_add_u32 m0, s57, 61440
    s_nop 0
    buffer_load_dwordx4 v44, s[24:27], s56 offen lds
    v_add_u32 v3, 512, v0
    v_lshlrev_b32 v45, 4, v3
    s_add_u32 m0, s57, 69632
    s_nop 0
    buffer_load_dwordx4 v45, s[24:27], s56 offen lds
    v_add_u32 v3, 1024, v0
    v_lshlrev_b32 v46, 4, v3
    s_add_u32 m0, s57, 77824
    s_nop 0
    buffer_load_dwordx4 v46, s[24:27], s56 offen lds
    v_add_u32 v3, 1536, v0
    v_lshlrev_b32 v47, 4, v3
    s_add_u32 m0, s57, 86016
    s_nop 0
    buffer_load_dwordx4 v47, s[24:27], s56 offen lds
    v_add_u32 v3, 2048, v0
    v_lshlrev_b32 v48, 4, v3
    s_add_u32 m0, s57, 94208
    s_nop 0
    buffer_load_dwordx4 v48, s[24:27], s56 offen lds
    v_add_u32 v3, 2560, v0
    v_lshlrev_b32 v49, 4, v3
    s_add_u32 m0, s57, 102400
    s_nop 0
    buffer_load_dwordx4 v49, s[24:27], s56 offen lds
    v_add_u32 v3, 3072, v0
    v_lshlrev_b32 v50, 4, v3
    s_add_u32 m0, s57, 110592
    s_nop 0
    buffer_load_dwordx4 v50, s[24:27], s56 offen lds
    s_cmp_ge_u32 s46, 4
    s_cbranch_scc1 L_wd_13
    v_add_u32 v3, 3584, v0
    v_lshlrev_b32 v51, 4, v3
    s_add_u32 m0, s57, 118784
    s_nop 0
    buffer_load_dwordx4 v51, s[24:27], s56 offen lds
L_wd_13:
    v_lshrrev_b32 v3, 2, v8
    v_lshl_add_u32 v3, v9, 3, v3
    v_mul_u32_u24 v2, 96, v3
    v_and_b32 v3, 3, v1
    v_lshl_add_u32 v2, v3, 3, v2
    s_mul_i32 s56, s76, 15360
    v_add_u32 v2, s56, v2
    s_waitcnt vmcnt(0)
    s_barrier
    s_cmp_eq_u32 s77, 0
    s_cbranch_scc1 L_wo_14
    ds_read_b64_tr_b16 v[44:45], v2 offset:0
    ds_read_b64_tr_b16 v[46:47], v2 offset:384
    ds_read_b64_tr_b16 v[48:49], v2 offset:3072
    ds_read_b64_tr_b16 v[50:51], v2 offset:3456
    ds_read_b64_tr_b16 v[52:53], v2 offset:6144
    ds_read_b64_tr_b16 v[54:55], v2 offset:6528
    ds_read_b64_tr_b16 v[56:57], v2 offset:9216
    ds_read_b64_tr_b16 v[58:59], v2 offset:9600
    ds_read_b64_tr_b16 v[60:61], v2 offset:12288
    ds_read_b64_tr_b16 v[62:63], v2 offset:12672
    s_waitcnt lgkmcnt(0)
    v_accvgpr_write_b32 a60, v44
    v_accvgpr_write_b32 a61, v45
    v_accvgpr_write_b32 a62, v46
    v_accvgpr_write_b32 a63, v47
    v_accvgpr_write_b32 a72, v48
    v_accvgpr_write_b32 a73, v49
    v_accvgpr_write_b32 a74, v50
    v_accvgpr_write_b32 a75, v51
    v_accvgpr_write_b32 a84, v52
    v_accvgpr_write_b32 a85, v53
    v_accvgpr_write_b32 a86, v54
    v_accvgpr_write_b32 a87, v55
    v_accvgpr_write_b32 a96, v56
    v_accvgpr_write_b32 a97, v57
    v_accvgpr_write_b32 a98, v58
    v_accvgpr_write_b32 a99, v59
    v_accvgpr_write_b32 a108, v60
    v_accvgpr_write_b32 a109, v61
    v_accvgpr_write_b32 a110, v62
    v_accvgpr_write_b32 a111, v63
    ds_read_b64_tr_b16 v[44:45], v2 offset:32
    ds_read_b64_tr_b16 v[46:47], v2 offset:416
    ds_read_b64_tr_b16 v[48:49], v2 offset:3104
    ds_read_b64_tr_b16 v[50:51], v2 offset:3488
    ds_read_b64_tr_b16 v[52:53], v2 offset:6176
    ds_read_b64_tr_b16 v[54:55], v2 offset:6560
    ds_read_b64_tr_b16 v[56:57], v2 offset:9248
    ds_read_b64_tr_b16 v[58:59], v2 offset:9632
    ds_read_b64_tr_b16 v[60:61], v2 offset:12320
    ds_read_b64_tr_b16 v[62:63], v2 offset:12704
    s_waitcnt lgkmcnt(0)
    v_accvgpr_write_b32 a64, v44
    v_accvgpr_write_b32 a65, v45
    v_accvgpr_write_b32 a66, v46
    v_accvgpr_write_b32 a67, v47
    v_accvgpr_write_b32 a76, v48
    v_accvgpr_write_b32 a77, v49
    v_accvgpr_write_b32 a78, v50
    v_accvgpr_write_b32 a79, v51
    v_accvgpr_write_b32 a88, v52
    v_accvgpr_write_b32 a89, v53
    v_accvgpr_write_b32 a90, v54
    v_accvgpr_write_b32 a91, v55
    v_accvgpr_write_b32 a100, v56
    v_accvgpr_write_b32 a101, v57
    v_accvgpr_write_b32 a102, v58
    v_accvgpr_write_b32 a103, v59
    v_accvgpr_write_b32 a112, v60
    v_accvgpr_write_b32 a113, v61
    v_accvgpr_write_b32 a114, v62
    v_accvgpr_write_b32 a115, v63
    ds_read_b64_tr_b16 v[44:45], v2 offset:64
    ds_read_b64_tr_b16 v[46:47], v2 offset:448
    ds_read_b64_tr_b16 v[48:49], v2 offset:3136
    ds_read_b64_tr_b16 v[50:51], v2 offset:3520
    ds_read_b64_tr_b16 v[52:53], v2 offset:6208
    ds_read_b64_tr_b16 v[54:55], v2 offset:6592
    ds_read_b64_tr_b16 v[56:57], v2 offset:9280
    ds_read_b64_tr_b16 v[58:59], v2 offset:9664
    ds_read_b64_tr_b16 v[60:61], v2 offset:12352
    ds_read_b64_tr_b16 v[62:63], v2 offset:12736
    s_waitcnt lgkmcnt(0)
    v_accvgpr_write_b32 a68, v44
    v_accvgpr_write_b32 a69, v45
    v_accvgpr_write_b32 a70, v46
    v_accvgpr_write_b32 a71, v47
    v_accvgpr_write_b32 a80, v48
    v_accvgpr_write_b32 a81, v49
    v_accvgpr_write_b32 a82, v50
    v_accvgpr_write_b32 a83, v51
    v_accvgpr_write_b32 a92, v52
    v_accvgpr_write_b32 a93, v53
    v_accvgpr_write_b32 a94, v54
    v_accvgpr_write_b32 a95, v55
    v_accvgpr_write_b32 a104, v56
    v_accvgpr_write_b32 a105, v57
    v_accvgpr_write_b32 a106, v58
    v_accvgpr_write_b32 a107, v59
    v_accvgpr_write_b32 a116, v60
    v_accvgpr_write_b32 a117, v61
    v_accvgpr_write_b32 a118, v62
    v_accvgpr_write_b32 a119, v63
    s_branch L_we_15
L_wo_14:
    v_lshrrev_b32 v3, 2, v8
    v_lshl_add_u32 v3, v9, 2, v3
    v_mul_u32_u24 v2, 1280, v3
    v_and_b32 v3, 3, v1
    v_lshl_add_u32 v2, v3, 3, v2
    s_mul_i32 s56, s46, 320
    s_add_u32 s56, s56, 61440
    v_add_u32 v2, s56, v2
    ds_read_b64_tr_b16 v[44:45], v2 offset:0
    ds_read_b64_tr_b16 v[46:47], v2 offset:20480
    ds_read_b64_tr_b16 v[52:53], v2 offset:40960
    ds_read_b64_tr_b16 v[56:57], v2 offset:32
    ds_read_b64_tr_b16 v[58:59], v2 offset:20512
    ds_read_b64_tr_b16 v[64:65], v2 offset:40992
    ds_read_b64_tr_b16 v[68:69], v2 offset:64
    ds_read_b64_tr_b16 v[70:71], v2 offset:20544
    ds_read_b64_tr_b16 v[76:77], v2 offset:41024
    ds_read_b64_tr_b16 v[80:81], v2 offset:96
    ds_read_b64_tr_b16 v[82:83], v2 offset:20576
    ds_read_b64_tr_b16 v[88:89], v2 offset:41056
    ds_read_b64_tr_b16 v[92:93], v2 offset:128
    ds_read_b64_tr_b16 v[94:95], v2 offset:20608
    ds_read_b64_tr_b16 v[100:101], v2 offset:41088
    ds_read_b64_tr_b16 v[48:49], v2 offset:160
    ds_read_b64_tr_b16 v[50:51], v2 offset:20640
    ds_read_b64_tr_b16 v[54:55], v2 offset:41120
    ds_read_b64_tr_b16 v[60:61], v2 offset:192
    ds_read_b64_tr_b16 v[62:63], v2 offset:20672
    ds_read_b64_tr_b16 v[66:67], v2 offset:41152
    ds_read_b64_tr_b16 v[72:73], v2 offset:224
    ds_read_b64_tr_b16 v[74:75], v2 offset:20704
    ds_read_b64_tr_b16 v[78:79], v2 offset:41184
    ds_read_b64_tr_b16 v[84:85], v2 offset:256
    ds_read_b64_tr_b16 v[86:87], v2 offset:20736
    ds_read_b64_tr_b16 v[90:91], v2 offset:41216
    ds_read_b64_tr_b16 v[96:97], v2 offset:288
    ds_read_b64_tr_b16 v[98:99], v2 offset:20768
    ds_read_b64_tr_b16 v[102:103], v2 offset:41248
    s_waitcnt lgkmcnt(0)
    v_accvgpr_write_b32 a60, v44
    v_accvgpr_write_b32 a61, v45
    v_accvgpr_write_b32 a62, v46
    v_accvgpr_write_b32 a63, v47
    v_accvgpr_write_b32 a64, v48
    v_accvgpr_write_b32 a65, v49
    v_accvgpr_write_b32 a66, v50
    v_accvgpr_write_b32 a67, v51
    v_accvgpr_write_b32 a68, v52
    v_accvgpr_write_b32 a69, v53
    v_accvgpr_write_b32 a70, v54
    v_accvgpr_write_b32 a71, v55
    v_accvgpr_write_b32 a72, v56
    v_accvgpr_write_b32 a73, v57
    v_accvgpr_write_b32 a74, v58
    v_accvgpr_write_b32 a75, v59
    v_accvgpr_write_b32 a76, v60
    v_accvgpr_write_b32 a77, v61
    v_accvgpr_write_b32 a78, v62
    v_accvgpr_write_b32 a79, v63
    v_accvgpr_write_b32 a80, v64
    v_accvgpr_write_b32 a81, v65
    v_accvgpr_write_b32 a82, v66
    v_accvgpr_write_b32 a83, v67
    v_accvgpr_write_b32 a84, v68
    v_accvgpr_write_b32 a85, v69
    v_accvgpr_write_b32 a86, v70
    v_accvgpr_write_b32 a87, v71
    v_accvgpr_write_b32 a88, v72
    v_accvgpr_write_b32 a89, v73
    v_accvgpr_write_b32 a90, v74
    v_accvgpr_write_b32 a91, v75
    v_accvgpr_write_b32 a92, v76
    v_accvgpr_write_b32 a93, v77
    v_accvgpr_write_b32 a94, v78
    v_accvgpr_write_b32 a95, v79
    v_accvgpr_write_b32 a96, v80
    v_accvgpr_write_b32 a97, v81
    v_accvgpr_write_b32 a98, v82
    v_accvgpr_write_b32 a99, v83
    v_accvgpr_write_b32 a100, v84
    v_accvgpr_write_b32 a101, v85
    v_accvgpr_write_b32 a102, v86
    v_accvgpr_write_b32 a103, v87
    v_accvgpr_write_b32 a104, v88
    v_accvgpr_write_b32 a105, v89
    v_accvgpr_write_b32 a106, v90
    v_accvgpr_write_b32 a107, v91
    v_accvgpr_write_b32 a108, v92
    v_accvgpr_write_b32 a109, v93
    v_accvgpr_write_b32 a110, v94
    v_accvgpr_write_b32 a111, v95
    v_accvgpr_write_b32 a112, v96
    v_accvgpr_write_b32 a113, v97
    v_accvgpr_write_b32 a114, v98
    v_accvgpr_write_b32 a115, v99
    v_accvgpr_write_b32 a116, v100
    v_accvgpr_write_b32 a117, v101
    v_accvgpr_write_b32 a118, v102
    v_accvgpr_write_b32 a119, v103
L_we_15:
    s_barrier
    v_min_u32 v4, 8, v1
    v_lshlrev_b32 v4, 2, v4
    v_cmp_le_u32 vcc, 8, v1
    v_mov_b32 v5, 64
    v_cndmask_b32 v4, v4, v5, vcc
    v_mov_b32 v6, 32
    v_mov_b32 v7, 256
    v_cndmask_b32 v6, v6, v7, vcc
    s_mov_b32 s60, 0
L_rpoll_16:
    buffer_load_dword v3, v4, s[32:35], 0 offen sc1
    s_waitcnt vmcnt(0)
    v_readlane_b32 s61, v3, 8
    s_cmp_eq_u32 s61, 256
    s_cbranch_scc1 L_rok_17
    s_sleep 2
    s_add_u32 s60, s60, 1
    s_cmp_lt_u32 s60, 262144
    s_cbranch_scc1 L_rpoll_16
L_rok_17:
    buffer_load_dword v3, v4, s[32:35], 0 offen sc1
    s_waitcnt vmcnt(0)
    v_cmp_ne_u32 vcc, v3, v6
    s_cmp_eq_u64 vcc, 0
    s_cselect_b32 s72, 0, 1
    v_lshl_add_u32 v7, v9, 3, v10
    v_lshlrev_b32 v7, 4, v7
    s_mul_i32 s56, s74, 20480
    s_mul_i32 s57, s76, 5120
    s_add_u32 s56, s56, s57
    v_lshlrev_b32 v11, 4, v1
    v_add_u32 v11, s56, v11
    s_mul_i32 s56, s76, 3840
    s_mul_i32 s57, s77, 640
    s_add_u32 s56, s56, s57
    s_add_u32 s56, s56, 0
    v_add_u32 v12, s56, v7
    v_lshrrev_b32 v3, 3, v8
    v_mul_u32_u24 v3, 640, v3
    v_add3_u32 v13, v3, v7, 0
    s_mul_i32 s56, s76, 1536
    s_add_u32 s56, s56, 15360
    v_lshlrev_b32 v14, 4, v1
    v_add_u32 v14, s56, v14
    v_lshrrev_b32 v3, 1, v9
    v_lshl_add_u32 v4, v3, 4, v8
    v_lshlrev_b32 v4, 4, v4
    v_and_b32 v5, 1, v9
    v_lshl_add_u32 v4, v5, 3, v4
    v_add_u32 v15, 15360, v4
    v_lshl_add_u32 v4, v3, 3, v10
    v_lshlrev_b32 v42, 4, v4
    v_lshrrev_b32 v6, 3, v8
    v_lshl_add_u32 v5, v5, 1, v6
    v_lshl_add_u32 v42, v5, 2, v42
    s_mul_i32 s56, s47, 6144
    s_add_u32 s56, s56, 1280
    v_add_u32 v42, s56, v42
    s_mul_i32 s56, s73, 1536
    s_lshl_b32 s57, s46, 9
    s_add_u32 s56, s56, s57
    v_add_u32 v16, s56, v7
    s_mul_i32 s56, s47, 6144
    v_lshrrev_b32 v6, 3, v8
    v_lshl_add_u32 v17, v6, 9, v7
    v_add_u32 v17, s56, v17
    v_lshrrev_b32 v3, 2, v8
    v_lshl_add_u32 v3, v9, 2, v3
    v_mul_u32_u24 v18, 112, v3
    v_and_b32 v4, 3, v1
    v_lshl_add_u32 v18, v4, 3, v18
    v_add_u32 v18, 21504, v18
    v_lshrrev_b32 v3, 1, v10
    v_mul_u32_u24 v19, 5120, v3
    v_and_b32 v3, 1, v8
    v_lshl_add_u32 v19, v3, 6, v19
    v_lshl_add_u32 v19, v9, 4, v19
    v_lshrrev_b32 v3, 3, v8
    v_mul_u32_u24 v3, 640, v3
    v_add_u32 v19, v19, v3
    s_mul_i32 s56, s73, 20480
    s_mul_i32 s57, s46, 1280
    s_add_u32 s56, s56, s57
    v_add_u32 v19, s56, v19
    s_mul_i32 s78, s73, 96
    s_lshl_b32 s56, s46, 4
    v_add_u32 v3, s56, v8
    v_mul_u32_u24 v20, 12288, v3
    v_lshl_add_u32 v20, v9, 3, v20
    s_add_u32 s56, s78, 29360128
    v_add_u32 v20, s56, v20
    v_lshrrev_b32 v3, 1, v1
    v_and_b32 v4, 1, v1
    v_mul_u32_u24 v4, 48, v4
    v_mul_u32_u24 v21, 12288, v3
    s_add_u32 s56, s78, 54525952
    v_add3_u32 v21, v21, v4, s56
    v_mul_u32_u24 v22, 112, v3
    v_add_u32 v22, v22, v4
    v_add_u32 v22, 21504, v22
    s_sub_u32 s56, s46, 3
    s_lshl_b32 s56, s56, 4
    v_add_u32 v3, s56, v8
    v_lshlrev_b32 v25, 4, v3
    s_lshl_b32 s57, s75, 2
    s_add_u32 s57, s57, s48
    s_mul_i32 s57, s57, 1280
    s_mul_i32 s56, s74, 327680
    s_add_u32 s56, s56, s57
    v_mul_u32_u24 v23, 81920, v9
    v_add3_u32 v23, v23, v25, s56
    v_lshl_add_u32 v25, v9, 2, v25
    v_subrev_u32 v3, 384, v0
    v_cmp_gt_u32 vcc, 80, v3
    s_mov_b64 s[82:83], vcc
    v_lshlrev_b32 v41, 4, v3
    v_add_u32 v24, s57, v41
    v_lshrrev_b32 v4, 2, v3
    v_and_b32 v4, 1, v4
    v_lshrrev_b32 v5, 3, v3
    v_and_b32 v3, 3, v3
    v_lshl_add_u32 v3, v5, 2, v3
    v_lshrrev_b32 v5, 3, v3
    v_lshlrev_b32 v26, 10, v5
    v_and_b32 v5, 6, v3
    v_lshl_add_u32 v4, v5, 3, v4
    v_and_b32 v5, 1, v3
    v_lshl_add_u32 v4, v5, 3, v4
    s_lshl_b32 s57, s75, 1
    v_add_u32 v4, s57, v4
    v_lshl_add_u32 v26, v4, 4, v26
    s_mul_i32 s56, s74, 20480
    s_mul_i32 s57, s48, 5120
    s_add_u32 s56, s56, s57
    v_add_u32 v26, s56, v26
    v_mul_u32_u24 v27, 12288, v10
    v_lshl_add_u32 v27, v9, 3, v27
    v_add_u32 v27, s78, v27
    v_mul_u32_u24 v28, 24576, v9
    v_lshl_add_u32 v28, v8, 1, v28
    v_add_u32 v28, s78, v28
    v_mul_u32_u24 v29, 1280, v10
    s_mul_i32 s56, s76, 320
    v_lshl_add_u32 v29, v9, 4, v29
    v_add_u32 v29, s56, v29
    s_mov_b32 s66, 0
    s_cmp_lg_u32 s46, 0
    s_cbranch_scc1 L_kv0_18
    s_mov_b32 s58, 135790592
    v_mov_b32 v3, 0
    s_mov_b32 s59, 0
L_kv0p_19:
    s_mov_b64 exec, 1
    buffer_load_dword v4, v3, s[8:11], s58 offen sc1
    s_mov_b64 exec, -1
    s_waitcnt vmcnt(0)
    v_readfirstlane_b32 s64, v4
    s_cmp_ge_u32 s64, 96
    s_cbranch_scc1 L_kv0_18
    s_sleep 16
    s_add_u32 s59, s59, 1
    s_cmp_lt_u32 s59, 262144
    s_cbranch_scc1 L_kv0p_19
L_kv0_18:
    s_barrier
    s_cmp_ge_u32 s46, 2
    s_cbranch_scc1 L_p0_20
    s_and_b32 s58, s66, 3
    s_cmp_lg_u32 s58, 0
    s_cbranch_scc1 L_nokv_22
    s_lshr_b32 s58, s66, 2
    s_lshl_b32 s58, s58, 7
    s_add_u32 s58, s58, 135790592
    v_mov_b32 v3, 0
    s_mov_b32 s59, 0
L_kvp_23:
    s_mov_b64 exec, 1
    buffer_load_dword v4, v3, s[8:11], s58 offen sc1
    s_mov_b64 exec, -1
    s_waitcnt vmcnt(0)
    v_readfirstlane_b32 s64, v4
    s_cmp_ge_u32 s64, 96
    s_cbranch_scc1 L_nokv_22
    s_sleep 4
    s_add_u32 s59, s59, 1
    s_cmp_lt_u32 s59, 262144
    s_cbranch_scc1 L_kvp_23
    s_branch L_bail_3
L_nokv_22:
    s_mul_i32 s58, s66, 393216
    buffer_load_dwordx2 v[30:31], v20, s[8:11], s58 offen offset:0
    buffer_load_dwordx2 v[32:33], v20, s[8:11], s58 offen offset:32
    buffer_load_dwordx2 v[34:35], v20, s[8:11], s58 offen offset:64
L_p0_20:
    s_cmp_lg_u32 s46, 2
    s_cbranch_scc1 L_p1_21
    s_and_b32 s58, s66, 3
    s_cmp_lg_u32 s58, 0
    s_cbranch_scc1 L_nokv_24
    s_lshr_b32 s58, s66, 2
    s_lshl_b32 s58, s58, 7
    s_add_u32 s58, s58, 135790592
    v_mov_b32 v3, 0
    s_mov_b32 s59, 0
L_kvp_25:
    s_mov_b64 exec, 1
    buffer_load_dword v4, v3, s[8:11], s58 offen sc1
    s_mov_b64 exec, -1
    s_waitcnt vmcnt(0)
    v_readfirstlane_b32 s64, v4
    s_cmp_ge_u32 s64, 96
    s_cbranch_scc1 L_nokv_24
    s_sleep 4
    s_add_u32 s59, s59, 1
    s_cmp_lt_u32 s59, 262144
    s_cbranch_scc1 L_kvp_25
    s_branch L_bail_3
L_nokv_24:
    s_mul_i32 s58, s66, 393216
    buffer_load_dwordx4 v[80:83], v21, s[8:11], s58 offen offset:0
    buffer_load_dwordx4 v[84:87], v21, s[8:11], s58 offen offset:16
    buffer_load_dwordx4 v[88:91], v21, s[8:11], s58 offen offset:32
    s_and_b32 s58, s66, 1
    s_mul_i32 s58, s58, 3584
    v_add_u32 v3, s58, v22
    s_waitcnt vmcnt(0)
    ds_write_b128 v3, v[80:83] offset:0
    ds_write_b128 v3, v[84:87] offset:16
    ds_write_b128 v3, v[88:91] offset:32
    s_waitcnt lgkmcnt(0)
L_p1_21:
    buffer_load_dwordx4 v[44:47], v29, s[28:31], 0 offen offset:0
    buffer_load_dwordx4 v[48:51], v29, s[28:31], 0 offen offset:64
    buffer_load_dwordx4 v[52:55], v29, s[28:31], 0 offen offset:128
    buffer_load_dwordx4 v[56:59], v29, s[28:31], 0 offen offset:192
    buffer_load_dwordx4 v[60:63], v29, s[28:31], 0 offen offset:256
    s_waitcnt vmcnt(0)
    s_branch L_aftermem_27
L_step_26:
    s_add_u32 s58, s66, 1
    s_and_b32 s58, s58, 1
    s_mul_i32 s58, s58, 163840
    s_add_u32 s58, s58, 134742016
    s_add_u32 s57, s58, 4096
    s_mov_b32 s59, 0
L_lpoll_29:
    buffer_load_dwordx4 v[44:47], v11, s[8:11], s58 offen offset:0 sc1
    buffer_load_dwordx4 v[48:51], v11, s[8:11], s58 offen offset:1024 sc1
    buffer_load_dwordx4 v[52:55], v11, s[8:11], s58 offen offset:2048 sc1
    buffer_load_dwordx4 v[56:59], v11, s[8:11], s58 offen offset:3072 sc1
    buffer_load_dwordx4 v[60:63], v11, s[8:11], s57 offen offset:0 sc1
    s_waitcnt vmcnt(0)
L_lchk_28:
    v_bitop3_b32 v3, v46, v50, s66 bitop3:0x7e
    v_bitop3_b32 v4, v54, v58, s66 bitop3:0x7e
    v_xor_b32 v5, s66, v62
    v_or3_b32 v3, v3, v4, v5
    v_cmp_ne_u32 vcc, 0, v3
    s_cbranch_vccz L_lok_30
    s_sleep 3
    s_add_u32 s59, s59, 1
    s_cmp_lt_u32 s59, 262144
    s_cbranch_scc1 L_lpoll_29
    s_branch L_bail_3
L_lok_30:
    v_mov_b32_dpp v46, v44 row_ror:8 row_mask:0xf bank_mask:0xf
    v_mov_b32_dpp v47, v45 row_ror:8 row_mask:0xf bank_mask:0xf
    v_mov_b32_dpp v50, v48 row_ror:8 row_mask:0xf bank_mask:0xf
    v_mov_b32_dpp v51, v49 row_ror:8 row_mask:0xf bank_mask:0xf
    v_mov_b32_dpp v54, v52 row_ror:8 row_mask:0xf bank_mask:0xf
    v_mov_b32_dpp v55, v53 row_ror:8 row_mask:0xf bank_mask:0xf
    v_mov_b32_dpp v58, v56 row_ror:8 row_mask:0xf bank_mask:0xf
    v_mov_b32_dpp v59, v57 row_ror:8 row_mask:0xf bank_mask:0xf
    v_mov_b32_dpp v62, v60 row_ror:8 row_mask:0xf bank_mask:0xf
    v_mov_b32_dpp v63, v61 row_ror:8 row_mask:0xf bank_mask:0xf
L_aftermem_27:
    s_nop 1
    v_mfma_f32_16x16x32_bf16 v[64:67], a[0:3], v[44:47], 0
    v_mfma_f32_16x16x32_bf16 v[68:71], a[4:7], v[44:47], 0
    v_mfma_f32_16x16x32_bf16 v[72:75], a[8:11], v[44:47], 0
    v_mfma_f32_16x16x32_bf16 v[64:67], a[12:15], v[48:51], v[64:67]
    v_mfma_f32_16x16x32_bf16 v[68:71], a[16:19], v[48:51], v[68:71]
    v_mfma_f32_16x16x32_bf16 v[72:75], a[20:23], v[48:51], v[72:75]
    v_mfma_f32_16x16x32_bf16 v[64:67], a[24:27], v[52:55], v[64:67]
    v_mfma_f32_16x16x32_bf16 v[68:71], a[28:31], v[52:55], v[68:71]
    v_mfma_f32_16x16x32_bf16 v[72:75], a[32:35], v[52:55], v[72:75]
    v_mfma_f32_16x16x32_bf16 v[64:67], a[36:39], v[56:59], v[64:67]
    v_mfma_f32_16x16x32_bf16 v[68:71], a[40:43], v[56:59], v[68:71]
    v_mfma_f32_16x16x32_bf16 v[72:75], a[44:47], v[56:59], v[72:75]
    v_mfma_f32_16x16x32_bf16 v[64:67], a[48:51], v[60:63], v[64:67]
    v_mfma_f32_16x16x32_bf16 v[68:71], a[52:55], v[60:63], v[68:71]
    v_mfma_f32_16x16x32_bf16 v[72:75], a[56:59], v[60:63], v[72:75]
    s_lshr_b32 s86, s66, 1
    s_add_u32 s86, s86, 1
    s_and_b32 s86, s86, 1
    s_and_b32 s67, s66, 1
    s_mul_i32 s68, s67, 196608
    s_add_u32 s68, s68, 134217728
    s_add_u32 s69, s68, 3072
    s_mul_i32 s87, s67, 2621440
    s_add_u32 s87, s87, 136314880
    s_add_u32 s71, s66, 1
    s_mov_b64 exec, s[52:53]
    s_nop 4
    ds_write_b128 v12, v[64:67] offset:0
    ds_write_b128 v12, v[68:71] offset:1280
    ds_write_b128 v12, v[72:75] offset:2560
    s_mov_b64 exec, -1
    s_waitcnt vmcnt(0) lgkmcnt(0)
    s_barrier
    s_cmp_ge_u32 s46, 4
    s_cbranch_scc1 L_w47_31
    s_cmp_ge_u32 s46, 3
    s_cbranch_scc1 L_sd_34
    s_cmp_ge_u32 s46, 2
    s_cbranch_scc1 L_s2_33
    s_mov_b64 exec, s[52:53]
    ds_read_b128 v[56:59], v13 offset:0
    ds_read_b128 v[60:63], v13 offset:1280
    ds_read_b128 v[64:67], v13 offset:2560
    ds_read_b128 v[68:71], v13 offset:3840
    ds_read_b128 v[72:75], v13 offset:5120
    ds_read_b128 v[76:79], v13 offset:6400
    ds_read_b128 v[80:83], v13 offset:7680
    ds_read_b128 v[84:87], v13 offset:8960
    ds_read_b128 v[88:91], v13 offset:10240
    ds_read_b128 v[92:95], v13 offset:11520
    ds_read_b128 v[96:99], v13 offset:12800
    ds_read_b128 v[100:103], v13 offset:14080
    s_waitcnt lgkmcnt(6)
    v_pk_add_f32 v[56:57], v[56:57], v[68:69]
    v_pk_add_f32 v[58:59], v[58:59], v[70:71]
    v_pk_add_f32 v[60:61], v[60:61], v[72:73]
    v_pk_add_f32 v[62:63], v[62:63], v[74:75]
    v_pk_add_f32 v[64:65], v[64:65], v[76:77]
    v_pk_add_f32 v[66:67], v[66:67], v[78:79]
    s_waitcnt lgkmcnt(0)
    v_pk_add_f32 v[80:81], v[80:81], v[92:93]
    v_pk_add_f32 v[82:83], v[82:83], v[94:95]
    v_pk_add_f32 v[84:85], v[84:85], v[96:97]
    v_pk_add_f32 v[86:87], v[86:87], v[98:99]
    v_pk_add_f32 v[88:89], v[88:89], v[100:101]
    v_pk_add_f32 v[90:91], v[90:91], v[102:103]
    v_pk_add_f32 v[56:57], v[56:57], v[80:81]
    v_pk_add_f32 v[58:59], v[58:59], v[82:83]
    v_pk_add_f32 v[60:61], v[60:61], v[84:85]
    v_pk_add_f32 v[62:63], v[62:63], v[86:87]
    v_pk_add_f32 v[64:65], v[64:65], v[88:89]
    v_pk_add_f32 v[66:67], v[66:67], v[90:91]
    v_cvt_pk_bf16_f32 v36, v56, v57
    v_cvt_pk_bf16_f32 v37, v58, v59
    v_cvt_pk_bf16_f32 v38, v60, v61
    v_cvt_pk_bf16_f32 v39, v62, v63
    v_cvt_pk_bf16_f32 v40, v64, v65
    v_cvt_pk_bf16_f32 v41, v66, v67
    s_nop 1
    v_mfma_f32_16x16x32_bf16 v[56:59], v[30:33], v[36:39], 0
    v_mfma_f32_16x16x16_bf16 v[60:63], v[34:35], v[40:41], 0
    s_mov_b64 exec, s[52:53]
    s_nop 7
    s_nop 1
    v_pk_add_f32 v[56:57], v[56:57], v[60:61]
    v_pk_add_f32 v[58:59], v[58:59], v[62:63]
    v_and_or_b32 v56, v56, -2, s86
    s_cmp_eq_u32 s72, 0
    s_cbranch_scc1 L_stf_35
    buffer_store_dwordx4 v[56:59], v16, s[8:11], s68 offen sc1
    s_branch L_ste_36
L_stf_35:
    buffer_store_dwordx4 v[56:59], v16, s[8:11], s68 offen
L_ste_36:
    s_mov_b64 exec, -1
    s_branch L_sd_34
L_s2_33:
    ds_read_b128 v[56:59], v13 offset:0
    ds_read_b128 v[60:63], v13 offset:1280
    ds_read_b128 v[64:67], v13 offset:2560
    ds_read_b128 v[68:71], v13 offset:3840
    ds_read_b128 v[72:75], v13 offset:5120
    ds_read_b128 v[76:79], v13 offset:6400
    ds_read_b128 v[80:83], v13 offset:7680
    ds_read_b128 v[84:87], v13 offset:8960
    ds_read_b128 v[88:91], v13 offset:10240
    ds_read_b128 v[92:95], v13 offset:11520
    ds_read_b128 v[96:99], v13 offset:12800
    ds_read_b128 v[100:103], v13 offset:14080
    s_waitcnt lgkmcnt(6)
    v_pk_add_f32 v[56:57], v[56:57], v[68:69]
    v_pk_add_f32 v[58:59], v[58:59], v[70:71]
    v_pk_add_f32 v[60:61], v[60:61], v[72:73]
    v_pk_add_f32 v[62:63], v[62:63], v[74:75]
    v_pk_add_f32 v[64:65], v[64:65], v[76:77]
    v_pk_add_f32 v[66:67], v[66:67], v[78:79]
    s_waitcnt lgkmcnt(0)
    v_pk_add_f32 v[80:81], v[80:81], v[92:93]
    v_pk_add_f32 v[82:83], v[82:83], v[94:95]
    v_pk_add_f32 v[84:85], v[84:85], v[96:97]
    v_pk_add_f32 v[86:87], v[86:87], v[98:99]
    v_pk_add_f32 v[88:89], v[88:89], v[100:101]
    v_pk_add_f32 v[90:91], v[90:91], v[102:103]
    v_pk_add_f32 v[56:57], v[56:57], v[80:81]
    v_pk_add_f32 v[58:59], v[58:59], v[82:83]
    v_pk_add_f32 v[60:61], v[60:61], v[84:85]
    v_pk_add_f32 v[62:63], v[62:63], v[86:87]
    v_pk_add_f32 v[64:65], v[64:65], v[88:89]
    v_pk_add_f32 v[66:67], v[66:67], v[90:91]
    v_cvt_pk_bf16_f32 v36, v56, v57
    v_cvt_pk_bf16_f32 v37, v58, v59
    v_cvt_pk_bf16_f32 v38, v60, v61
    v_cvt_pk_bf16_f32 v39, v62, v63
    v_cvt_pk_bf16_f32 v40, v64, v65
    v_cvt_pk_bf16_f32 v41, v66, v67
    s_nop 1
    v_mfma_f32_16x16x32_bf16 v[56:59], v[36:39], v[36:39], 0
    v_mfma_f32_16x16x16_bf16 v[60:63], v[40:41], v[40:41], 0
    s_mov_b64 exec, s[52:53]
    s_nop 7
    s_nop 1
    v_pk_add_f32 v[56:57], v[56:57], v[60:61]
    v_pk_add_f32 v[58:59], v[58:59], v[62:63]
    v_and_or_b32 v56, v56, -2, s86
    v_and_or_b32 v57, v57, -2, s86
    v_and_or_b32 v58, v58, -2, s86
    v_and_or_b32 v59, v59, -2, s86
    s_cmp_eq_u32 s72, 0
    s_cbranch_scc1 L_stf_37
    buffer_store_dwordx4 v[56:59], v16, s[8:11], s68 offen sc1
    s_branch L_ste_38
L_stf_37:
    buffer_store_dwordx4 v[56:59], v16, s[8:11], s68 offen
L_ste_38:
    s_mov_b64 exec, -1
L_sd_34:
    s_barrier
    s_cmp_ge_u32 s66, 63
    s_cbranch_scc1 L_lastl_39
    s_sleep 2
    buffer_load_dwordx4 v[60:63], v17, s[8:11], s68 offen offset:0 sc1
    buffer_load_dword v76, v42, s[8:11], s68 offen offset:0 sc1
    buffer_load_dwordx4 v[64:67], v17, s[8:11], s68 offen offset:1536 sc1
    buffer_load_dword v77, v42, s[8:11], s68 offen offset:1536 sc1
    buffer_load_dwordx4 v[68:71], v17, s[8:11], s69 offen offset:0 sc1
    buffer_load_dword v78, v42, s[8:11], s69 offen offset:0 sc1
    buffer_load_dwordx4 v[72:75], v17, s[8:11], s69 offen offset:1536 sc1
    buffer_load_dword v79, v42, s[8:11], s69 offen offset:1536 sc1
    s_mul_i32 s59, s67, 3584
    v_add_u32 v6, s59, v18
    ds_read_b64 v[80:81], v15 offset:0
    ds_read_b64 v[82:83], v15 offset:512
    ds_read_b64 v[84:85], v15 offset:1024
    ds_read_b64 v[86:87], v15 offset:1536
    ds_read_b64 v[88:89], v15 offset:2048
    ds_read_b64 v[90:91], v15 offset:2560
    ds_read_b64 v[92:93], v15 offset:3072
    ds_read_b64 v[94:95], v15 offset:3584
    ds_read_b64 v[96:97], v15 offset:4096
    ds_read_b64 v[98:99], v15 offset:4608
    ds_read_b64 v[100:101], v15 offset:5120
    ds_read_b64 v[102:103], v15 offset:5632
    ds_read_b64_tr_b16 v[36:37], v6 offset:0
    ds_read_b64_tr_b16 v[38:39], v6 offset:1792
    ds_read_b64_tr_b16 v[44:45], v6 offset:32
    ds_read_b64_tr_b16 v[46:47], v6 offset:1824
    ds_read_b64_tr_b16 v[50:51], v6 offset:64
    ds_read_b64_tr_b16 v[52:53], v6 offset:1856
    v_mov_b32 v41, 0
    v_mov_b32 v49, 0
    v_mov_b32 v55, 0
    s_waitcnt lgkmcnt(6)
    v_pk_add_f32 v[80:81], v[80:81], v[86:87]
    v_pk_add_f32 v[82:83], v[82:83], v[88:89]
    v_pk_add_f32 v[84:85], v[84:85], v[90:91]
    v_pk_add_f32 v[92:93], v[92:93], v[98:99]
    v_pk_add_f32 v[94:95], v[94:95], v[100:101]
    v_pk_add_f32 v[96:97], v[96:97], v[102:103]
    v_pk_add_f32 v[80:81], v[80:81], v[92:93]
    v_pk_add_f32 v[82:83], v[82:83], v[94:95]
    v_pk_add_f32 v[84:85], v[84:85], v[96:97]
    v_cvt_pk_bf16_f32 v40, v80, v81
    v_cvt_pk_bf16_f32 v48, v82, v83
    v_cvt_pk_bf16_f32 v54, v84, v85
    v_mov_b32 v84, 0
    v_mov_b32 v85, 0
    v_mov_b32 v86, 0
    v_mov_b32 v87, 0
    v_mov_b32 v88, 0
    v_mov_b32 v89, 0
    v_mov_b32 v90, 0
    v_mov_b32 v91, 0
    v_mov_b32 v92, 0
    v_mov_b32 v93, 0
    v_mov_b32 v94, 0
    v_mov_b32 v95, 0
    s_mov_b32 s59, 0
    s_branch L_gw_42
L_gpoll_40:
    buffer_load_dwordx4 v[60:63], v17, s[8:11], s68 offen offset:0 sc1
    buffer_load_dword v76, v42, s[8:11], s68 offen offset:0 sc1
    buffer_load_dwordx4 v[64:67], v17, s[8:11], s68 offen offset:1536 sc1
    buffer_load_dword v77, v42, s[8:11], s68 offen offset:1536 sc1
    buffer_load_dwordx4 v[68:71], v17, s[8:11], s69 offen offset:0 sc1
    buffer_load_dword v78, v42, s[8:11], s69 offen offset:0 sc1
    buffer_load_dwordx4 v[72:75], v17, s[8:11], s69 offen offset:1536 sc1
    buffer_load_dword v79, v42, s[8:11], s69 offen offset:1536 sc1
L_gw_42:
    s_waitcnt vmcnt(0)
    v_bitop3_b32 v2, v60, v64, s86 bitop3:0x7e
    v_bitop3_b32 v3, v68, v72, s86 bitop3:0x7e
    v_bitop3_b32 v4, v76, v77, s86 bitop3:0x7e
    v_bitop3_b32 v5, v78, v79, s86 bitop3:0x7e
    v_or3_b32 v2, v2, v5, v4
    v_or_b32 v2, v2, v3
    v_and_b32 v2, 1, v2
    v_cmp_ne_u32 vcc, 0, v2
    s_cbranch_vccz L_gok_41
    s_sleep 2
    s_add_u32 s59, s59, 1
    s_cmp_lt_u32 s59, 262144
    s_cbranch_scc1 L_gpoll_40
    s_branch L_bail_3
L_gok_41:
    v_pk_add_f32 v[60:61], v[60:61], v[64:65]
    v_pk_add_f32 v[68:69], v[68:69], v[72:73]
    v_pk_add_f32 v[62:63], v[62:63], v[66:67]
    v_pk_add_f32 v[70:71], v[70:71], v[74:75]
    v_pk_add_f32 v[76:77], v[76:77], v[78:79]
L_gj_43:
    v_pk_add_f32 v[60:61], v[60:61], v[68:69]
    v_pk_add_f32 v[62:63], v[62:63], v[70:71]
    v_add_f32 v64, v76, v77
    v_cvt_pk_bf16_f32 v2, v60, v61
    v_cvt_pk_bf16_f32 v3, v62, v63
    v_cvt_pk_bf16_f32 v4, v64, v64
    v_lshlrev_b32 v60, 16, v2
    v_and_b32 v61, 0xffff0000, v2
    v_lshlrev_b32 v62, 16, v3
    v_and_b32 v63, 0xffff0000, v3
    v_lshlrev_b32 v64, 16, v4
    v_pk_mul_f32 v[60:61], v[60:61], s[50:51] op_sel_hi:[1,0]
    v_pk_mul_f32 v[62:63], v[62:63], s[50:51] op_sel_hi:[1,0]
    v_mul_f32 v64, s50, v64
    v_cvt_pk_bf16_f32 v2, v60, v61
    v_cvt_pk_bf16_f32 v3, v62, v63
    v_cvt_pk_bf16_f32 v4, v64, v64
    v_lshlrev_b32 v60, 16, v2
    v_and_b32 v61, 0xffff0000, v2
    v_lshlrev_b32 v62, 16, v3
    v_and_b32 v63, 0xffff0000, v3
    v_lshlrev_b32 v64, 16, v4
    v_max3_f32 v4, v60, v61, v62
    v_max3_f32 v4, v4, v63, v64
    s_nop 1
    v_max_f32_dpp v4, v4, v4 row_ror:8 row_mask:0xf bank_mask:0xf
    v_mov_b32 v3, v4
    s_nop 1
    v_permlane32_swap_b32 v4, v3
    s_nop 1
    v_max_f32 v4, v4, v3
    v_mov_b32 v3, v4
    s_nop 1
    v_permlane16_swap_b32 v4, v3
    s_nop 1
    v_max_f32 v4, v4, v3
    v_pk_add_f32 v[60:61], v[60:61], v[4:5] op_sel_hi:[1,0] neg_lo:[0,1] neg_hi:[0,1]
    v_pk_add_f32 v[62:63], v[62:63], v[4:5] op_sel_hi:[1,0] neg_lo:[0,1] neg_hi:[0,1]
    v_sub_f32 v64, v64, v4
    v_pk_mul_f32 v[60:61], v[60:61], s[50:51] op_sel:[0,1] op_sel_hi:[1,1]
    v_pk_mul_f32 v[62:63], v[62:63], s[50:51] op_sel:[0,1] op_sel_hi:[1,1]
    v_mul_f32 v64, s51, v64
    v_exp_f32 v60, v60
    v_exp_f32 v61, v61
    v_exp_f32 v62, v62
    v_exp_f32 v63, v63
    v_exp_f32 v64, v64
    s_nop 0
    v_pk_add_f32 v[4:5], v[60:61], v[62:63]
    v_add_f32 v4, v4, v64
    v_add_f32 v4, v4, v5
    s_nop 1
    v_add_f32_dpp v4, v4, v4 row_ror:8 row_mask:0xf bank_mask:0xf
    v_mov_b32 v3, v4
    s_nop 1
    v_permlane32_swap_b32 v4, v3
    s_nop 1
    v_add_f32 v4, v4, v3
    v_mov_b32 v3, v4
    s_nop 1
    v_permlane16_swap_b32 v4, v3
    s_nop 1
    v_add_f32 v4, v4, v3
    v_rcp_f32 v4, v4
    s_waitcnt vmcnt(0)
    v_mov_b32 v101, 0
    v_pk_mul_f32 v[60:61], v[60:61], v[4:5] op_sel_hi:[1,0]
    v_pk_mul_f32 v[62:63], v[62:63], v[4:5] op_sel_hi:[1,0]
    v_mul_f32 v64, v64, v4
    v_cvt_pk_bf16_f32 v96, v60, v61
    v_cvt_pk_bf16_f32 v97, v62, v63
    v_mov_b32_dpp v3, v64 row_ror:8 row_mask:0xf bank_mask:0xf
    v_mov_b32_dpp v98, v96 row_ror:8 row_mask:0xf bank_mask:0xf
    v_mov_b32_dpp v99, v97 row_ror:8 row_mask:0xf bank_mask:0xf
    v_cvt_pk_bf16_f32 v100, v64, v3
    s_waitcnt lgkmcnt(0)
    s_nop 0
    v_mfma_f32_16x16x16_bf16 v[68:71], v[40:41], v[100:101], 0
    v_mfma_f32_16x16x16_bf16 v[72:75], v[48:49], v[100:101], 0
    v_mfma_f32_16x16x16_bf16 v[76:79], v[54:55], v[100:101], 0
    s_nop 1
    v_mfma_f32_16x16x32_bf16 v[68:71], v[36:39], v[96:99], v[68:71]
    v_mfma_f32_16x16x32_bf16 v[72:75], v[44:47], v[96:99], v[72:75]
    v_mfma_f32_16x16x32_bf16 v[76:79], v[50:53], v[96:99], v[76:79]
    s_mov_b64 exec, s[52:53]
    s_nop 7
    s_nop 0
    v_cvt_pk_bf16_f32 v84, v68, v69
    v_cvt_pk_bf16_f32 v85, v70, v71
    v_cvt_pk_bf16_f32 v86, v72, v73
    v_cvt_pk_bf16_f32 v87, v74, v75
    v_cvt_pk_bf16_f32 v92, v76, v77
    v_cvt_pk_bf16_f32 v93, v78, v79
    s_mov_b64 exec, -1
    v_mfma_f32_16x16x32_bf16 v[56:59], a[60:63], v[84:87], 0
    v_mov_b32_dpp v94, v92 row_ror:8 row_mask:0xf bank_mask:0xc
    v_mov_b32_dpp v95, v93 row_ror:8 row_mask:0xf bank_mask:0xc
    v_mfma_f32_16x16x32_bf16 v[60:63], a[72:75], v[84:87], 0
    v_mov_b32_dpp v88, v84 row_ror:8 row_mask:0xf bank_mask:0xc
    v_mov_b32_dpp v89, v85 row_ror:8 row_mask:0xf bank_mask:0xc
    v_mov_b32_dpp v90, v86 row_ror:8 row_mask:0xf bank_mask:0xc
    v_mov_b32_dpp v91, v87 row_ror:8 row_mask:0xf bank_mask:0xc
    v_mfma_f32_16x16x32_bf16 v[64:67], a[84:87], v[84:87], 0
    v_mfma_f32_16x16x32_bf16 v[68:71], a[96:99], v[84:87], 0
    v_mfma_f32_16x16x32_bf16 v[72:75], a[108:111], v[84:87], 0
    v_mfma_f32_16x16x32_bf16 v[56:59], a[68:71], v[92:95], v[56:59]
    v_mfma_f32_16x16x32_bf16 v[60:63], a[80:83], v[92:95], v[60:63]
    v_mfma_f32_16x16x32_bf16 v[64:67], a[92:95], v[92:95], v[64:67]
    v_mfma_f32_16x16x32_bf16 v[68:71], a[104:107], v[92:95], v[68:71]
    v_mfma_f32_16x16x32_bf16 v[72:75], a[116:119], v[92:95], v[72:75]
    s_cmp_eq_u32 s72, 0
    s_cbranch_scc1 L_pbf_44
    v_mfma_f32_16x16x32_bf16 v[56:59], a[64:67], v[88:91], v[56:59]
    v_mfma_f32_16x16x32_bf16 v[60:63], a[76:79], v[88:91], v[60:63]
    v_mfma_f32_16x16x32_bf16 v[64:67], a[88:91], v[88:91], v[64:67]
    v_and_or_b32 v56, v56, -2, s86
    buffer_store_dwordx4 v[56:59], v19, s[8:11], s87 offen offset:0 sc1
    v_mfma_f32_16x16x32_bf16 v[68:71], a[100:103], v[88:91], v[68:71]
    v_and_or_b32 v60, v60, -2, s86
    buffer_store_dwordx4 v[60:63], v19, s[8:11], s87 offen offset:128 sc1
    v_mfma_f32_16x16x32_bf16 v[72:75], a[112:115], v[88:91], v[72:75]
    v_and_or_b32 v64, v64, -2, s86
    buffer_store_dwordx4 v[64:67], v19, s[8:11], s87 offen offset:256 sc1
    s_nop 5
    v_and_or_b32 v68, v68, -2, s86
    buffer_store_dwordx4 v[68:71], v19, s[8:11], s87 offen offset:384 sc1
    s_nop 3
    v_and_or_b32 v72, v72, -2, s86
    buffer_store_dwordx4 v[72:75], v19, s[8:11], s87 offen offset:512 sc1
    s_branch L_pbe_45
L_pbf_44:
    v_mfma_f32_16x16x32_bf16 v[56:59], a[64:67], v[88:91], v[56:59]
    v_mfma_f32_16x16x32_bf16 v[60:63], a[76:79], v[88:91], v[60:63]
    v_mfma_f32_16x16x32_bf16 v[64:67], a[88:91], v[88:91], v[64:67]
    v_and_or_b32 v56, v56, -2, s86
    buffer_store_dwordx4 v[56:59], v19, s[8:11], s87 offen offset:0
    v_mfma_f32_16x16x32_bf16 v[68:71], a[100:103], v[88:91], v[68:71]
    v_and_or_b32 v60, v60, -2, s86
    buffer_store_dwordx4 v[60:63], v19, s[8:11], s87 offen offset:128
    v_mfma_f32_16x16x32_bf16 v[72:75], a[112:115], v[88:91], v[72:75]
    v_and_or_b32 v64, v64, -2, s86
    buffer_store_dwordx4 v[64:67], v19, s[8:11], s87 offen offset:256
    s_nop 5
    v_and_or_b32 v68, v68, -2, s86
    buffer_store_dwordx4 v[68:71], v19, s[8:11], s87 offen offset:384
    s_nop 3
    v_and_or_b32 v72, v72, -2, s86
    buffer_store_dwordx4 v[72:75], v19, s[8:11], s87 offen offset:512
L_pbe_45:
    s_branch L_b3_46
L_w47_31:
    v_mfma_f32_16x16x32_bf16 v[64:67], v[44:47], a[60:63], 0
    v_mfma_f32_16x16x32_bf16 v[68:71], v[44:47], a[64:67], 0
    v_mfma_f32_16x16x32_bf16 v[72:75], v[44:47], a[68:71], 0
    v_mfma_f32_16x16x32_bf16 v[64:67], v[48:51], a[72:75], v[64:67]
    v_mfma_f32_16x16x32_bf16 v[68:71], v[48:51], a[76:79], v[68:71]
    v_mfma_f32_16x16x32_bf16 v[72:75], v[48:51], a[80:83], v[72:75]
    v_mfma_f32_16x16x32_bf16 v[64:67], v[52:55], a[84:87], v[64:67]
    v_mfma_f32_16x16x32_bf16 v[68:71], v[52:55], a[88:91], v[68:71]
    v_mfma_f32_16x16x32_bf16 v[72:75], v[52:55], a[92:95], v[72:75]
    v_mfma_f32_16x16x32_bf16 v[64:67], v[56:59], a[96:99], v[64:67]
    v_mfma_f32_16x16x32_bf16 v[68:71], v[56:59], a[100:103], v[68:71]
    v_mfma_f32_16x16x32_bf16 v[72:75], v[56:59], a[104:107], v[72:75]
    v_mfma_f32_16x16x32_bf16 v[64:67], v[60:63], a[108:111], v[64:67]
    v_mfma_f32_16x16x32_bf16 v[68:71], v[60:63], a[112:115], v[68:71]
    v_mfma_f32_16x16x32_bf16 v[72:75], v[60:63], a[116:119], v[72:75]
    s_mov_b64 exec, s[54:55]
    s_nop 7
    s_nop 1
    ds_write_b128 v14, v[64:67] offset:0
    ds_write_b128 v14, v[68:71] offset:512
    ds_write_b128 v14, v[72:75] offset:1024
    s_mov_b64 exec, -1
    s_waitcnt lgkmcnt(0)
    s_barrier
L_n5_47:
    s_cmp_ge_u32 s66, 63
    s_cbranch_scc1 L_done_2
L_b3_46:
    s_barrier
    s_cmp_ge_u32 s46, 3
    s_cbranch_scc1 L_n4_48
    s_cmp_eq_u32 s46, 2
    s_cbranch_scc1 L_n4b_49
    s_barrier
    s_and_b32 s58, s71, 3
    s_cmp_lg_u32 s58, 0
    s_cbranch_scc1 L_nokv_51
    s_lshr_b32 s58, s71, 2
    s_lshl_b32 s58, s58, 7
    s_add_u32 s58, s58, 135790592
    v_mov_b32 v3, 0
    s_mov_b32 s59, 0
L_kvp_52:
    s_mov_b64 exec, 1
    buffer_load_dword v4, v3, s[8:11], s58 offen sc1
    s_mov_b64 exec, -1
    s_waitcnt vmcnt(0)
    v_readfirstlane_b32 s64, v4
    s_cmp_ge_u32 s64, 96
    s_cbranch_scc1 L_nokv_51
    s_sleep 4
    s_add_u32 s59, s59, 1
    s_cmp_lt_u32 s59, 262144
    s_cbranch_scc1 L_kvp_52
    s_branch L_bail_3
L_nokv_51:
    s_mul_i32 s58, s71, 393216
    buffer_load_dwordx2 v[30:31], v20, s[8:11], s58 offen offset:0
    buffer_load_dwordx2 v[32:33], v20, s[8:11], s58 offen offset:32
    buffer_load_dwordx2 v[34:35], v20, s[8:11], s58 offen offset:64
    s_cmp_eq_u32 s46, 0
    s_cbranch_scc1 L_endb_32
    s_sleep 3
    s_not_b64 exec, s[52:53]
    ds_read_b128 v[56:59], v13 offset:0
    ds_read_b128 v[60:63], v13 offset:1280
    ds_read_b128 v[64:67], v13 offset:2560
    ds_read_b128 v[68:71], v13 offset:3840
    ds_read_b128 v[72:75], v13 offset:5120
    ds_read_b128 v[76:79], v13 offset:6400
    ds_read_b128 v[80:83], v13 offset:7680
    ds_read_b128 v[84:87], v13 offset:8960
    ds_read_b128 v[88:91], v13 offset:10240
    ds_read_b128 v[92:95], v13 offset:11520
    ds_read_b128 v[96:99], v13 offset:12800
    ds_read_b128 v[100:103], v13 offset:14080
    s_waitcnt lgkmcnt(6)
    v_pk_add_f32 v[56:57], v[56:57], v[68:69]
    v_pk_add_f32 v[58:59], v[58:59], v[70:71]
    v_pk_add_f32 v[60:61], v[60:61], v[72:73]
    v_pk_add_f32 v[62:63], v[62:63], v[74:75]
    v_pk_add_f32 v[64:65], v[64:65], v[76:77]
    v_pk_add_f32 v[66:67], v[66:67], v[78:79]
    s_waitcnt lgkmcnt(0)
    v_pk_add_f32 v[80:81], v[80:81], v[92:93]
    v_pk_add_f32 v[82:83], v[82:83], v[94:95]
    v_pk_add_f32 v[84:85], v[84:85], v[96:97]
    v_pk_add_f32 v[86:87], v[86:87], v[98:99]
    v_pk_add_f32 v[88:89], v[88:89], v[100:101]
    v_pk_add_f32 v[90:91], v[90:91], v[102:103]
    v_pk_add_f32 v[56:57], v[56:57], v[80:81]
    v_pk_add_f32 v[58:59], v[58:59], v[82:83]
    v_pk_add_f32 v[60:61], v[60:61], v[84:85]
    v_pk_add_f32 v[62:63], v[62:63], v[86:87]
    v_pk_add_f32 v[64:65], v[64:65], v[88:89]
    v_pk_add_f32 v[66:67], v[66:67], v[90:91]
    v_cvt_pk_bf16_f32 v36, v56, v57
    v_cvt_pk_bf16_f32 v37, v58, v59
    v_cvt_pk_bf16_f32 v38, v60, v61
    v_cvt_pk_bf16_f32 v39, v62, v63
    v_cvt_pk_bf16_f32 v40, v64, v65
    v_cvt_pk_bf16_f32 v41, v66, v67
    s_mul_i32 s59, s66, 98304
    s_add_u32 s59, s59, 79691776
    buffer_store_dwordx2 v[36:37], v27, s[8:11], s59 offen offset:0
    buffer_store_dwordx2 v[38:39], v27, s[8:11], s59 offen offset:32
    buffer_store_dwordx2 v[40:41], v27, s[8:11], s59 offen offset:64
    s_mov_b64 exec, -1
    ds_read_b64 v[80:81], v15 offset:0
    ds_read_b64 v[82:83], v15 offset:512
    ds_read_b64 v[84:85], v15 offset:1024
    ds_read_b64 v[86:87], v15 offset:1536
    ds_read_b64 v[88:89], v15 offset:2048
    ds_read_b64 v[90:91], v15 offset:2560
    ds_read_b64 v[92:93], v15 offset:3072
    ds_read_b64 v[94:95], v15 offset:3584
    ds_read_b64 v[96:97], v15 offset:4096
    ds_read_b64 v[98:99], v15 offset:4608
    ds_read_b64 v[100:101], v15 offset:5120
    ds_read_b64 v[102:103], v15 offset:5632
    s_waitcnt lgkmcnt(0)
    v_pk_add_f32 v[80:81], v[80:81], v[86:87]
    v_pk_add_f32 v[82:83], v[82:83], v[88:89]
    v_pk_add_f32 v[84:85], v[84:85], v[90:91]
    v_pk_add_f32 v[92:93], v[92:93], v[98:99]
    v_pk_add_f32 v[94:95], v[94:95], v[100:101]
    v_pk_add_f32 v[96:97], v[96:97], v[102:103]
    v_pk_add_f32 v[80:81], v[80:81], v[92:93]
    v_pk_add_f32 v[82:83], v[82:83], v[94:95]
    v_pk_add_f32 v[84:85], v[84:85], v[96:97]
    v_cvt_pk_bf16_f32 v44, v80, v81
    v_cvt_pk_bf16_f32 v45, v82, v83
    v_cvt_pk_bf16_f32 v46, v84, v85
    s_add_u32 s59, s59, 6291456
    s_add_u32 s58, s59, 12288
    buffer_store_short v44, v28, s[8:11], s59 offen offset:0
    buffer_store_short_d16_hi v44, v28, s[8:11], s58 offen offset:0
    buffer_store_short v45, v28, s[8:11], s59 offen offset:32
    buffer_store_short_d16_hi v45, v28, s[8:11], s58 offen offset:32
    buffer_store_short v46, v28, s[8:11], s59 offen offset:64
    buffer_store_short_d16_hi v46, v28, s[8:11], s58 offen offset:64
    s_branch L_endb_32
    s_cmp_eq_u32 s46, 0
    s_cbranch_scc1 L_k0_50
    s_barrier
    s_sleep 4
    s_not_b64 exec, s[52:53]
    ds_read_b128 v[56:59], v13 offset:0
    ds_read_b128 v[60:63], v13 offset:1280
    ds_read_b128 v[64:67], v13 offset:2560
    ds_read_b128 v[68:71], v13 offset:3840
    ds_read_b128 v[72:75], v13 offset:5120
    ds_read_b128 v[76:79], v13 offset:6400
    ds_read_b128 v[80:83], v13 offset:7680
    ds_read_b128 v[84:87], v13 offset:8960
    ds_read_b128 v[88:91], v13 offset:10240
    ds_read_b128 v[92:95], v13 offset:11520
    ds_read_b128 v[96:99], v13 offset:12800
    ds_read_b128 v[100:103], v13 offset:14080
    s_waitcnt lgkmcnt(6)
    v_pk_add_f32 v[56:57], v[56:57], v[68:69]
    v_pk_add_f32 v[58:59], v[58:59], v[70:71]
    v_pk_add_f32 v[60:61], v[60:61], v[72:73]
    v_pk_add_f32 v[62:63], v[62:63], v[74:75]
    v_pk_add_f32 v[64:65], v[64:65], v[76:77]
    v_pk_add_f32 v[66:67], v[66:67], v[78:79]
    s_waitcnt lgkmcnt(0)
    v_pk_add_f32 v[80:81], v[80:81], v[92:93]
    v_pk_add_f32 v[82:83], v[82:83], v[94:95]
    v_pk_add_f32 v[84:85], v[84:85], v[96:97]
    v_pk_add_f32 v[86:87], v[86:87], v[98:99]
    v_pk_add_f32 v[88:89], v[88:89], v[100:101]
    v_pk_add_f32 v[90:91], v[90:91], v[102:103]
    v_pk_add_f32 v[56:57], v[56:57], v[80:81]
    v_pk_add_f32 v[58:59], v[58:59], v[82:83]
    v_pk_add_f32 v[60:61], v[60:61], v[84:85]
    v_pk_add_f32 v[62:63], v[62:63], v[86:87]
    v_pk_add_f32 v[64:65], v[64:65], v[88:89]
    v_pk_add_f32 v[66:67], v[66:67], v[90:91]
    v_cvt_pk_bf16_f32 v36, v56, v57
    v_cvt_pk_bf16_f32 v37, v58, v59
    v_cvt_pk_bf16_f32 v38, v60, v61
    v_cvt_pk_bf16_f32 v39, v62, v63
    v_cvt_pk_bf16_f32 v40, v64, v65
    v_cvt_pk_bf16_f32 v41, v66, v67
    s_mul_i32 s59, s66, 98304
    s_add_u32 s59, s59, 79691776
    buffer_store_dwordx2 v[36:37], v27, s[8:11], s59 offen offset:0
    buffer_store_dwordx2 v[38:39], v27, s[8:11], s59 offen offset:32
    buffer_store_dwordx2 v[40:41], v27, s[8:11], s59 offen offset:64
    s_mov_b64 exec, -1
    ds_read_b64 v[80:81], v15 offset:0
    ds_read_b64 v[82:83], v15 offset:512
    ds_read_b64 v[84:85], v15 offset:1024
    ds_read_b64 v[86:87], v15 offset:1536
    ds_read_b64 v[88:89], v15 offset:2048
    ds_read_b64 v[90:91], v15 offset:2560
    ds_read_b64 v[92:93], v15 offset:3072
    ds_read_b64 v[94:95], v15 offset:3584
    ds_read_b64 v[96:97], v15 offset:4096
    ds_read_b64 v[98:99], v15 offset:4608
    ds_read_b64 v[100:101], v15 offset:5120
    ds_read_b64 v[102:103], v15 offset:5632
    s_waitcnt lgkmcnt(0)
    v_pk_add_f32 v[80:81], v[80:81], v[86:87]
    v_pk_add_f32 v[82:83], v[82:83], v[88:89]
    v_pk_add_f32 v[84:85], v[84:85], v[90:91]
    v_pk_add_f32 v[92:93], v[92:93], v[98:99]
    v_pk_add_f32 v[94:95], v[94:95], v[100:101]
    v_pk_add_f32 v[96:97], v[96:97], v[102:103]
    v_pk_add_f32 v[80:81], v[80:81], v[92:93]
    v_pk_add_f32 v[82:83], v[82:83], v[94:95]
    v_pk_add_f32 v[84:85], v[84:85], v[96:97]
    v_cvt_pk_bf16_f32 v44, v80, v81
    v_cvt_pk_bf16_f32 v45, v82, v83
    v_cvt_pk_bf16_f32 v46, v84, v85
    s_add_u32 s59, s59, 6291456
    s_add_u32 s58, s59, 12288
    buffer_store_short v44, v28, s[8:11], s59 offen offset:0
    buffer_store_short_d16_hi v44, v28, s[8:11], s58 offen offset:0
    buffer_store_short v45, v28, s[8:11], s59 offen offset:32
    buffer_store_short_d16_hi v45, v28, s[8:11], s58 offen offset:32
    buffer_store_short v46, v28, s[8:11], s59 offen offset:64
    buffer_store_short_d16_hi v46, v28, s[8:11], s58 offen offset:64
    s_branch L_endb_32
L_k0_50:
    s_barrier
    s_branch L_endb_32
L_n4b_49:
    s_barrier
    s_sleep 8
    s_and_b32 s58, s71, 3
    s_cmp_lg_u32 s58, 0
    s_cbranch_scc1 L_nokv_53
    s_lshr_b32 s58, s71, 2
    s_lshl_b32 s58, s58, 7
    s_add_u32 s58, s58, 135790592
    v_mov_b32 v3, 0
    s_mov_b32 s59, 0
L_kvp_54:
    s_mov_b64 exec, 1
    buffer_load_dword v4, v3, s[8:11], s58 offen sc1
    s_mov_b64 exec, -1
    s_waitcnt vmcnt(0)
    v_readfirstlane_b32 s64, v4
    s_cmp_ge_u32 s64, 96
    s_cbranch_scc1 L_nokv_53
    s_sleep 4
    s_add_u32 s59, s59, 1
    s_cmp_lt_u32 s59, 262144
    s_cbranch_scc1 L_kvp_54
    s_branch L_bail_3
L_nokv_53:
    s_mul_i32 s58, s71, 393216
    buffer_load_dwordx4 v[80:83], v21, s[8:11], s58 offen offset:0
    buffer_load_dwordx4 v[84:87], v21, s[8:11], s58 offen offset:16
    buffer_load_dwordx4 v[88:91], v21, s[8:11], s58 offen offset:32
    s_branch L_endb_32
L_n4_48:
    s_sleep 3
    s_mov_b32 s59, 0
L_r1p_55:
    s_mov_b32 s58, s87
    buffer_load_dwordx4 v[44:47], v23, s[8:11], s58 offen sc1
    s_add_u32 s58, s58, 20480
    buffer_load_dwordx4 v[48:51], v23, s[8:11], s58 offen sc1
    s_add_u32 s58, s58, 20480
    buffer_load_dwordx4 v[52:55], v23, s[8:11], s58 offen sc1
    s_add_u32 s58, s58, 20480
    buffer_load_dwordx4 v[56:59], v23, s[8:11], s58 offen sc1
    s_waitcnt vmcnt(0)
    v_bitop3_b32 v2, v44, v48, s86 bitop3:0x7e
    v_bitop3_b32 v3, v52, v56, s86 bitop3:0x7e
    v_or_b32 v2, v2, v3
    v_and_b32 v2, 1, v2
    v_cmp_ne_u32 vcc, 0, v2
    s_cbranch_vccz L_r1ok_56
    s_add_u32 s59, s59, 1
    s_cmp_lt_u32 s59, 262144
    s_cbranch_scc1 L_r1p_55
    s_mov_b64 exec, -1
    s_branch L_bail_3
L_r1ok_56:
    v_pk_add_f32 v[44:45], v[44:45], v[52:53]
    v_pk_add_f32 v[46:47], v[46:47], v[54:55]
    v_pk_add_f32 v[48:49], v[48:49], v[56:57]
    v_pk_add_f32 v[50:51], v[50:51], v[58:59]
    v_pk_add_f32 v[44:45], v[44:45], v[48:49]
    v_pk_add_f32 v[46:47], v[46:47], v[50:51]
    s_nop 1
    v_permlane32_swap_b32 v44, v46
    v_permlane32_swap_b32 v45, v47
    s_nop 1
    v_pk_add_f32 v[44:45], v[44:45], v[46:47]
    s_nop 1
    v_permlane16_swap_b32 v44, v45
    s_mul_i32 s89, s67, 163840
    s_add_u32 s89, s89, 135266304
    v_add_f32 v44, v44, v45
    s_mul_i32 s58, s73, 1280
    s_add_u32 s58, s58, s89
    ds_write_b32 v25, v44 offset:28672
    s_waitcnt lgkmcnt(0)
    s_barrier
    s_cmp_lt_u32 s46, 6
    s_cbranch_scc1 L_endb_32
    s_mov_b64 exec, s[82:83]
    ds_read_b128 v[44:47], v41 offset:28672
    s_waitcnt lgkmcnt(0)
    v_and_or_b32 v44, v44, -2, s86
    buffer_store_dwordx4 v[44:47], v41, s[8:11], s58 offen sc1
    s_nop 1
    s_sleep 15
    s_mov_b32 s58, s89
    buffer_load_dwordx4 v[44:47], v24, s[8:11], s58 offen sc1
    s_add_u32 s58, s58, 20480
    buffer_load_dwordx4 v[48:51], v24, s[8:11], s58 offen sc1
    s_add_u32 s58, s58, 20480
    buffer_load_dwordx4 v[52:55], v24, s[8:11], s58 offen sc1
    s_add_u32 s58, s58, 20480
    buffer_load_dwordx4 v[56:59], v24, s[8:11], s58 offen sc1
    s_add_u32 s58, s58, 20480
    buffer_load_dwordx4 v[60:63], v24, s[8:11], s58 offen sc1
    s_add_u32 s58, s58, 20480
    buffer_load_dwordx4 v[64:67], v24, s[8:11], s58 offen sc1
    s_add_u32 s58, s58, 20480
    buffer_load_dwordx4 v[68:71], v24, s[8:11], s58 offen sc1
    s_add_u32 s58, s58, 20480
    buffer_load_dwordx4 v[72:75], v24, s[8:11], s58 offen sc1
    s_sleep 6
    s_mov_b32 s58, s89
    buffer_load_dwordx4 v[76:79], v24, s[8:11], s58 offen sc1
    s_add_u32 s58, s58, 20480
    buffer_load_dwordx4 v[80:83], v24, s[8:11], s58 offen sc1
    s_add_u32 s58, s58, 20480
    buffer_load_dwordx4 v[84:87], v24, s[8:11], s58 offen sc1
    s_add_u32 s58, s58, 20480
    buffer_load_dwordx4 v[88:91], v24, s[8:11], s58 offen sc1
    s_add_u32 s58, s58, 20480
    buffer_load_dwordx4 v[92:95], v24, s[8:11], s58 offen sc1
    s_add_u32 s58, s58, 20480
    buffer_load_dwordx4 v[96:99], v24, s[8:11], s58 offen sc1
    s_add_u32 s58, s58, 20480
    buffer_load_dwordx4 v[100:103], v24, s[8:11], s58 offen sc1
    s_add_u32 s58, s58, 20480
    buffer_load_dwordx4 v[104:107], v24, s[8:11], s58 offen sc1
    s_waitcnt vmcnt(8)
    v_bitop3_b32 v2, v44, v48, s86 bitop3:0x7e
    v_bitop3_b32 v3, v52, v56, s86 bitop3:0x7e
    v_bitop3_b32 v4, v60, v64, s86 bitop3:0x7e
    v_bitop3_b32 v5, v68, v72, s86 bitop3:0x7e
    v_or3_b32 v2, v2, v5, v4
    v_or_b32 v2, v2, v3
    v_and_b32 v2, 1, v2
    v_cmp_ne_u32 vcc, 0, v2
    s_cbranch_vccz L_useA_58
    s_waitcnt vmcnt(0)
    v_bitop3_b32 v2, v76, v80, s86 bitop3:0x7e
    v_bitop3_b32 v3, v84, v88, s86 bitop3:0x7e
    v_bitop3_b32 v4, v92, v96, s86 bitop3:0x7e
    v_bitop3_b32 v5, v100, v104, s86 bitop3:0x7e
    v_or3_b32 v2, v2, v5, v4
    v_or_b32 v2, v2, v3
    v_and_b32 v2, 1, v2
    v_cmp_ne_u32 vcc, 0, v2
    s_cbranch_vccnz L_cslow_59
    v_pk_add_f32 v[76:77], v[76:77], v[92:93]
    v_pk_add_f32 v[78:79], v[78:79], v[94:95]
    v_pk_add_f32 v[80:81], v[80:81], v[96:97]
    v_pk_add_f32 v[82:83], v[82:83], v[98:99]
    v_pk_add_f32 v[84:85], v[84:85], v[100:101]
    v_pk_add_f32 v[86:87], v[86:87], v[102:103]
    v_pk_add_f32 v[88:89], v[88:89], v[104:105]
    v_pk_add_f32 v[90:91], v[90:91], v[106:107]
    v_pk_add_f32 v[76:77], v[76:77], v[84:85]
    v_pk_add_f32 v[78:79], v[78:79], v[86:87]
    v_pk_add_f32 v[80:81], v[80:81], v[88:89]
    v_pk_add_f32 v[82:83], v[82:83], v[90:91]
    v_pk_add_f32 v[44:45], v[76:77], v[80:81]
    v_pk_add_f32 v[46:47], v[78:79], v[82:83]
    s_branch L_cdone_57
L_useA_58:
    v_pk_add_f32 v[44:45], v[44:45], v[60:61]
    v_pk_add_f32 v[46:47], v[46:47], v[62:63]
    v_pk_add_f32 v[48:49], v[48:49], v[64:65]
    v_pk_add_f32 v[50:51], v[50:51], v[66:67]
    v_pk_add_f32 v[52:53], v[52:53], v[68:69]
    v_pk_add_f32 v[54:55], v[54:55], v[70:71]
    v_pk_add_f32 v[56:57], v[56:57], v[72:73]
    v_pk_add_f32 v[58:59], v[58:59], v[74:75]
    v_pk_add_f32 v[44:45], v[44:45], v[52:53]
    v_pk_add_f32 v[46:47], v[46:47], v[54:55]
    v_pk_add_f32 v[48:49], v[48:49], v[56:57]
    v_pk_add_f32 v[50:51], v[50:51], v[58:59]
    v_pk_add_f32 v[44:45], v[44:45], v[48:49]
    v_pk_add_f32 v[46:47], v[46:47], v[50:51]
    s_branch L_cdone_57
L_cslow_59:
    s_mov_b32 s59, 0
L_ccp_60:
    s_mov_b32 s58, s89
    buffer_load_dwordx4 v[44:47], v24, s[8:11], s58 offen sc1
    s_add_u32 s58, s58, 20480
    buffer_load_dwordx4 v[48:51], v24, s[8:11], s58 offen sc1
    s_add_u32 s58, s58, 20480
    buffer_load_dwordx4 v[52:55], v24, s[8:11], s58 offen sc1
    s_add_u32 s58, s58, 20480
    buffer_load_dwordx4 v[56:59], v24, s[8:11], s58 offen sc1
    s_add_u32 s58, s58, 20480
    buffer_load_dwordx4 v[60:63], v24, s[8:11], s58 offen sc1
    s_add_u32 s58, s58, 20480
    buffer_load_dwordx4 v[64:67], v24, s[8:11], s58 offen sc1
    s_add_u32 s58, s58, 20480
    buffer_load_dwordx4 v[68:71], v24, s[8:11], s58 offen sc1
    s_add_u32 s58, s58, 20480
    buffer_load_dwordx4 v[72:75], v24, s[8:11], s58 offen sc1
    s_waitcnt vmcnt(0)
    v_bitop3_b32 v2, v44, v48, s86 bitop3:0x7e
    v_bitop3_b32 v3, v52, v56, s86 bitop3:0x7e
    v_bitop3_b32 v4, v60, v64, s86 bitop3:0x7e
    v_bitop3_b32 v5, v68, v72, s86 bitop3:0x7e
    v_or3_b32 v2, v2, v5, v4
    v_or_b32 v2, v2, v3
    v_and_b32 v2, 1, v2
    v_cmp_ne_u32 vcc, 0, v2
    s_cbranch_vccz L_ccok_61
    s_add_u32 s59, s59, 1
    s_cmp_lt_u32 s59, 262144
    s_cbranch_scc1 L_ccp_60
    s_mov_b64 exec, -1
    s_branch L_bail_3
L_ccok_61:
    v_pk_add_f32 v[44:45], v[44:45], v[60:61]
    v_pk_add_f32 v[46:47], v[46:47], v[62:63]
    v_pk_add_f32 v[48:49], v[48:49], v[64:65]
    v_pk_add_f32 v[50:51], v[50:51], v[66:67]
    v_pk_add_f32 v[52:53], v[52:53], v[68:69]
    v_pk_add_f32 v[54:55], v[54:55], v[70:71]
    v_pk_add_f32 v[56:57], v[56:57], v[72:73]
    v_pk_add_f32 v[58:59], v[58:59], v[74:75]
    v_pk_add_f32 v[44:45], v[44:45], v[52:53]
    v_pk_add_f32 v[46:47], v[46:47], v[54:55]
    v_pk_add_f32 v[48:49], v[48:49], v[56:57]
    v_pk_add_f32 v[50:51], v[50:51], v[58:59]
    v_pk_add_f32 v[44:45], v[44:45], v[48:49]
    v_pk_add_f32 v[46:47], v[46:47], v[50:51]
L_cdone_57:
    v_cvt_pk_bf16_f32 v48, v44, v45
    v_cvt_pk_bf16_f32 v49, v46, v47
    v_mov_b32 v50, s71
    v_mov_b32 v51, 0
    s_mul_i32 s58, s67, 163840
    s_add_u32 s58, s58, 134742016
    s_cmp_eq_u32 s72, 0
    s_cbranch_scc1 L_stf_62
    buffer_store_dwordx4 v[48:51], v26, s[8:11], s58 offen sc1
    s_branch L_ste_63
L_stf_62:
    buffer_store_dwordx4 v[48:51], v26, s[8:11], s58 offen
L_ste_63:
    s_mov_b64 exec, -1
L_endb_32:
    s_barrier
    s_mov_b32 s66, s71
    s_cmp_lg_u32 s46, 2
    s_cbranch_scc1 L_step_26
    s_and_b32 s58, s71, 1
    s_mul_i32 s58, s58, 3584
    v_add_u32 v3, s58, v22
    s_waitcnt vmcnt(0)
    ds_write_b128 v3, v[80:83] offset:0
    ds_write_b128 v3, v[84:87] offset:16
    ds_write_b128 v3, v[88:91] offset:32
    s_waitcnt lgkmcnt(0)
    s_branch L_step_26
L_lastl_39:
    s_cmp_lg_u32 s46, 1
    s_cbranch_scc1 L_done_2
    s_waitcnt vmcnt(0)
    s_not_b64 exec, s[52:53]
    ds_read_b128 v[56:59], v13 offset:0
    ds_read_b128 v[60:63], v13 offset:1280
    ds_read_b128 v[64:67], v13 offset:2560
    ds_read_b128 v[68:71], v13 offset:3840
    ds_read_b128 v[72:75], v13 offset:5120
    ds_read_b128 v[76:79], v13 offset:6400
    ds_read_b128 v[80:83], v13 offset:7680
    ds_read_b128 v[84:87], v13 offset:8960
    ds_read_b128 v[88:91], v13 offset:10240
    ds_read_b128 v[92:95], v13 offset:11520
    ds_read_b128 v[96:99], v13 offset:12800
    ds_read_b128 v[100:103], v13 offset:14080
    s_waitcnt lgkmcnt(6)
    v_pk_add_f32 v[56:57], v[56:57], v[68:69]
    v_pk_add_f32 v[58:59], v[58:59], v[70:71]
    v_pk_add_f32 v[60:61], v[60:61], v[72:73]
    v_pk_add_f32 v[62:63], v[62:63], v[74:75]
    v_pk_add_f32 v[64:65], v[64:65], v[76:77]
    v_pk_add_f32 v[66:67], v[66:67], v[78:79]
    s_waitcnt lgkmcnt(0)
    v_pk_add_f32 v[80:81], v[80:81], v[92:93]
    v_pk_add_f32 v[82:83], v[82:83], v[94:95]
    v_pk_add_f32 v[84:85], v[84:85], v[96:97]
    v_pk_add_f32 v[86:87], v[86:87], v[98:99]
    v_pk_add_f32 v[88:89], v[88:89], v[100:101]
    v_pk_add_f32 v[90:91], v[90:91], v[102:103]
    v_pk_add_f32 v[56:57], v[56:57], v[80:81]
    v_pk_add_f32 v[58:59], v[58:59], v[82:83]
    v_pk_add_f32 v[60:61], v[60:61], v[84:85]
    v_pk_add_f32 v[62:63], v[62:63], v[86:87]
    v_pk_add_f32 v[64:65], v[64:65], v[88:89]
    v_pk_add_f32 v[66:67], v[66:67], v[90:91]
    v_cvt_pk_bf16_f32 v36, v56, v57
    v_cvt_pk_bf16_f32 v37, v58, v59
    v_cvt_pk_bf16_f32 v38, v60, v61
    v_cvt_pk_bf16_f32 v39, v62, v63
    v_cvt_pk_bf16_f32 v40, v64, v65
    v_cvt_pk_bf16_f32 v41, v66, v67
    s_mul_i32 s59, s66, 98304
    s_add_u32 s59, s59, 79691776
    buffer_store_dwordx2 v[36:37], v27, s[8:11], s59 offen offset:0
    buffer_store_dwordx2 v[38:39], v27, s[8:11], s59 offen offset:32
    buffer_store_dwordx2 v[40:41], v27, s[8:11], s59 offen offset:64
    s_mov_b64 exec, -1
    ds_read_b64 v[80:81], v15 offset:0
    ds_read_b64 v[82:83], v15 offset:512
    ds_read_b64 v[84:85], v15 offset:1024
    ds_read_b64 v[86:87], v15 offset:1536
    ds_read_b64 v[88:89], v15 offset:2048
    ds_read_b64 v[90:91], v15 offset:2560
    ds_read_b64 v[92:93], v15 offset:3072
    ds_read_b64 v[94:95], v15 offset:3584
    ds_read_b64 v[96:97], v15 offset:4096
    ds_read_b64 v[98:99], v15 offset:4608
    ds_read_b64 v[100:101], v15 offset:5120
    ds_read_b64 v[102:103], v15 offset:5632
    s_waitcnt lgkmcnt(0)
    v_pk_add_f32 v[80:81], v[80:81], v[86:87]
    v_pk_add_f32 v[82:83], v[82:83], v[88:89]
    v_pk_add_f32 v[84:85], v[84:85], v[90:91]
    v_pk_add_f32 v[92:93], v[92:93], v[98:99]
    v_pk_add_f32 v[94:95], v[94:95], v[100:101]
    v_pk_add_f32 v[96:97], v[96:97], v[102:103]
    v_pk_add_f32 v[80:81], v[80:81], v[92:93]
    v_pk_add_f32 v[82:83], v[82:83], v[94:95]
    v_pk_add_f32 v[84:85], v[84:85], v[96:97]
    v_cvt_pk_bf16_f32 v44, v80, v81
    v_cvt_pk_bf16_f32 v45, v82, v83
    v_cvt_pk_bf16_f32 v46, v84, v85
    s_add_u32 s59, s59, 6291456
    s_add_u32 s58, s59, 12288
    buffer_store_short v44, v28, s[8:11], s59 offen offset:0
    buffer_store_short_d16_hi v44, v28, s[8:11], s58 offen offset:0
    buffer_store_short v45, v28, s[8:11], s59 offen offset:32
    buffer_store_short_d16_hi v45, v28, s[8:11], s58 offen offset:32
    buffer_store_short v46, v28, s[8:11], s59 offen offset:64
    buffer_store_short_d16_hi v46, v28, s[8:11], s58 offen offset:64
L_bail_3:
L_done_2:
    s_endpgm
L_worker_9:
    s_mov_b32 s96, s46
    s_sub_u32 s90, s73, 128
    s_lshr_b32 s91, s46, 2
    s_lshl_b32 s29, s91, 16
    s_and_b32 s40, s46, 3
    s_mov_b32 s76, s12
    s_mov_b32 s77, s13
    s_mov_b32 s78, s14
    s_mov_b32 s79, s15
    s_mov_b32 s80, s16
    s_mov_b32 s81, s17
    s_mov_b32 s82, s18
    s_mov_b32 s83, s19
    s_mov_b32 s84, s20
    s_mov_b32 s85, s21
    s_mov_b32 s86, s22
    s_mov_b32 s87, s23
    s_and_b32 s92, s90, 15
    s_lshl_b32 s92, s92, 3
    s_lshr_b32 s93, s90, 4
    s_add_u32 s92, s92, s93
    s_cmp_ge_u32 s92, 96
    s_cbranch_scc1 L_early_64
    s_cmp_ge_u32 s96, 4
    s_cbranch_scc1 L_idleh_65
    s_mov_b32 s31, 0
    s_cmp_ge_u32 s92, 48
    s_cselect_b32 s33, 2, 1
    s_cselect_b32 s94, 48, 0
    s_sub_u32 s34, s92, s94
    s_cmp_eq_u32 s33, 2
    s_cselect_b32 s12, s84, s80
    s_cselect_b32 s13, s85, s81
    s_mov_b32 s14, s78
    s_mov_b32 s15, s79
    s_lshr_b32 s41, s40, 1
    s_and_b32 s42, s40, 1
    v_and_b32 v96, 63, v0
    v_lshrrev_b32 v98, 3, v96
    v_and_b32 v99, 7, v96
    v_xor_b32 v99, v99, v98
    v_lshlrev_b32 v99, 4, v99
    s_mul_i32 s43, s40, 32
    v_add_u32 v98, s43, v98
    s_mov_b32 s44, 1280
    v_mul_lo_u32 v98, v98, s44
    v_add_u32 v1, v98, v99
    v_add_u32 v2, 10240, v1
    v_add_u32 v3, 20480, v1
    v_add_u32 v4, 30720, v1
    v_lshrrev_b32 v98, 4, v96
    v_and_b32 v99, 15, v96
    v_lshrrev_b32 v100, 1, v99
    v_and_b32 v99, 1, v99
    v_or_b32 v101, 0, v98
    v_xor_b32 v101, v100, v101
    v_lshlrev_b32 v101, 5, v101
    v_lshl_add_u32 v101, v99, 4, v101
    s_mul_i32 s43, s40, 16
    s_add_u32 s43, s43, 0
    v_add_u32 v102, s43, v98
    s_mov_b32 s44, 12288
    v_mul_lo_u32 v102, v102, s44
    v_add_u32 v5, v102, v101
    v_or_b32 v101, 0, v98
    v_xor_b32 v101, v100, v101
    v_lshlrev_b32 v101, 5, v101
    v_lshl_add_u32 v101, v99, 4, v101
    s_mul_i32 s43, s40, 16
    s_add_u32 s43, s43, 4
    v_add_u32 v102, s43, v98
    s_mov_b32 s44, 12288
    v_mul_lo_u32 v102, v102, s44
    v_add_u32 v6, v102, v101
    v_or_b32 v101, 4, v98
    v_xor_b32 v101, v100, v101
    v_lshlrev_b32 v101, 5, v101
    v_lshl_add_u32 v101, v99, 4, v101
    s_mul_i32 s43, s40, 16
    s_add_u32 s43, s43, 8
    v_add_u32 v102, s43, v98
    s_mov_b32 s44, 12288
    v_mul_lo_u32 v102, v102, s44
    v_add_u32 v7, v102, v101
    v_or_b32 v101, 4, v98
    v_xor_b32 v101, v100, v101
    v_lshlrev_b32 v101, 5, v101
    v_lshl_add_u32 v101, v99, 4, v101
    s_mul_i32 s43, s40, 16
    s_add_u32 s43, s43, 12
    v_add_u32 v102, s43, v98
    s_mov_b32 s44, 12288
    v_mul_lo_u32 v102, v102, s44
    v_add_u32 v8, v102, v101
    v_and_b32 v98, 15, v96
    v_lshrrev_b32 v99, 4, v96
    v_and_b32 v100, 7, v96
    v_xor_b32 v100, v100, v99
    s_mul_i32 s43, s41, 64
    v_add_u32 v98, s43, v98
    v_lshlrev_b32 v98, 7, v98
    v_add_u32 v98, s29, v98
    v_lshl_add_u32 v9, v100, 4, v98
    v_xor_b32 v100, 4, v100
    v_lshl_add_u32 v10, v100, 4, v98
    v_and_b32 v98, 15, v96
    v_lshrrev_b32 v98, 2, v98
    v_and_b32 v100, 3, v96
    v_lshl_add_u32 v101, v99, 3, v98
    v_mul_u32_u24 v101, 256, v101
    v_lshl_add_u32 v101, v100, 3, v101
    v_add_u32 v101, s29, v101
    v_and_b32 v102, 1, v99
    v_lshl_or_b32 v102, v102, 2, v98
    s_mul_i32 s43, s42, 4
    s_add_u32 s44, s43, 0
    v_xor_b32 v103, s44, v102
    v_lshl_add_u32 v11, v103, 5, v101
    v_add_u32 v11, 16384, v11
    s_add_u32 s44, s43, 1
    v_xor_b32 v103, s44, v102
    v_lshl_add_u32 v12, v103, 5, v101
    v_add_u32 v12, 16384, v12
    s_add_u32 s44, s43, 2
    v_xor_b32 v103, s44, v102
    v_lshl_add_u32 v13, v103, 5, v101
    v_add_u32 v13, 16384, v13
    s_add_u32 s44, s43, 3
    v_xor_b32 v103, s44, v102
    v_lshl_add_u32 v14, v103, 5, v101
    v_add_u32 v14, 16384, v14
    v_add_u32 v15, 65536, v9
    v_add_u32 v16, 65536, v10
    v_add_u32 v17, 65536, v11
    v_add_u32 v18, 65536, v12
    v_add_u32 v19, 65536, v13
    v_add_u32 v20, 65536, v14
    v_add_u32 v21, 131072, v9
    v_add_u32 v22, 131072, v10
    v_add_u32 v23, 131072, v11
    v_add_u32 v24, 131072, v12
    v_add_u32 v25, 131072, v13
    v_add_u32 v26, 131072, v14
    v_accvgpr_write_b32 a0, 0
    v_accvgpr_write_b32 a1, 0
    v_accvgpr_write_b32 a2, 0
    v_accvgpr_write_b32 a3, 0
    v_accvgpr_write_b32 a4, 0
    v_accvgpr_write_b32 a5, 0
    v_accvgpr_write_b32 a6, 0
    v_accvgpr_write_b32 a7, 0
    v_accvgpr_write_b32 a8, 0
    v_accvgpr_write_b32 a9, 0
    v_accvgpr_write_b32 a10, 0
    v_accvgpr_write_b32 a11, 0
    v_accvgpr_write_b32 a12, 0
    v_accvgpr_write_b32 a13, 0
    v_accvgpr_write_b32 a14, 0
    v_accvgpr_write_b32 a15, 0
    v_accvgpr_write_b32 a16, 0
    v_accvgpr_write_b32 a17, 0
    v_accvgpr_write_b32 a18, 0
    v_accvgpr_write_b32 a19, 0
    v_accvgpr_write_b32 a20, 0
    v_accvgpr_write_b32 a21, 0
    v_accvgpr_write_b32 a22, 0
    v_accvgpr_write_b32 a23, 0
    v_accvgpr_write_b32 a24, 0
    v_accvgpr_write_b32 a25, 0
    v_accvgpr_write_b32 a26, 0
    v_accvgpr_write_b32 a27, 0
    v_accvgpr_write_b32 a28, 0
    v_accvgpr_write_b32 a29, 0
    v_accvgpr_write_b32 a30, 0
    v_accvgpr_write_b32 a31, 0
    v_accvgpr_write_b32 a32, 0
    v_accvgpr_write_b32 a33, 0
    v_accvgpr_write_b32 a34, 0
    v_accvgpr_write_b32 a35, 0
    v_accvgpr_write_b32 a36, 0
    v_accvgpr_write_b32 a37, 0
    v_accvgpr_write_b32 a38, 0
    v_accvgpr_write_b32 a39, 0
    v_accvgpr_write_b32 a40, 0
    v_accvgpr_write_b32 a41, 0
    v_accvgpr_write_b32 a42, 0
    v_accvgpr_write_b32 a43, 0
    v_accvgpr_write_b32 a44, 0
    v_accvgpr_write_b32 a45, 0
    v_accvgpr_write_b32 a46, 0
    v_accvgpr_write_b32 a47, 0
    v_accvgpr_write_b32 a48, 0
    v_accvgpr_write_b32 a49, 0
    v_accvgpr_write_b32 a50, 0
    v_accvgpr_write_b32 a51, 0
    v_accvgpr_write_b32 a52, 0
    v_accvgpr_write_b32 a53, 0
    v_accvgpr_write_b32 a54, 0
    v_accvgpr_write_b32 a55, 0
    v_accvgpr_write_b32 a56, 0
    v_accvgpr_write_b32 a57, 0
    v_accvgpr_write_b32 a58, 0
    v_accvgpr_write_b32 a59, 0
    v_accvgpr_write_b32 a60, 0
    v_accvgpr_write_b32 a61, 0
    v_accvgpr_write_b32 a62, 0
    v_accvgpr_write_b32 a63, 0
    s_mul_i32 s45, s31, 163840
    s_add_u32 s45, s45, 0
    s_mul_i32 s46, s34, 256
    s_mul_i32 s47, s40, 4096
    s_add_u32 s47, s47, 0
    s_add_u32 m0, s47, s29
    s_nop 0
    buffer_load_dwordx4 v1, s[8:11], s45 offen lds
    s_mul_i32 s47, s40, 4096
    s_add_u32 s47, s47, 1024
    s_add_u32 m0, s47, s29
    s_nop 0
    buffer_load_dwordx4 v2, s[8:11], s45 offen lds
    s_mul_i32 s47, s40, 4096
    s_add_u32 s47, s47, 2048
    s_add_u32 m0, s47, s29
    s_nop 0
    buffer_load_dwordx4 v3, s[8:11], s45 offen lds
    s_mul_i32 s47, s40, 4096
    s_add_u32 s47, s47, 3072
    s_add_u32 m0, s47, s29
    s_nop 0
    buffer_load_dwordx4 v4, s[8:11], s45 offen lds
    s_mul_i32 s47, s40, 4096
    s_add_u32 s47, s47, 16384
    s_add_u32 m0, s47, s29
    s_nop 0
    buffer_load_dwordx4 v5, s[12:15], s46 offen lds
    s_mul_i32 s47, s40, 4096
    s_add_u32 s47, s47, 17408
    s_add_u32 m0, s47, s29
    s_nop 0
    buffer_load_dwordx4 v6, s[12:15], s46 offen lds
    s_mul_i32 s47, s40, 4096
    s_add_u32 s47, s47, 18432
    s_add_u32 m0, s47, s29
    s_nop 0
    buffer_load_dwordx4 v7, s[12:15], s46 offen lds
    s_mul_i32 s47, s40, 4096
    s_add_u32 s47, s47, 19456
    s_add_u32 m0, s47, s29
    s_nop 0
    buffer_load_dwordx4 v8, s[12:15], s46 offen lds
    s_add_u32 s45, s45, 128
    s_add_u32 s46, s46, 786432
    s_mul_i32 s47, s40, 4096
    s_add_u32 s47, s47, 32768
    s_add_u32 m0, s47, s29
    s_nop 0
    buffer_load_dwordx4 v1, s[8:11], s45 offen lds
    s_mul_i32 s47, s40, 4096
    s_add_u32 s47, s47, 33792
    s_add_u32 m0, s47, s29
    s_nop 0
    buffer_load_dwordx4 v2, s[8:11], s45 offen lds
    s_mul_i32 s47, s40, 4096
    s_add_u32 s47, s47, 34816
    s_add_u32 m0, s47, s29
    s_nop 0
    buffer_load_dwordx4 v3, s[8:11], s45 offen lds
    s_mul_i32 s47, s40, 4096
    s_add_u32 s47, s47, 35840
    s_add_u32 m0, s47, s29
    s_nop 0
    buffer_load_dwordx4 v4, s[8:11], s45 offen lds
    s_mul_i32 s47, s40, 4096
    s_add_u32 s47, s47, 49152
    s_add_u32 m0, s47, s29
    s_nop 0
    buffer_load_dwordx4 v5, s[12:15], s46 offen lds
    s_mul_i32 s47, s40, 4096
    s_add_u32 s47, s47, 50176
    s_add_u32 m0, s47, s29
    s_nop 0
    buffer_load_dwordx4 v6, s[12:15], s46 offen lds
    s_mul_i32 s47, s40, 4096
    s_add_u32 s47, s47, 51200
    s_add_u32 m0, s47, s29
    s_nop 0
    buffer_load_dwordx4 v7, s[12:15], s46 offen lds
    s_mul_i32 s47, s40, 4096
    s_add_u32 s47, s47, 52224
    s_add_u32 m0, s47, s29
    s_nop 0
    buffer_load_dwordx4 v8, s[12:15], s46 offen lds
    s_add_u32 s45, s45, 128
    s_add_u32 s46, s46, 786432
    s_mul_i32 s47, s40, 4096
    s_add_u32 s47, s47, 65536
    s_add_u32 m0, s47, s29
    s_nop 0
    buffer_load_dwordx4 v1, s[8:11], s45 offen lds
    s_mul_i32 s47, s40, 4096
    s_add_u32 s47, s47, 66560
    s_add_u32 m0, s47, s29
    s_nop 0
    buffer_load_dwordx4 v2, s[8:11], s45 offen lds
    s_mul_i32 s47, s40, 4096
    s_add_u32 s47, s47, 67584
    s_add_u32 m0, s47, s29
    s_nop 0
    buffer_load_dwordx4 v3, s[8:11], s45 offen lds
    s_mul_i32 s47, s40, 4096
    s_add_u32 s47, s47, 68608
    s_add_u32 m0, s47, s29
    s_nop 0
    buffer_load_dwordx4 v4, s[8:11], s45 offen lds
    s_mul_i32 s47, s40, 4096
    s_add_u32 s47, s47, 81920
    s_add_u32 m0, s47, s29
    s_nop 0
    buffer_load_dwordx4 v5, s[12:15], s46 offen lds
    s_mul_i32 s47, s40, 4096
    s_add_u32 s47, s47, 82944
    s_add_u32 m0, s47, s29
    s_nop 0
    buffer_load_dwordx4 v6, s[12:15], s46 offen lds
    s_mul_i32 s47, s40, 4096
    s_add_u32 s47, s47, 83968
    s_add_u32 m0, s47, s29
    s_nop 0
    buffer_load_dwordx4 v7, s[12:15], s46 offen lds
    s_mul_i32 s47, s40, 4096
    s_add_u32 s47, s47, 84992
    s_add_u32 m0, s47, s29
    s_nop 0
    buffer_load_dwordx4 v8, s[12:15], s46 offen lds
    s_add_u32 s45, s45, 128
    s_add_u32 s46, s46, 786432
    s_mul_i32 s47, s40, 4096
    s_add_u32 s47, s47, 98304
    s_add_u32 m0, s47, s29
    s_nop 0
    buffer_load_dwordx4 v1, s[8:11], s45 offen lds
    s_mul_i32 s47, s40, 4096
    s_add_u32 s47, s47, 99328
    s_add_u32 m0, s47, s29
    s_nop 0
    buffer_load_dwordx4 v2, s[8:11], s45 offen lds
    s_mul_i32 s47, s40, 4096
    s_add_u32 s47, s47, 100352
    s_add_u32 m0, s47, s29
    s_nop 0
    buffer_load_dwordx4 v3, s[8:11], s45 offen lds
    s_mul_i32 s47, s40, 4096
    s_add_u32 s47, s47, 101376
    s_add_u32 m0, s47, s29
    s_nop 0
    buffer_load_dwordx4 v4, s[8:11], s45 offen lds
    s_mul_i32 s47, s40, 4096
    s_add_u32 s47, s47, 114688
    s_add_u32 m0, s47, s29
    s_nop 0
    buffer_load_dwordx4 v5, s[12:15], s46 offen lds
    s_mul_i32 s47, s40, 4096
    s_add_u32 s47, s47, 115712
    s_add_u32 m0, s47, s29
    s_nop 0
    buffer_load_dwordx4 v6, s[12:15], s46 offen lds
    s_mul_i32 s47, s40, 4096
    s_add_u32 s47, s47, 116736
    s_add_u32 m0, s47, s29
    s_nop 0
    buffer_load_dwordx4 v7, s[12:15], s46 offen lds
    s_mul_i32 s47, s40, 4096
    s_add_u32 s47, s47, 117760
    s_add_u32 m0, s47, s29
    s_nop 0
    buffer_load_dwordx4 v8, s[12:15], s46 offen lds
    s_add_u32 s45, s45, 128
    s_add_u32 s46, s46, 786432
    s_waitcnt vmcnt(24)
    s_barrier
    s_mov_b32 s48, 0
L_gl_67:
    s_mul_i32 s47, s40, 4096
    s_add_u32 s47, s47, 131072
    s_add_u32 m0, s47, s29
    s_nop 0
    buffer_load_dwordx4 v1, s[8:11], s45 offen lds
    s_mul_i32 s47, s40, 4096
    s_add_u32 s47, s47, 132096
    s_add_u32 m0, s47, s29
    s_nop 0
    buffer_load_dwordx4 v2, s[8:11], s45 offen lds
    s_mul_i32 s47, s40, 4096
    s_add_u32 s47, s47, 133120
    s_add_u32 m0, s47, s29
    s_nop 0
    buffer_load_dwordx4 v3, s[8:11], s45 offen lds
    s_mul_i32 s47, s40, 4096
    s_add_u32 s47, s47, 134144
    s_add_u32 m0, s47, s29
    s_nop 0
    buffer_load_dwordx4 v4, s[8:11], s45 offen lds
    s_mul_i32 s47, s40, 4096
    s_add_u32 s47, s47, 147456
    s_add_u32 m0, s47, s29
    s_nop 0
    buffer_load_dwordx4 v5, s[12:15], s46 offen lds
    s_mul_i32 s47, s40, 4096
    s_add_u32 s47, s47, 148480
    s_add_u32 m0, s47, s29
    s_nop 0
    buffer_load_dwordx4 v6, s[12:15], s46 offen lds
    s_mul_i32 s47, s40, 4096
    s_add_u32 s47, s47, 149504
    s_add_u32 m0, s47, s29
    s_nop 0
    buffer_load_dwordx4 v7, s[12:15], s46 offen lds
    s_mul_i32 s47, s40, 4096
    s_add_u32 s47, s47, 150528
    s_add_u32 m0, s47, s29
    s_nop 0
    buffer_load_dwordx4 v8, s[12:15], s46 offen lds
    s_add_u32 s45, s45, 128
    s_add_u32 s46, s46, 786432
    ds_read_b128 v[28:31], v9 offset:0
    ds_read_b128 v[32:35], v9 offset:2048
    ds_read_b128 v[36:39], v9 offset:4096
    ds_read_b128 v[40:43], v9 offset:6144
    ds_read_b64_tr_b16 v[60:61], v11 offset:0
    ds_read_b64_tr_b16 v[62:63], v11 offset:1024
    ds_read_b64_tr_b16 v[64:65], v12 offset:0
    ds_read_b64_tr_b16 v[66:67], v12 offset:1024
    ds_read_b64_tr_b16 v[68:69], v13 offset:0
    ds_read_b64_tr_b16 v[70:71], v13 offset:1024
    ds_read_b64_tr_b16 v[72:73], v14 offset:0
    ds_read_b64_tr_b16 v[74:75], v14 offset:1024
    ds_read_b128 v[44:47], v10 offset:0
    ds_read_b128 v[48:51], v10 offset:2048
    ds_read_b128 v[52:55], v10 offset:4096
    ds_read_b128 v[56:59], v10 offset:6144
    ds_read_b64_tr_b16 v[76:77], v11 offset:8192
    ds_read_b64_tr_b16 v[78:79], v11 offset:9216
    ds_read_b64_tr_b16 v[80:81], v12 offset:8192
    ds_read_b64_tr_b16 v[82:83], v12 offset:9216
    ds_read_b64_tr_b16 v[84:85], v13 offset:8192
    ds_read_b64_tr_b16 v[86:87], v13 offset:9216
    ds_read_b64_tr_b16 v[88:89], v14 offset:8192
    ds_read_b64_tr_b16 v[90:91], v14 offset:9216
    s_waitcnt lgkmcnt(12)
    v_mfma_f32_16x16x32_bf16 a[0:3], v[60:63], v[28:31], a[0:3]
    v_mfma_f32_16x16x32_bf16 a[4:7], v[60:63], v[32:35], a[4:7]
    v_mfma_f32_16x16x32_bf16 a[8:11], v[60:63], v[36:39], a[8:11]
    v_mfma_f32_16x16x32_bf16 a[12:15], v[60:63], v[40:43], a[12:15]
    v_mfma_f32_16x16x32_bf16 a[16:19], v[64:67], v[28:31], a[16:19]
    v_mfma_f32_16x16x32_bf16 a[20:23], v[64:67], v[32:35], a[20:23]
    v_mfma_f32_16x16x32_bf16 a[24:27], v[64:67], v[36:39], a[24:27]
    v_mfma_f32_16x16x32_bf16 a[28:31], v[64:67], v[40:43], a[28:31]
    v_mfma_f32_16x16x32_bf16 a[32:35], v[68:71], v[28:31], a[32:35]
    v_mfma_f32_16x16x32_bf16 a[36:39], v[68:71], v[32:35], a[36:39]
    v_mfma_f32_16x16x32_bf16 a[40:43], v[68:71], v[36:39], a[40:43]
    v_mfma_f32_16x16x32_bf16 a[44:47], v[68:71], v[40:43], a[44:47]
    v_mfma_f32_16x16x32_bf16 a[48:51], v[72:75], v[28:31], a[48:51]
    v_mfma_f32_16x16x32_bf16 a[52:55], v[72:75], v[32:35], a[52:55]
    v_mfma_f32_16x16x32_bf16 a[56:59], v[72:75], v[36:39], a[56:59]
    v_mfma_f32_16x16x32_bf16 a[60:63], v[72:75], v[40:43], a[60:63]
    s_waitcnt lgkmcnt(0)
    v_mfma_f32_16x16x32_bf16 a[0:3], v[76:79], v[44:47], a[0:3]
    v_mfma_f32_16x16x32_bf16 a[4:7], v[76:79], v[48:51], a[4:7]
    v_mfma_f32_16x16x32_bf16 a[8:11], v[76:79], v[52:55], a[8:11]
    v_mfma_f32_16x16x32_bf16 a[12:15], v[76:79], v[56:59], a[12:15]
    v_mfma_f32_16x16x32_bf16 a[16:19], v[80:83], v[44:47], a[16:19]
    v_mfma_f32_16x16x32_bf16 a[20:23], v[80:83], v[48:51], a[20:23]
    v_mfma_f32_16x16x32_bf16 a[24:27], v[80:83], v[52:55], a[24:27]
    v_mfma_f32_16x16x32_bf16 a[28:31], v[80:83], v[56:59], a[28:31]
    v_mfma_f32_16x16x32_bf16 a[32:35], v[84:87], v[44:47], a[32:35]
    v_mfma_f32_16x16x32_bf16 a[36:39], v[84:87], v[48:51], a[36:39]
    v_mfma_f32_16x16x32_bf16 a[40:43], v[84:87], v[52:55], a[40:43]
    v_mfma_f32_16x16x32_bf16 a[44:47], v[84:87], v[56:59], a[44:47]
    v_mfma_f32_16x16x32_bf16 a[48:51], v[88:91], v[44:47], a[48:51]
    v_mfma_f32_16x16x32_bf16 a[52:55], v[88:91], v[48:51], a[52:55]
    v_mfma_f32_16x16x32_bf16 a[56:59], v[88:91], v[52:55], a[56:59]
    v_mfma_f32_16x16x32_bf16 a[60:63], v[88:91], v[56:59], a[60:63]
    s_waitcnt vmcnt(24)
    s_barrier
    s_mul_i32 s47, s40, 4096
    s_add_u32 s47, s47, 0
    s_add_u32 m0, s47, s29
    s_nop 0
    buffer_load_dwordx4 v1, s[8:11], s45 offen lds
    s_mul_i32 s47, s40, 4096
    s_add_u32 s47, s47, 1024
    s_add_u32 m0, s47, s29
    s_nop 0
    buffer_load_dwordx4 v2, s[8:11], s45 offen lds
    s_mul_i32 s47, s40, 4096
    s_add_u32 s47, s47, 2048
    s_add_u32 m0, s47, s29
    s_nop 0
    buffer_load_dwordx4 v3, s[8:11], s45 offen lds
    s_mul_i32 s47, s40, 4096
    s_add_u32 s47, s47, 3072
    s_add_u32 m0, s47, s29
    s_nop 0
    buffer_load_dwordx4 v4, s[8:11], s45 offen lds
    s_mul_i32 s47, s40, 4096
    s_add_u32 s47, s47, 16384
    s_add_u32 m0, s47, s29
    s_nop 0
    buffer_load_dwordx4 v5, s[12:15], s46 offen lds
    s_mul_i32 s47, s40, 4096
    s_add_u32 s47, s47, 17408
    s_add_u32 m0, s47, s29
    s_nop 0
    buffer_load_dwordx4 v6, s[12:15], s46 offen lds
    s_mul_i32 s47, s40, 4096
    s_add_u32 s47, s47, 18432
    s_add_u32 m0, s47, s29
    s_nop 0
    buffer_load_dwordx4 v7, s[12:15], s46 offen lds
    s_mul_i32 s47, s40, 4096
    s_add_u32 s47, s47, 19456
    s_add_u32 m0, s47, s29
    s_nop 0
    buffer_load_dwordx4 v8, s[12:15], s46 offen lds
    s_add_u32 s45, s45, 128
    s_add_u32 s46, s46, 786432
    ds_read_b128 v[28:31], v9 offset:32768
    ds_read_b128 v[32:35], v9 offset:34816
    ds_read_b128 v[36:39], v9 offset:36864
    ds_read_b128 v[40:43], v9 offset:38912
    ds_read_b64_tr_b16 v[60:61], v11 offset:32768
    ds_read_b64_tr_b16 v[62:63], v11 offset:33792
    ds_read_b64_tr_b16 v[64:65], v12 offset:32768
    ds_read_b64_tr_b16 v[66:67], v12 offset:33792
    ds_read_b64_tr_b16 v[68:69], v13 offset:32768
    ds_read_b64_tr_b16 v[70:71], v13 offset:33792
    ds_read_b64_tr_b16 v[72:73], v14 offset:32768
    ds_read_b64_tr_b16 v[74:75], v14 offset:33792
    ds_read_b128 v[44:47], v10 offset:32768
    ds_read_b128 v[48:51], v10 offset:34816
    ds_read_b128 v[52:55], v10 offset:36864
    ds_read_b128 v[56:59], v10 offset:38912
    ds_read_b64_tr_b16 v[76:77], v11 offset:40960
    ds_read_b64_tr_b16 v[78:79], v11 offset:41984
    ds_read_b64_tr_b16 v[80:81], v12 offset:40960
    ds_read_b64_tr_b16 v[82:83], v12 offset:41984
    ds_read_b64_tr_b16 v[84:85], v13 offset:40960
    ds_read_b64_tr_b16 v[86:87], v13 offset:41984
    ds_read_b64_tr_b16 v[88:89], v14 offset:40960
    ds_read_b64_tr_b16 v[90:91], v14 offset:41984
    s_waitcnt lgkmcnt(12)
    v_mfma_f32_16x16x32_bf16 a[0:3], v[60:63], v[28:31], a[0:3]
    v_mfma_f32_16x16x32_bf16 a[4:7], v[60:63], v[32:35], a[4:7]
    v_mfma_f32_16x16x32_bf16 a[8:11], v[60:63], v[36:39], a[8:11]
    v_mfma_f32_16x16x32_bf16 a[12:15], v[60:63], v[40:43], a[12:15]
    v_mfma_f32_16x16x32_bf16 a[16:19], v[64:67], v[28:31], a[16:19]
    v_mfma_f32_16x16x32_bf16 a[20:23], v[64:67], v[32:35], a[20:23]
    v_mfma_f32_16x16x32_bf16 a[24:27], v[64:67], v[36:39], a[24:27]
    v_mfma_f32_16x16x32_bf16 a[28:31], v[64:67], v[40:43], a[28:31]
    v_mfma_f32_16x16x32_bf16 a[32:35], v[68:71], v[28:31], a[32:35]
    v_mfma_f32_16x16x32_bf16 a[36:39], v[68:71], v[32:35], a[36:39]
    v_mfma_f32_16x16x32_bf16 a[40:43], v[68:71], v[36:39], a[40:43]
    v_mfma_f32_16x16x32_bf16 a[44:47], v[68:71], v[40:43], a[44:47]
    v_mfma_f32_16x16x32_bf16 a[48:51], v[72:75], v[28:31], a[48:51]
    v_mfma_f32_16x16x32_bf16 a[52:55], v[72:75], v[32:35], a[52:55]
    v_mfma_f32_16x16x32_bf16 a[56:59], v[72:75], v[36:39], a[56:59]
    v_mfma_f32_16x16x32_bf16 a[60:63], v[72:75], v[40:43], a[60:63]
    s_waitcnt lgkmcnt(0)
    v_mfma_f32_16x16x32_bf16 a[0:3], v[76:79], v[44:47], a[0:3]
    v_mfma_f32_16x16x32_bf16 a[4:7], v[76:79], v[48:51], a[4:7]
    v_mfma_f32_16x16x32_bf16 a[8:11], v[76:79], v[52:55], a[8:11]
    v_mfma_f32_16x16x32_bf16 a[12:15], v[76:79], v[56:59], a[12:15]
    v_mfma_f32_16x16x32_bf16 a[16:19], v[80:83], v[44:47], a[16:19]
    v_mfma_f32_16x16x32_bf16 a[20:23], v[80:83], v[48:51], a[20:23]
    v_mfma_f32_16x16x32_bf16 a[24:27], v[80:83], v[52:55], a[24:27]
    v_mfma_f32_16x16x32_bf16 a[28:31], v[80:83], v[56:59], a[28:31]
    v_mfma_f32_16x16x32_bf16 a[32:35], v[84:87], v[44:47], a[32:35]
    v_mfma_f32_16x16x32_bf16 a[36:39], v[84:87], v[48:51], a[36:39]
    v_mfma_f32_16x16x32_bf16 a[40:43], v[84:87], v[52:55], a[40:43]
    v_mfma_f32_16x16x32_bf16 a[44:47], v[84:87], v[56:59], a[44:47]
    v_mfma_f32_16x16x32_bf16 a[48:51], v[88:91], v[44:47], a[48:51]
    v_mfma_f32_16x16x32_bf16 a[52:55], v[88:91], v[48:51], a[52:55]
    v_mfma_f32_16x16x32_bf16 a[56:59], v[88:91], v[52:55], a[56:59]
    v_mfma_f32_16x16x32_bf16 a[60:63], v[88:91], v[56:59], a[60:63]
    s_waitcnt vmcnt(24)
    s_barrier
    s_mul_i32 s47, s40, 4096
    s_add_u32 s47, s47, 32768
    s_add_u32 m0, s47, s29
    s_nop 0
    buffer_load_dwordx4 v1, s[8:11], s45 offen lds
    s_mul_i32 s47, s40, 4096
    s_add_u32 s47, s47, 33792
    s_add_u32 m0, s47, s29
    s_nop 0
    buffer_load_dwordx4 v2, s[8:11], s45 offen lds
    s_mul_i32 s47, s40, 4096
    s_add_u32 s47, s47, 34816
    s_add_u32 m0, s47, s29
    s_nop 0
    buffer_load_dwordx4 v3, s[8:11], s45 offen lds
    s_mul_i32 s47, s40, 4096
    s_add_u32 s47, s47, 35840
    s_add_u32 m0, s47, s29
    s_nop 0
    buffer_load_dwordx4 v4, s[8:11], s45 offen lds
    s_mul_i32 s47, s40, 4096
    s_add_u32 s47, s47, 49152
    s_add_u32 m0, s47, s29
    s_nop 0
    buffer_load_dwordx4 v5, s[12:15], s46 offen lds
    s_mul_i32 s47, s40, 4096
    s_add_u32 s47, s47, 50176
    s_add_u32 m0, s47, s29
    s_nop 0
    buffer_load_dwordx4 v6, s[12:15], s46 offen lds
    s_mul_i32 s47, s40, 4096
    s_add_u32 s47, s47, 51200
    s_add_u32 m0, s47, s29
    s_nop 0
    buffer_load_dwordx4 v7, s[12:15], s46 offen lds
    s_mul_i32 s47, s40, 4096
    s_add_u32 s47, s47, 52224
    s_add_u32 m0, s47, s29
    s_nop 0
    buffer_load_dwordx4 v8, s[12:15], s46 offen lds
    s_add_u32 s45, s45, 128
    s_add_u32 s46, s46, 786432
    ds_read_b128 v[28:31], v15 offset:0
    ds_read_b128 v[32:35], v15 offset:2048
    ds_read_b128 v[36:39], v15 offset:4096
    ds_read_b128 v[40:43], v15 offset:6144
    ds_read_b64_tr_b16 v[60:61], v17 offset:0
    ds_read_b64_tr_b16 v[62:63], v17 offset:1024
    ds_read_b64_tr_b16 v[64:65], v18 offset:0
    ds_read_b64_tr_b16 v[66:67], v18 offset:1024
    ds_read_b64_tr_b16 v[68:69], v19 offset:0
    ds_read_b64_tr_b16 v[70:71], v19 offset:1024
    ds_read_b64_tr_b16 v[72:73], v20 offset:0
    ds_read_b64_tr_b16 v[74:75], v20 offset:1024
    ds_read_b128 v[44:47], v16 offset:0
    ds_read_b128 v[48:51], v16 offset:2048
    ds_read_b128 v[52:55], v16 offset:4096
    ds_read_b128 v[56:59], v16 offset:6144
    ds_read_b64_tr_b16 v[76:77], v17 offset:8192
    ds_read_b64_tr_b16 v[78:79], v17 offset:9216
    ds_read_b64_tr_b16 v[80:81], v18 offset:8192
    ds_read_b64_tr_b16 v[82:83], v18 offset:9216
    ds_read_b64_tr_b16 v[84:85], v19 offset:8192
    ds_read_b64_tr_b16 v[86:87], v19 offset:9216
    ds_read_b64_tr_b16 v[88:89], v20 offset:8192
    ds_read_b64_tr_b16 v[90:91], v20 offset:9216
    s_waitcnt lgkmcnt(12)
    v_mfma_f32_16x16x32_bf16 a[0:3], v[60:63], v[28:31], a[0:3]
    v_mfma_f32_16x16x32_bf16 a[4:7], v[60:63], v[32:35], a[4:7]
    v_mfma_f32_16x16x32_bf16 a[8:11], v[60:63], v[36:39], a[8:11]
    v_mfma_f32_16x16x32_bf16 a[12:15], v[60:63], v[40:43], a[12:15]
    v_mfma_f32_16x16x32_bf16 a[16:19], v[64:67], v[28:31], a[16:19]
    v_mfma_f32_16x16x32_bf16 a[20:23], v[64:67], v[32:35], a[20:23]
    v_mfma_f32_16x16x32_bf16 a[24:27], v[64:67], v[36:39], a[24:27]
    v_mfma_f32_16x16x32_bf16 a[28:31], v[64:67], v[40:43], a[28:31]
    v_mfma_f32_16x16x32_bf16 a[32:35], v[68:71], v[28:31], a[32:35]
    v_mfma_f32_16x16x32_bf16 a[36:39], v[68:71], v[32:35], a[36:39]
    v_mfma_f32_16x16x32_bf16 a[40:43], v[68:71], v[36:39], a[40:43]
    v_mfma_f32_16x16x32_bf16 a[44:47], v[68:71], v[40:43], a[44:47]
    v_mfma_f32_16x16x32_bf16 a[48:51], v[72:75], v[28:31], a[48:51]
    v_mfma_f32_16x16x32_bf16 a[52:55], v[72:75], v[32:35], a[52:55]
    v_mfma_f32_16x16x32_bf16 a[56:59], v[72:75], v[36:39], a[56:59]
    v_mfma_f32_16x16x32_bf16 a[60:63], v[72:75], v[40:43], a[60:63]
    s_waitcnt lgkmcnt(0)
    v_mfma_f32_16x16x32_bf16 a[0:3], v[76:79], v[44:47], a[0:3]
    v_mfma_f32_16x16x32_bf16 a[4:7], v[76:79], v[48:51], a[4:7]
    v_mfma_f32_16x16x32_bf16 a[8:11], v[76:79], v[52:55], a[8:11]
    v_mfma_f32_16x16x32_bf16 a[12:15], v[76:79], v[56:59], a[12:15]
    v_mfma_f32_16x16x32_bf16 a[16:19], v[80:83], v[44:47], a[16:19]
    v_mfma_f32_16x16x32_bf16 a[20:23], v[80:83], v[48:51], a[20:23]
    v_mfma_f32_16x16x32_bf16 a[24:27], v[80:83], v[52:55], a[24:27]
    v_mfma_f32_16x16x32_bf16 a[28:31], v[80:83], v[56:59], a[28:31]
    v_mfma_f32_16x16x32_bf16 a[32:35], v[84:87], v[44:47], a[32:35]
    v_mfma_f32_16x16x32_bf16 a[36:39], v[84:87], v[48:51], a[36:39]
    v_mfma_f32_16x16x32_bf16 a[40:43], v[84:87], v[52:55], a[40:43]
    v_mfma_f32_16x16x32_bf16 a[44:47], v[84:87], v[56:59], a[44:47]
    v_mfma_f32_16x16x32_bf16 a[48:51], v[88:91], v[44:47], a[48:51]
    v_mfma_f32_16x16x32_bf16 a[52:55], v[88:91], v[48:51], a[52:55]
    v_mfma_f32_16x16x32_bf16 a[56:59], v[88:91], v[52:55], a[56:59]
    v_mfma_f32_16x16x32_bf16 a[60:63], v[88:91], v[56:59], a[60:63]
    s_waitcnt vmcnt(24)
    s_barrier
    s_mul_i32 s47, s40, 4096
    s_add_u32 s47, s47, 65536
    s_add_u32 m0, s47, s29
    s_nop 0
    buffer_load_dwordx4 v1, s[8:11], s45 offen lds
    s_mul_i32 s47, s40, 4096
    s_add_u32 s47, s47, 66560
    s_add_u32 m0, s47, s29
    s_nop 0
    buffer_load_dwordx4 v2, s[8:11], s45 offen lds
    s_mul_i32 s47, s40, 4096
    s_add_u32 s47, s47, 67584
    s_add_u32 m0, s47, s29
    s_nop 0
    buffer_load_dwordx4 v3, s[8:11], s45 offen lds
    s_mul_i32 s47, s40, 4096
    s_add_u32 s47, s47, 68608
    s_add_u32 m0, s47, s29
    s_nop 0
    buffer_load_dwordx4 v4, s[8:11], s45 offen lds
    s_mul_i32 s47, s40, 4096
    s_add_u32 s47, s47, 81920
    s_add_u32 m0, s47, s29
    s_nop 0
    buffer_load_dwordx4 v5, s[12:15], s46 offen lds
    s_mul_i32 s47, s40, 4096
    s_add_u32 s47, s47, 82944
    s_add_u32 m0, s47, s29
    s_nop 0
    buffer_load_dwordx4 v6, s[12:15], s46 offen lds
    s_mul_i32 s47, s40, 4096
    s_add_u32 s47, s47, 83968
    s_add_u32 m0, s47, s29
    s_nop 0
    buffer_load_dwordx4 v7, s[12:15], s46 offen lds
    s_mul_i32 s47, s40, 4096
    s_add_u32 s47, s47, 84992
    s_add_u32 m0, s47, s29
    s_nop 0
    buffer_load_dwordx4 v8, s[12:15], s46 offen lds
    s_add_u32 s45, s45, 128
    s_add_u32 s46, s46, 786432
    ds_read_b128 v[28:31], v15 offset:32768
    ds_read_b128 v[32:35], v15 offset:34816
    ds_read_b128 v[36:39], v15 offset:36864
    ds_read_b128 v[40:43], v15 offset:38912
    ds_read_b64_tr_b16 v[60:61], v17 offset:32768
    ds_read_b64_tr_b16 v[62:63], v17 offset:33792
    ds_read_b64_tr_b16 v[64:65], v18 offset:32768
    ds_read_b64_tr_b16 v[66:67], v18 offset:33792
    ds_read_b64_tr_b16 v[68:69], v19 offset:32768
    ds_read_b64_tr_b16 v[70:71], v19 offset:33792
    ds_read_b64_tr_b16 v[72:73], v20 offset:32768
    ds_read_b64_tr_b16 v[74:75], v20 offset:33792
    ds_read_b128 v[44:47], v16 offset:32768
    ds_read_b128 v[48:51], v16 offset:34816
    ds_read_b128 v[52:55], v16 offset:36864
    ds_read_b128 v[56:59], v16 offset:38912
    ds_read_b64_tr_b16 v[76:77], v17 offset:40960
    ds_read_b64_tr_b16 v[78:79], v17 offset:41984
    ds_read_b64_tr_b16 v[80:81], v18 offset:40960
    ds_read_b64_tr_b16 v[82:83], v18 offset:41984
    ds_read_b64_tr_b16 v[84:85], v19 offset:40960
    ds_read_b64_tr_b16 v[86:87], v19 offset:41984
    ds_read_b64_tr_b16 v[88:89], v20 offset:40960
    ds_read_b64_tr_b16 v[90:91], v20 offset:41984
    s_waitcnt lgkmcnt(12)
    v_mfma_f32_16x16x32_bf16 a[0:3], v[60:63], v[28:31], a[0:3]
    v_mfma_f32_16x16x32_bf16 a[4:7], v[60:63], v[32:35], a[4:7]
    v_mfma_f32_16x16x32_bf16 a[8:11], v[60:63], v[36:39], a[8:11]
    v_mfma_f32_16x16x32_bf16 a[12:15], v[60:63], v[40:43], a[12:15]
    v_mfma_f32_16x16x32_bf16 a[16:19], v[64:67], v[28:31], a[16:19]
    v_mfma_f32_16x16x32_bf16 a[20:23], v[64:67], v[32:35], a[20:23]
    v_mfma_f32_16x16x32_bf16 a[24:27], v[64:67], v[36:39], a[24:27]
    v_mfma_f32_16x16x32_bf16 a[28:31], v[64:67], v[40:43], a[28:31]
    v_mfma_f32_16x16x32_bf16 a[32:35], v[68:71], v[28:31], a[32:35]
    v_mfma_f32_16x16x32_bf16 a[36:39], v[68:71], v[32:35], a[36:39]
    v_mfma_f32_16x16x32_bf16 a[40:43], v[68:71], v[36:39], a[40:43]
    v_mfma_f32_16x16x32_bf16 a[44:47], v[68:71], v[40:43], a[44:47]
    v_mfma_f32_16x16x32_bf16 a[48:51], v[72:75], v[28:31], a[48:51]
    v_mfma_f32_16x16x32_bf16 a[52:55], v[72:75], v[32:35], a[52:55]
    v_mfma_f32_16x16x32_bf16 a[56:59], v[72:75], v[36:39], a[56:59]
    v_mfma_f32_16x16x32_bf16 a[60:63], v[72:75], v[40:43], a[60:63]
    s_waitcnt lgkmcnt(0)
    v_mfma_f32_16x16x32_bf16 a[0:3], v[76:79], v[44:47], a[0:3]
    v_mfma_f32_16x16x32_bf16 a[4:7], v[76:79], v[48:51], a[4:7]
    v_mfma_f32_16x16x32_bf16 a[8:11], v[76:79], v[52:55], a[8:11]
    v_mfma_f32_16x16x32_bf16 a[12:15], v[76:79], v[56:59], a[12:15]
    v_mfma_f32_16x16x32_bf16 a[16:19], v[80:83], v[44:47], a[16:19]
    v_mfma_f32_16x16x32_bf16 a[20:23], v[80:83], v[48:51], a[20:23]
    v_mfma_f32_16x16x32_bf16 a[24:27], v[80:83], v[52:55], a[24:27]
    v_mfma_f32_16x16x32_bf16 a[28:31], v[80:83], v[56:59], a[28:31]
    v_mfma_f32_16x16x32_bf16 a[32:35], v[84:87], v[44:47], a[32:35]
    v_mfma_f32_16x16x32_bf16 a[36:39], v[84:87], v[48:51], a[36:39]
    v_mfma_f32_16x16x32_bf16 a[40:43], v[84:87], v[52:55], a[40:43]
    v_mfma_f32_16x16x32_bf16 a[44:47], v[84:87], v[56:59], a[44:47]
    v_mfma_f32_16x16x32_bf16 a[48:51], v[88:91], v[44:47], a[48:51]
    v_mfma_f32_16x16x32_bf16 a[52:55], v[88:91], v[48:51], a[52:55]
    v_mfma_f32_16x16x32_bf16 a[56:59], v[88:91], v[52:55], a[56:59]
    v_mfma_f32_16x16x32_bf16 a[60:63], v[88:91], v[56:59], a[60:63]
    s_waitcnt vmcnt(24)
    s_barrier
    s_mul_i32 s47, s40, 4096
    s_add_u32 s47, s47, 98304
    s_add_u32 m0, s47, s29
    s_nop 0
    buffer_load_dwordx4 v1, s[8:11], s45 offen lds
    s_mul_i32 s47, s40, 4096
    s_add_u32 s47, s47, 99328
    s_add_u32 m0, s47, s29
    s_nop 0
    buffer_load_dwordx4 v2, s[8:11], s45 offen lds
    s_mul_i32 s47, s40, 4096
    s_add_u32 s47, s47, 100352
    s_add_u32 m0, s47, s29
    s_nop 0
    buffer_load_dwordx4 v3, s[8:11], s45 offen lds
    s_mul_i32 s47, s40, 4096
    s_add_u32 s47, s47, 101376
    s_add_u32 m0, s47, s29
    s_nop 0
    buffer_load_dwordx4 v4, s[8:11], s45 offen lds
    s_mul_i32 s47, s40, 4096
    s_add_u32 s47, s47, 114688
    s_add_u32 m0, s47, s29
    s_nop 0
    buffer_load_dwordx4 v5, s[12:15], s46 offen lds
    s_mul_i32 s47, s40, 4096
    s_add_u32 s47, s47, 115712
    s_add_u32 m0, s47, s29
    s_nop 0
    buffer_load_dwordx4 v6, s[12:15], s46 offen lds
    s_mul_i32 s47, s40, 4096
    s_add_u32 s47, s47, 116736
    s_add_u32 m0, s47, s29
    s_nop 0
    buffer_load_dwordx4 v7, s[12:15], s46 offen lds
    s_mul_i32 s47, s40, 4096
    s_add_u32 s47, s47, 117760
    s_add_u32 m0, s47, s29
    s_nop 0
    buffer_load_dwordx4 v8, s[12:15], s46 offen lds
    s_add_u32 s45, s45, 128
    s_add_u32 s46, s46, 786432
    ds_read_b128 v[28:31], v21 offset:0
    ds_read_b128 v[32:35], v21 offset:2048
    ds_read_b128 v[36:39], v21 offset:4096
    ds_read_b128 v[40:43], v21 offset:6144
    ds_read_b64_tr_b16 v[60:61], v23 offset:0
    ds_read_b64_tr_b16 v[62:63], v23 offset:1024
    ds_read_b64_tr_b16 v[64:65], v24 offset:0
    ds_read_b64_tr_b16 v[66:67], v24 offset:1024
    ds_read_b64_tr_b16 v[68:69], v25 offset:0
    ds_read_b64_tr_b16 v[70:71], v25 offset:1024
    ds_read_b64_tr_b16 v[72:73], v26 offset:0
    ds_read_b64_tr_b16 v[74:75], v26 offset:1024
    ds_read_b128 v[44:47], v22 offset:0
    ds_read_b128 v[48:51], v22 offset:2048
    ds_read_b128 v[52:55], v22 offset:4096
    ds_read_b128 v[56:59], v22 offset:6144
    ds_read_b64_tr_b16 v[76:77], v23 offset:8192
    ds_read_b64_tr_b16 v[78:79], v23 offset:9216
    ds_read_b64_tr_b16 v[80:81], v24 offset:8192
    ds_read_b64_tr_b16 v[82:83], v24 offset:9216
    ds_read_b64_tr_b16 v[84:85], v25 offset:8192
    ds_read_b64_tr_b16 v[86:87], v25 offset:9216
    ds_read_b64_tr_b16 v[88:89], v26 offset:8192
    ds_read_b64_tr_b16 v[90:91], v26 offset:9216
    s_waitcnt lgkmcnt(12)
    v_mfma_f32_16x16x32_bf16 a[0:3], v[60:63], v[28:31], a[0:3]
    v_mfma_f32_16x16x32_bf16 a[4:7], v[60:63], v[32:35], a[4:7]
    v_mfma_f32_16x16x32_bf16 a[8:11], v[60:63], v[36:39], a[8:11]
    v_mfma_f32_16x16x32_bf16 a[12:15], v[60:63], v[40:43], a[12:15]
    v_mfma_f32_16x16x32_bf16 a[16:19], v[64:67], v[28:31], a[16:19]
    v_mfma_f32_16x16x32_bf16 a[20:23], v[64:67], v[32:35], a[20:23]
    v_mfma_f32_16x16x32_bf16 a[24:27], v[64:67], v[36:39], a[24:27]
    v_mfma_f32_16x16x32_bf16 a[28:31], v[64:67], v[40:43], a[28:31]
    v_mfma_f32_16x16x32_bf16 a[32:35], v[68:71], v[28:31], a[32:35]
    v_mfma_f32_16x16x32_bf16 a[36:39], v[68:71], v[32:35], a[36:39]
    v_mfma_f32_16x16x32_bf16 a[40:43], v[68:71], v[36:39], a[40:43]
    v_mfma_f32_16x16x32_bf16 a[44:47], v[68:71], v[40:43], a[44:47]
    v_mfma_f32_16x16x32_bf16 a[48:51], v[72:75], v[28:31], a[48:51]
    v_mfma_f32_16x16x32_bf16 a[52:55], v[72:75], v[32:35], a[52:55]
    v_mfma_f32_16x16x32_bf16 a[56:59], v[72:75], v[36:39], a[56:59]
    v_mfma_f32_16x16x32_bf16 a[60:63], v[72:75], v[40:43], a[60:63]
    s_waitcnt lgkmcnt(0)
    v_mfma_f32_16x16x32_bf16 a[0:3], v[76:79], v[44:47], a[0:3]
    v_mfma_f32_16x16x32_bf16 a[4:7], v[76:79], v[48:51], a[4:7]
    v_mfma_f32_16x16x32_bf16 a[8:11], v[76:79], v[52:55], a[8:11]
    v_mfma_f32_16x16x32_bf16 a[12:15], v[76:79], v[56:59], a[12:15]
    v_mfma_f32_16x16x32_bf16 a[16:19], v[80:83], v[44:47], a[16:19]
    v_mfma_f32_16x16x32_bf16 a[20:23], v[80:83], v[48:51], a[20:23]
    v_mfma_f32_16x16x32_bf16 a[24:27], v[80:83], v[52:55], a[24:27]
    v_mfma_f32_16x16x32_bf16 a[28:31], v[80:83], v[56:59], a[28:31]
    v_mfma_f32_16x16x32_bf16 a[32:35], v[84:87], v[44:47], a[32:35]
    v_mfma_f32_16x16x32_bf16 a[36:39], v[84:87], v[48:51], a[36:39]
    v_mfma_f32_16x16x32_bf16 a[40:43], v[84:87], v[52:55], a[40:43]
    v_mfma_f32_16x16x32_bf16 a[44:47], v[84:87], v[56:59], a[44:47]
    v_mfma_f32_16x16x32_bf16 a[48:51], v[88:91], v[44:47], a[48:51]
    v_mfma_f32_16x16x32_bf16 a[52:55], v[88:91], v[48:51], a[52:55]
    v_mfma_f32_16x16x32_bf16 a[56:59], v[88:91], v[52:55], a[56:59]
    v_mfma_f32_16x16x32_bf16 a[60:63], v[88:91], v[56:59], a[60:63]
    s_waitcnt vmcnt(24)
    s_barrier
    s_add_u32 s48, s48, 5
    s_cmp_lt_u32 s48, 10
    s_cbranch_scc1 L_gl_67
    s_waitcnt vmcnt(0)
    s_barrier
    s_nop 7
    s_nop 7
    v_and_b32 v96, 63, v0
    v_and_b32 v98, 15, v96
    s_mul_i32 s43, s41, 64
    v_add_u32 v98, s43, v98
    s_mov_b32 s44, 12288
    v_mul_lo_u32 v98, v98, s44
    v_lshrrev_b32 v99, 4, v96
    v_lshlrev_b32 v99, 3, v99
    s_mul_i32 s43, s42, 128
    v_add3_u32 v98, v98, v99, s43
    s_mul_i32 s45, s31, 1572864
    s_mul_i32 s46, s34, 256
    s_add_u32 s45, s45, s46
    s_mul_i32 s46, s33, 25165824
    s_add_u32 s45, s45, s46
    s_mov_b32 s49, s45
    s_add_u32 s45, s45, 4194304
    s_mul_i32 s43, s40, 9216
    s_add_u32 s43, s43, s29
    v_and_b32 v98, 15, v96
    v_mul_u32_u24 v98, 144, v98
    v_lshrrev_b32 v99, 4, v96
    v_lshl_add_u32 v98, v99, 3, v98
    v_add_u32 v98, s43, v98
    v_lshrrev_b32 v99, 3, v96
    v_and_b32 v100, 7, v96
    v_mul_u32_u24 v101, 144, v99
    v_lshl_add_u32 v101, v100, 4, v101
    v_add_u32 v101, s43, v101
    s_mul_i32 s43, s41, 64
    v_add_u32 v99, s43, v99
    s_mov_b32 s44, 12288
    v_mul_lo_u32 v99, v99, s44
    v_lshl_add_u32 v99, v100, 4, v99
    s_mul_i32 s43, s42, 128
    v_add_u32 v99, s43, v99
    v_accvgpr_read_b32 v18, a0
    v_accvgpr_read_b32 v19, a1
    v_accvgpr_read_b32 v20, a2
    v_accvgpr_read_b32 v21, a3
    v_cvt_pk_bf16_f32 v16, v18, v19
    v_cvt_pk_bf16_f32 v17, v20, v21
    ds_write_b64 v98, v[16:17] offset:0
    v_accvgpr_read_b32 v26, a16
    v_accvgpr_read_b32 v27, a17
    v_accvgpr_read_b32 v28, a18
    v_accvgpr_read_b32 v29, a19
    v_cvt_pk_bf16_f32 v24, v26, v27
    v_cvt_pk_bf16_f32 v25, v28, v29
    ds_write_b64 v98, v[24:25] offset:32
    v_accvgpr_read_b32 v34, a32
    v_accvgpr_read_b32 v35, a33
    v_accvgpr_read_b32 v36, a34
    v_accvgpr_read_b32 v37, a35
    v_cvt_pk_bf16_f32 v32, v34, v35
    v_cvt_pk_bf16_f32 v33, v36, v37
    ds_write_b64 v98, v[32:33] offset:64
    v_accvgpr_read_b32 v42, a48
    v_accvgpr_read_b32 v43, a49
    v_accvgpr_read_b32 v44, a50
    v_accvgpr_read_b32 v45, a51
    v_cvt_pk_bf16_f32 v40, v42, v43
    v_cvt_pk_bf16_f32 v41, v44, v45
    ds_write_b64 v98, v[40:41] offset:96
    v_accvgpr_read_b32 v18, a4
    v_accvgpr_read_b32 v19, a5
    v_accvgpr_read_b32 v20, a6
    v_accvgpr_read_b32 v21, a7
    v_cvt_pk_bf16_f32 v16, v18, v19
    v_cvt_pk_bf16_f32 v17, v20, v21
    ds_write_b64 v98, v[16:17] offset:2304
    v_accvgpr_read_b32 v26, a20
    v_accvgpr_read_b32 v27, a21
    v_accvgpr_read_b32 v28, a22
    v_accvgpr_read_b32 v29, a23
    v_cvt_pk_bf16_f32 v24, v26, v27
    v_cvt_pk_bf16_f32 v25, v28, v29
    ds_write_b64 v98, v[24:25] offset:2336
    v_accvgpr_read_b32 v34, a36
    v_accvgpr_read_b32 v35, a37
    v_accvgpr_read_b32 v36, a38
    v_accvgpr_read_b32 v37, a39
    v_cvt_pk_bf16_f32 v32, v34, v35
    v_cvt_pk_bf16_f32 v33, v36, v37
    ds_write_b64 v98, v[32:33] offset:2368
    v_accvgpr_read_b32 v42, a52
    v_accvgpr_read_b32 v43, a53
    v_accvgpr_read_b32 v44, a54
    v_accvgpr_read_b32 v45, a55
    v_cvt_pk_bf16_f32 v40, v42, v43
    v_cvt_pk_bf16_f32 v41, v44, v45
    ds_write_b64 v98, v[40:41] offset:2400
    v_accvgpr_read_b32 v18, a8
    v_accvgpr_read_b32 v19, a9
    v_accvgpr_read_b32 v20, a10
    v_accvgpr_read_b32 v21, a11
    v_cvt_pk_bf16_f32 v16, v18, v19
    v_cvt_pk_bf16_f32 v17, v20, v21
    ds_write_b64 v98, v[16:17] offset:4608
    v_accvgpr_read_b32 v26, a24
    v_accvgpr_read_b32 v27, a25
    v_accvgpr_read_b32 v28, a26
    v_accvgpr_read_b32 v29, a27
    v_cvt_pk_bf16_f32 v24, v26, v27
    v_cvt_pk_bf16_f32 v25, v28, v29
    ds_write_b64 v98, v[24:25] offset:4640
    v_accvgpr_read_b32 v34, a40
    v_accvgpr_read_b32 v35, a41
    v_accvgpr_read_b32 v36, a42
    v_accvgpr_read_b32 v37, a43
    v_cvt_pk_bf16_f32 v32, v34, v35
    v_cvt_pk_bf16_f32 v33, v36, v37
    ds_write_b64 v98, v[32:33] offset:4672
    v_accvgpr_read_b32 v42, a56
    v_accvgpr_read_b32 v43, a57
    v_accvgpr_read_b32 v44, a58
    v_accvgpr_read_b32 v45, a59
    v_cvt_pk_bf16_f32 v40, v42, v43
    v_cvt_pk_bf16_f32 v41, v44, v45
    ds_write_b64 v98, v[40:41] offset:4704
    v_accvgpr_read_b32 v18, a12
    v_accvgpr_read_b32 v19, a13
    v_accvgpr_read_b32 v20, a14
    v_accvgpr_read_b32 v21, a15
    v_cvt_pk_bf16_f32 v16, v18, v19
    v_cvt_pk_bf16_f32 v17, v20, v21
    ds_write_b64 v98, v[16:17] offset:6912
    v_accvgpr_read_b32 v26, a28
    v_accvgpr_read_b32 v27, a29
    v_accvgpr_read_b32 v28, a30
    v_accvgpr_read_b32 v29, a31
    v_cvt_pk_bf16_f32 v24, v26, v27
    v_cvt_pk_bf16_f32 v25, v28, v29
    ds_write_b64 v98, v[24:25] offset:6944
    v_accvgpr_read_b32 v34, a44
    v_accvgpr_read_b32 v35, a45
    v_accvgpr_read_b32 v36, a46
    v_accvgpr_read_b32 v37, a47
    v_cvt_pk_bf16_f32 v32, v34, v35
    v_cvt_pk_bf16_f32 v33, v36, v37
    ds_write_b64 v98, v[32:33] offset:6976
    v_accvgpr_read_b32 v42, a60
    v_accvgpr_read_b32 v43, a61
    v_accvgpr_read_b32 v44, a62
    v_accvgpr_read_b32 v45, a63
    v_cvt_pk_bf16_f32 v40, v42, v43
    v_cvt_pk_bf16_f32 v41, v44, v45
    ds_write_b64 v98, v[40:41] offset:7008
    s_waitcnt lgkmcnt(0)
    ds_read_b128 v[16:19], v101 offset:0
    ds_read_b128 v[20:23], v101 offset:1152
    ds_read_b128 v[24:27], v101 offset:2304
    ds_read_b128 v[28:31], v101 offset:3456
    ds_read_b128 v[32:35], v101 offset:4608
    ds_read_b128 v[36:39], v101 offset:5760
    ds_read_b128 v[40:43], v101 offset:6912
    ds_read_b128 v[44:47], v101 offset:8064
    s_waitcnt lgkmcnt(7)
    buffer_store_dwordx4 v[16:19], v99, s[8:11], s45 offen sc1
    s_add_u32 s45, s45, 98304
    s_waitcnt lgkmcnt(6)
    buffer_store_dwordx4 v[20:23], v99, s[8:11], s45 offen sc1
    s_add_u32 s45, s45, 98304
    s_waitcnt lgkmcnt(5)
    buffer_store_dwordx4 v[24:27], v99, s[8:11], s45 offen sc1
    s_add_u32 s45, s45, 98304
    s_waitcnt lgkmcnt(4)
    buffer_store_dwordx4 v[28:31], v99, s[8:11], s45 offen sc1
    s_add_u32 s45, s45, 98304
    s_waitcnt lgkmcnt(3)
    buffer_store_dwordx4 v[32:35], v99, s[8:11], s45 offen sc1
    s_add_u32 s45, s45, 98304
    s_waitcnt lgkmcnt(2)
    buffer_store_dwordx4 v[36:39], v99, s[8:11], s45 offen sc1
    s_add_u32 s45, s45, 98304
    s_waitcnt lgkmcnt(1)
    buffer_store_dwordx4 v[40:43], v99, s[8:11], s45 offen sc1
    s_add_u32 s45, s45, 98304
    s_waitcnt lgkmcnt(0)
    buffer_store_dwordx4 v[44:47], v99, s[8:11], s45 offen sc1
    s_branch L_fdone_66
L_idleh_65:
    s_barrier
    s_barrier
    s_barrier
    s_barrier
    s_barrier
    s_barrier
    s_barrier
    s_barrier
    s_barrier
    s_barrier
    s_barrier
    s_barrier
L_fdone_66:
    s_mov_b32 s95, 135790592
    s_waitcnt vmcnt(0)
    s_barrier
    s_cmp_lg_u32 s96, 0
    s_cbranch_scc1 L_nosig_68
    v_mov_b32 v3, 1
    v_mov_b32 v4, 0
    s_mov_b64 exec, 1
    buffer_atomic_add v3, v4, s[8:11], s95 offen
    s_mov_b64 exec, -1
L_nosig_68:
L_early_64:
    s_add_u32 s92, s92, 32
    s_and_b32 s92, s92, 127
    s_add_u32 s92, s92, 48
L_wq_69:
    s_cmp_ge_u32 s92, 768
    s_cbranch_scc1 L_isq_70
    s_mov_b32 s93, 89478486
    s_mul_hi_u32 s31, s92, s93
    s_mul_i32 s93, s31, 48
    s_sub_u32 s93, s92, s93
    s_lshl_b32 s93, s93, 1
    s_add_u32 s93, s93, s91
    s_cmp_ge_u32 s93, 48
    s_cselect_b32 s33, 2, 1
    s_cselect_b32 s94, 48, 0
    s_sub_u32 s34, s93, s94
    s_lshl_b32 s95, s31, 7
    s_add_u32 s95, s95, 135790592
    s_branch L_dec_71
L_isq_70:
    s_sub_u32 s93, s92, 768
    s_mov_b32 s94, 178956971
    s_mul_hi_u32 s31, s93, s94
    s_mul_i32 s94, s31, 24
    s_sub_u32 s93, s93, s94
    s_lshl_b32 s93, s93, 1
    s_add_u32 s34, s93, s91
    s_mov_b32 s33, 0
    s_lshl_b32 s95, s31, 7
    s_add_u32 s95, s95, 135794688
L_dec_71:
    s_cmp_eq_u32 s33, 0
    s_cselect_b32 s12, s76, s80
    s_cselect_b32 s13, s77, s81
    s_cmp_eq_u32 s33, 2
    s_cselect_b32 s12, s84, s12
    s_cselect_b32 s13, s85, s13
    s_mov_b32 s14, s78
    s_mov_b32 s15, s79
    s_lshr_b32 s41, s40, 1
    s_and_b32 s42, s40, 1
    v_and_b32 v96, 63, v0
    v_lshrrev_b32 v98, 3, v96
    v_and_b32 v99, 7, v96
    v_xor_b32 v99, v99, v98
    v_lshlrev_b32 v99, 4, v99
    s_mul_i32 s43, s40, 32
    v_add_u32 v98, s43, v98
    s_mov_b32 s44, 1280
    v_mul_lo_u32 v98, v98, s44
    v_add_u32 v1, v98, v99
    v_add_u32 v2, 10240, v1
    v_add_u32 v3, 20480, v1
    v_add_u32 v4, 30720, v1
    v_lshrrev_b32 v98, 4, v96
    v_and_b32 v99, 15, v96
    v_lshrrev_b32 v100, 1, v99
    v_and_b32 v99, 1, v99
    v_or_b32 v101, 0, v98
    v_xor_b32 v101, v100, v101
    v_lshlrev_b32 v101, 5, v101
    v_lshl_add_u32 v101, v99, 4, v101
    s_mul_i32 s43, s40, 16
    s_add_u32 s43, s43, 0
    v_add_u32 v102, s43, v98
    s_mov_b32 s44, 12288
    v_mul_lo_u32 v102, v102, s44
    v_add_u32 v5, v102, v101
    v_or_b32 v101, 0, v98
    v_xor_b32 v101, v100, v101
    v_lshlrev_b32 v101, 5, v101
    v_lshl_add_u32 v101, v99, 4, v101
    s_mul_i32 s43, s40, 16
    s_add_u32 s43, s43, 4
    v_add_u32 v102, s43, v98
    s_mov_b32 s44, 12288
    v_mul_lo_u32 v102, v102, s44
    v_add_u32 v6, v102, v101
    v_or_b32 v101, 4, v98
    v_xor_b32 v101, v100, v101
    v_lshlrev_b32 v101, 5, v101
    v_lshl_add_u32 v101, v99, 4, v101
    s_mul_i32 s43, s40, 16
    s_add_u32 s43, s43, 8
    v_add_u32 v102, s43, v98
    s_mov_b32 s44, 12288
    v_mul_lo_u32 v102, v102, s44
    v_add_u32 v7, v102, v101
    v_or_b32 v101, 4, v98
    v_xor_b32 v101, v100, v101
    v_lshlrev_b32 v101, 5, v101
    v_lshl_add_u32 v101, v99, 4, v101
    s_mul_i32 s43, s40, 16
    s_add_u32 s43, s43, 12
    v_add_u32 v102, s43, v98
    s_mov_b32 s44, 12288
    v_mul_lo_u32 v102, v102, s44
    v_add_u32 v8, v102, v101
    v_and_b32 v98, 15, v96
    v_lshrrev_b32 v99, 4, v96
    v_and_b32 v100, 7, v96
    v_xor_b32 v100, v100, v99
    s_mul_i32 s43, s41, 64
    v_add_u32 v98, s43, v98
    v_lshlrev_b32 v98, 7, v98
    v_add_u32 v98, s29, v98
    v_lshl_add_u32 v9, v100, 4, v98
    v_xor_b32 v100, 4, v100
    v_lshl_add_u32 v10, v100, 4, v98
    v_and_b32 v98, 15, v96
    v_lshrrev_b32 v98, 2, v98
    v_and_b32 v100, 3, v96
    v_lshl_add_u32 v101, v99, 3, v98
    v_mul_u32_u24 v101, 256, v101
    v_lshl_add_u32 v101, v100, 3, v101
    v_add_u32 v101, s29, v101
    v_and_b32 v102, 1, v99
    v_lshl_or_b32 v102, v102, 2, v98
    s_mul_i32 s43, s42, 4
    s_add_u32 s44, s43, 0
    v_xor_b32 v103, s44, v102
    v_lshl_add_u32 v11, v103, 5, v101
    v_add_u32 v11, 16384, v11
    s_add_u32 s44, s43, 1
    v_xor_b32 v103, s44, v102
    v_lshl_add_u32 v12, v103, 5, v101
    v_add_u32 v12, 16384, v12
    s_add_u32 s44, s43, 2
    v_xor_b32 v103, s44, v102
    v_lshl_add_u32 v13, v103, 5, v101
    v_add_u32 v13, 16384, v13
    s_add_u32 s44, s43, 3
    v_xor_b32 v103, s44, v102
    v_lshl_add_u32 v14, v103, 5, v101
    v_add_u32 v14, 16384, v14
    v_accvgpr_write_b32 a0, 0
    v_accvgpr_write_b32 a1, 0
    v_accvgpr_write_b32 a2, 0
    v_accvgpr_write_b32 a3, 0
    v_accvgpr_write_b32 a4, 0
    v_accvgpr_write_b32 a5, 0
    v_accvgpr_write_b32 a6, 0
    v_accvgpr_write_b32 a7, 0
    v_accvgpr_write_b32 a8, 0
    v_accvgpr_write_b32 a9, 0
    v_accvgpr_write_b32 a10, 0
    v_accvgpr_write_b32 a11, 0
    v_accvgpr_write_b32 a12, 0
    v_accvgpr_write_b32 a13, 0
    v_accvgpr_write_b32 a14, 0
    v_accvgpr_write_b32 a15, 0
    v_accvgpr_write_b32 a16, 0
    v_accvgpr_write_b32 a17, 0
    v_accvgpr_write_b32 a18, 0
    v_accvgpr_write_b32 a19, 0
    v_accvgpr_write_b32 a20, 0
    v_accvgpr_write_b32 a21, 0
    v_accvgpr_write_b32 a22, 0
    v_accvgpr_write_b32 a23, 0
    v_accvgpr_write_b32 a24, 0
    v_accvgpr_write_b32 a25, 0
    v_accvgpr_write_b32 a26, 0
    v_accvgpr_write_b32 a27, 0
    v_accvgpr_write_b32 a28, 0
    v_accvgpr_write_b32 a29, 0
    v_accvgpr_write_b32 a30, 0
    v_accvgpr_write_b32 a31, 0
    v_accvgpr_write_b32 a32, 0
    v_accvgpr_write_b32 a33, 0
    v_accvgpr_write_b32 a34, 0
    v_accvgpr_write_b32 a35, 0
    v_accvgpr_write_b32 a36, 0
    v_accvgpr_write_b32 a37, 0
    v_accvgpr_write_b32 a38, 0
    v_accvgpr_write_b32 a39, 0
    v_accvgpr_write_b32 a40, 0
    v_accvgpr_write_b32 a41, 0
    v_accvgpr_write_b32 a42, 0
    v_accvgpr_write_b32 a43, 0
    v_accvgpr_write_b32 a44, 0
    v_accvgpr_write_b32 a45, 0
    v_accvgpr_write_b32 a46, 0
    v_accvgpr_write_b32 a47, 0
    v_accvgpr_write_b32 a48, 0
    v_accvgpr_write_b32 a49, 0
    v_accvgpr_write_b32 a50, 0
    v_accvgpr_write_b32 a51, 0
    v_accvgpr_write_b32 a52, 0
    v_accvgpr_write_b32 a53, 0
    v_accvgpr_write_b32 a54, 0
    v_accvgpr_write_b32 a55, 0
    v_accvgpr_write_b32 a56, 0
    v_accvgpr_write_b32 a57, 0
    v_accvgpr_write_b32 a58, 0
    v_accvgpr_write_b32 a59, 0
    v_accvgpr_write_b32 a60, 0
    v_accvgpr_write_b32 a61, 0
    v_accvgpr_write_b32 a62, 0
    v_accvgpr_write_b32 a63, 0
    s_mul_i32 s45, s31, 163840
    s_add_u32 s45, s45, 0
    s_mul_i32 s46, s34, 256
    s_mul_i32 s47, s40, 4096
    s_add_u32 s47, s47, 0
    s_add_u32 m0, s47, s29
    s_nop 0
    buffer_load_dwordx4 v1, s[8:11], s45 offen lds
    s_mul_i32 s47, s40, 4096
    s_add_u32 s47, s47, 1024
    s_add_u32 m0, s47, s29
    s_nop 0
    buffer_load_dwordx4 v2, s[8:11], s45 offen lds
    s_mul_i32 s47, s40, 4096
    s_add_u32 s47, s47, 2048
    s_add_u32 m0, s47, s29
    s_nop 0
    buffer_load_dwordx4 v3, s[8:11], s45 offen lds
    s_mul_i32 s47, s40, 4096
    s_add_u32 s47, s47, 3072
    s_add_u32 m0, s47, s29
    s_nop 0
    buffer_load_dwordx4 v4, s[8:11], s45 offen lds
    s_mul_i32 s47, s40, 4096
    s_add_u32 s47, s47, 16384
    s_add_u32 m0, s47, s29
    s_nop 0
    buffer_load_dwordx4 v5, s[12:15], s46 offen lds
    s_mul_i32 s47, s40, 4096
    s_add_u32 s47, s47, 17408
    s_add_u32 m0, s47, s29
    s_nop 0
    buffer_load_dwordx4 v6, s[12:15], s46 offen lds
    s_mul_i32 s47, s40, 4096
    s_add_u32 s47, s47, 18432
    s_add_u32 m0, s47, s29
    s_nop 0
    buffer_load_dwordx4 v7, s[12:15], s46 offen lds
    s_mul_i32 s47, s40, 4096
    s_add_u32 s47, s47, 19456
    s_add_u32 m0, s47, s29
    s_nop 0
    buffer_load_dwordx4 v8, s[12:15], s46 offen lds
    s_add_u32 s45, s45, 128
    s_add_u32 s46, s46, 786432
    s_waitcnt vmcnt(0)
    s_barrier
    s_mov_b32 s48, 0
L_gl_72:
    s_mul_i32 s47, s40, 4096
    s_add_u32 s47, s47, 32768
    s_add_u32 m0, s47, s29
    s_nop 0
    buffer_load_dwordx4 v1, s[8:11], s45 offen lds
    s_mul_i32 s47, s40, 4096
    s_add_u32 s47, s47, 33792
    s_add_u32 m0, s47, s29
    s_nop 0
    buffer_load_dwordx4 v2, s[8:11], s45 offen lds
    s_mul_i32 s47, s40, 4096
    s_add_u32 s47, s47, 34816
    s_add_u32 m0, s47, s29
    s_nop 0
    buffer_load_dwordx4 v3, s[8:11], s45 offen lds
    s_mul_i32 s47, s40, 4096
    s_add_u32 s47, s47, 35840
    s_add_u32 m0, s47, s29
    s_nop 0
    buffer_load_dwordx4 v4, s[8:11], s45 offen lds
    s_mul_i32 s47, s40, 4096
    s_add_u32 s47, s47, 49152
    s_add_u32 m0, s47, s29
    s_nop 0
    buffer_load_dwordx4 v5, s[12:15], s46 offen lds
    s_mul_i32 s47, s40, 4096
    s_add_u32 s47, s47, 50176
    s_add_u32 m0, s47, s29
    s_nop 0
    buffer_load_dwordx4 v6, s[12:15], s46 offen lds
    s_mul_i32 s47, s40, 4096
    s_add_u32 s47, s47, 51200
    s_add_u32 m0, s47, s29
    s_nop 0
    buffer_load_dwordx4 v7, s[12:15], s46 offen lds
    s_mul_i32 s47, s40, 4096
    s_add_u32 s47, s47, 52224
    s_add_u32 m0, s47, s29
    s_nop 0
    buffer_load_dwordx4 v8, s[12:15], s46 offen lds
    s_add_u32 s45, s45, 128
    s_add_u32 s46, s46, 786432
    ds_read_b128 v[16:19], v9 offset:0
    ds_read_b128 v[20:23], v9 offset:2048
    ds_read_b128 v[24:27], v9 offset:4096
    ds_read_b128 v[28:31], v9 offset:6144
    ds_read_b64_tr_b16 v[48:49], v11 offset:0
    ds_read_b64_tr_b16 v[50:51], v11 offset:1024
    ds_read_b64_tr_b16 v[52:53], v12 offset:0
    ds_read_b64_tr_b16 v[54:55], v12 offset:1024
    ds_read_b64_tr_b16 v[56:57], v13 offset:0
    ds_read_b64_tr_b16 v[58:59], v13 offset:1024
    ds_read_b64_tr_b16 v[60:61], v14 offset:0
    ds_read_b64_tr_b16 v[62:63], v14 offset:1024
    ds_read_b128 v[32:35], v10 offset:0
    ds_read_b128 v[36:39], v10 offset:2048
    ds_read_b128 v[40:43], v10 offset:4096
    ds_read_b128 v[44:47], v10 offset:6144
    ds_read_b64_tr_b16 v[64:65], v11 offset:8192
    ds_read_b64_tr_b16 v[66:67], v11 offset:9216
    ds_read_b64_tr_b16 v[68:69], v12 offset:8192
    ds_read_b64_tr_b16 v[70:71], v12 offset:9216
    ds_read_b64_tr_b16 v[72:73], v13 offset:8192
    ds_read_b64_tr_b16 v[74:75], v13 offset:9216
    ds_read_b64_tr_b16 v[76:77], v14 offset:8192
    ds_read_b64_tr_b16 v[78:79], v14 offset:9216
    s_waitcnt lgkmcnt(12)
    v_mfma_f32_16x16x32_bf16 a[0:3], v[48:51], v[16:19], a[0:3]
    v_mfma_f32_16x16x32_bf16 a[4:7], v[48:51], v[20:23], a[4:7]
    v_mfma_f32_16x16x32_bf16 a[8:11], v[48:51], v[24:27], a[8:11]
    v_mfma_f32_16x16x32_bf16 a[12:15], v[48:51], v[28:31], a[12:15]
    v_mfma_f32_16x16x32_bf16 a[16:19], v[52:55], v[16:19], a[16:19]
    v_mfma_f32_16x16x32_bf16 a[20:23], v[52:55], v[20:23], a[20:23]
    v_mfma_f32_16x16x32_bf16 a[24:27], v[52:55], v[24:27], a[24:27]
    v_mfma_f32_16x16x32_bf16 a[28:31], v[52:55], v[28:31], a[28:31]
    v_mfma_f32_16x16x32_bf16 a[32:35], v[56:59], v[16:19], a[32:35]
    v_mfma_f32_16x16x32_bf16 a[36:39], v[56:59], v[20:23], a[36:39]
    v_mfma_f32_16x16x32_bf16 a[40:43], v[56:59], v[24:27], a[40:43]
    v_mfma_f32_16x16x32_bf16 a[44:47], v[56:59], v[28:31], a[44:47]
    v_mfma_f32_16x16x32_bf16 a[48:51], v[60:63], v[16:19], a[48:51]
    v_mfma_f32_16x16x32_bf16 a[52:55], v[60:63], v[20:23], a[52:55]
    v_mfma_f32_16x16x32_bf16 a[56:59], v[60:63], v[24:27], a[56:59]
    v_mfma_f32_16x16x32_bf16 a[60:63], v[60:63], v[28:31], a[60:63]
    s_waitcnt lgkmcnt(0)
    v_mfma_f32_16x16x32_bf16 a[0:3], v[64:67], v[32:35], a[0:3]
    v_mfma_f32_16x16x32_bf16 a[4:7], v[64:67], v[36:39], a[4:7]
    v_mfma_f32_16x16x32_bf16 a[8:11], v[64:67], v[40:43], a[8:11]
    v_mfma_f32_16x16x32_bf16 a[12:15], v[64:67], v[44:47], a[12:15]
    v_mfma_f32_16x16x32_bf16 a[16:19], v[68:71], v[32:35], a[16:19]
    v_mfma_f32_16x16x32_bf16 a[20:23], v[68:71], v[36:39], a[20:23]
    v_mfma_f32_16x16x32_bf16 a[24:27], v[68:71], v[40:43], a[24:27]
    v_mfma_f32_16x16x32_bf16 a[28:31], v[68:71], v[44:47], a[28:31]
    v_mfma_f32_16x16x32_bf16 a[32:35], v[72:75], v[32:35], a[32:35]
    v_mfma_f32_16x16x32_bf16 a[36:39], v[72:75], v[36:39], a[36:39]
    v_mfma_f32_16x16x32_bf16 a[40:43], v[72:75], v[40:43], a[40:43]
    v_mfma_f32_16x16x32_bf16 a[44:47], v[72:75], v[44:47], a[44:47]
    v_mfma_f32_16x16x32_bf16 a[48:51], v[76:79], v[32:35], a[48:51]
    v_mfma_f32_16x16x32_bf16 a[52:55], v[76:79], v[36:39], a[52:55]
    v_mfma_f32_16x16x32_bf16 a[56:59], v[76:79], v[40:43], a[56:59]
    v_mfma_f32_16x16x32_bf16 a[60:63], v[76:79], v[44:47], a[60:63]
    s_waitcnt vmcnt(0)
    s_barrier
    s_cmp_ge_u32 s48, 8
    s_cbranch_scc1 L_gs_73
    s_mul_i32 s47, s40, 4096
    s_add_u32 s47, s47, 0
    s_add_u32 m0, s47, s29
    s_nop 0
    buffer_load_dwordx4 v1, s[8:11], s45 offen lds
    s_mul_i32 s47, s40, 4096
    s_add_u32 s47, s47, 1024
    s_add_u32 m0, s47, s29
    s_nop 0
    buffer_load_dwordx4 v2, s[8:11], s45 offen lds
    s_mul_i32 s47, s40, 4096
    s_add_u32 s47, s47, 2048
    s_add_u32 m0, s47, s29
    s_nop 0
    buffer_load_dwordx4 v3, s[8:11], s45 offen lds
    s_mul_i32 s47, s40, 4096
    s_add_u32 s47, s47, 3072
    s_add_u32 m0, s47, s29
    s_nop 0
    buffer_load_dwordx4 v4, s[8:11], s45 offen lds
    s_mul_i32 s47, s40, 4096
    s_add_u32 s47, s47, 16384
    s_add_u32 m0, s47, s29
    s_nop 0
    buffer_load_dwordx4 v5, s[12:15], s46 offen lds
    s_mul_i32 s47, s40, 4096
    s_add_u32 s47, s47, 17408
    s_add_u32 m0, s47, s29
    s_nop 0
    buffer_load_dwordx4 v6, s[12:15], s46 offen lds
    s_mul_i32 s47, s40, 4096
    s_add_u32 s47, s47, 18432
    s_add_u32 m0, s47, s29
    s_nop 0
    buffer_load_dwordx4 v7, s[12:15], s46 offen lds
    s_mul_i32 s47, s40, 4096
    s_add_u32 s47, s47, 19456
    s_add_u32 m0, s47, s29
    s_nop 0
    buffer_load_dwordx4 v8, s[12:15], s46 offen lds
    s_add_u32 s45, s45, 128
    s_add_u32 s46, s46, 786432
L_gs_73:
    ds_read_b128 v[16:19], v9 offset:32768
    ds_read_b128 v[20:23], v9 offset:34816
    ds_read_b128 v[24:27], v9 offset:36864
    ds_read_b128 v[28:31], v9 offset:38912
    ds_read_b64_tr_b16 v[48:49], v11 offset:32768
    ds_read_b64_tr_b16 v[50:51], v11 offset:33792
    ds_read_b64_tr_b16 v[52:53], v12 offset:32768
    ds_read_b64_tr_b16 v[54:55], v12 offset:33792
    ds_read_b64_tr_b16 v[56:57], v13 offset:32768
    ds_read_b64_tr_b16 v[58:59], v13 offset:33792
    ds_read_b64_tr_b16 v[60:61], v14 offset:32768
    ds_read_b64_tr_b16 v[62:63], v14 offset:33792
    ds_read_b128 v[32:35], v10 offset:32768
    ds_read_b128 v[36:39], v10 offset:34816
    ds_read_b128 v[40:43], v10 offset:36864
    ds_read_b128 v[44:47], v10 offset:38912
    ds_read_b64_tr_b16 v[64:65], v11 offset:40960
    ds_read_b64_tr_b16 v[66:67], v11 offset:41984
    ds_read_b64_tr_b16 v[68:69], v12 offset:40960
    ds_read_b64_tr_b16 v[70:71], v12 offset:41984
    ds_read_b64_tr_b16 v[72:73], v13 offset:40960
    ds_read_b64_tr_b16 v[74:75], v13 offset:41984
    ds_read_b64_tr_b16 v[76:77], v14 offset:40960
    ds_read_b64_tr_b16 v[78:79], v14 offset:41984
    s_waitcnt lgkmcnt(12)
    v_mfma_f32_16x16x32_bf16 a[0:3], v[48:51], v[16:19], a[0:3]
    v_mfma_f32_16x16x32_bf16 a[4:7], v[48:51], v[20:23], a[4:7]
    v_mfma_f32_16x16x32_bf16 a[8:11], v[48:51], v[24:27], a[8:11]
    v_mfma_f32_16x16x32_bf16 a[12:15], v[48:51], v[28:31], a[12:15]
    v_mfma_f32_16x16x32_bf16 a[16:19], v[52:55], v[16:19], a[16:19]
    v_mfma_f32_16x16x32_bf16 a[20:23], v[52:55], v[20:23], a[20:23]
    v_mfma_f32_16x16x32_bf16 a[24:27], v[52:55], v[24:27], a[24:27]
    v_mfma_f32_16x16x32_bf16 a[28:31], v[52:55], v[28:31], a[28:31]
    v_mfma_f32_16x16x32_bf16 a[32:35], v[56:59], v[16:19], a[32:35]
    v_mfma_f32_16x16x32_bf16 a[36:39], v[56:59], v[20:23], a[36:39]
    v_mfma_f32_16x16x32_bf16 a[40:43], v[56:59], v[24:27], a[40:43]
    v_mfma_f32_16x16x32_bf16 a[44:47], v[56:59], v[28:31], a[44:47]
    v_mfma_f32_16x16x32_bf16 a[48:51], v[60:63], v[16:19], a[48:51]
    v_mfma_f32_16x16x32_bf16 a[52:55], v[60:63], v[20:23], a[52:55]
    v_mfma_f32_16x16x32_bf16 a[56:59], v[60:63], v[24:27], a[56:59]
    v_mfma_f32_16x16x32_bf16 a[60:63], v[60:63], v[28:31], a[60:63]
    s_waitcnt lgkmcnt(0)
    v_mfma_f32_16x16x32_bf16 a[0:3], v[64:67], v[32:35], a[0:3]
    v_mfma_f32_16x16x32_bf16 a[4:7], v[64:67], v[36:39], a[4:7]
    v_mfma_f32_16x16x32_bf16 a[8:11], v[64:67], v[40:43], a[8:11]
    v_mfma_f32_16x16x32_bf16 a[12:15], v[64:67], v[44:47], a[12:15]
    v_mfma_f32_16x16x32_bf16 a[16:19], v[68:71], v[32:35], a[16:19]
    v_mfma_f32_16x16x32_bf16 a[20:23], v[68:71], v[36:39], a[20:23]
    v_mfma_f32_16x16x32_bf16 a[24:27], v[68:71], v[40:43], a[24:27]
    v_mfma_f32_16x16x32_bf16 a[28:31], v[68:71], v[44:47], a[28:31]
    v_mfma_f32_16x16x32_bf16 a[32:35], v[72:75], v[32:35], a[32:35]
    v_mfma_f32_16x16x32_bf16 a[36:39], v[72:75], v[36:39], a[36:39]
    v_mfma_f32_16x16x32_bf16 a[40:43], v[72:75], v[40:43], a[40:43]
    v_mfma_f32_16x16x32_bf16 a[44:47], v[72:75], v[44:47], a[44:47]
    v_mfma_f32_16x16x32_bf16 a[48:51], v[76:79], v[32:35], a[48:51]
    v_mfma_f32_16x16x32_bf16 a[52:55], v[76:79], v[36:39], a[52:55]
    v_mfma_f32_16x16x32_bf16 a[56:59], v[76:79], v[40:43], a[56:59]
    v_mfma_f32_16x16x32_bf16 a[60:63], v[76:79], v[44:47], a[60:63]
    s_waitcnt vmcnt(0)
    s_barrier
    s_add_u32 s48, s48, 2
    s_cmp_lt_u32 s48, 10
    s_cbranch_scc1 L_gl_72
    s_nop 7
    s_nop 7
    v_and_b32 v96, 63, v0
    v_and_b32 v98, 15, v96
    s_mul_i32 s43, s41, 64
    v_add_u32 v98, s43, v98
    s_mov_b32 s44, 12288
    v_mul_lo_u32 v98, v98, s44
    v_lshrrev_b32 v99, 4, v96
    v_lshlrev_b32 v99, 3, v99
    s_mul_i32 s43, s42, 128
    v_add3_u32 v98, v98, v99, s43
    s_mul_i32 s45, s31, 1572864
    s_mul_i32 s46, s34, 256
    s_add_u32 s45, s45, s46
    s_mul_i32 s46, s33, 25165824
    s_add_u32 s45, s45, s46
    s_mov_b32 s49, s45
    s_add_u32 s45, s45, 4194304
    s_mul_i32 s43, s40, 9216
    s_add_u32 s43, s43, s29
    v_and_b32 v98, 15, v96
    v_mul_u32_u24 v98, 144, v98
    v_lshrrev_b32 v99, 4, v96
    v_lshl_add_u32 v98, v99, 3, v98
    v_add_u32 v98, s43, v98
    v_lshrrev_b32 v99, 3, v96
    v_and_b32 v100, 7, v96
    v_mul_u32_u24 v101, 144, v99
    v_lshl_add_u32 v101, v100, 4, v101
    v_add_u32 v101, s43, v101
    s_mul_i32 s43, s41, 64
    v_add_u32 v99, s43, v99
    s_mov_b32 s44, 12288
    v_mul_lo_u32 v99, v99, s44
    v_lshl_add_u32 v99, v100, 4, v99
    s_mul_i32 s43, s42, 128
    v_add_u32 v99, s43, v99
    v_accvgpr_read_b32 v18, a0
    v_accvgpr_read_b32 v19, a1
    v_accvgpr_read_b32 v20, a2
    v_accvgpr_read_b32 v21, a3
    v_cvt_pk_bf16_f32 v16, v18, v19
    v_cvt_pk_bf16_f32 v17, v20, v21
    ds_write_b64 v98, v[16:17] offset:0
    v_accvgpr_read_b32 v26, a16
    v_accvgpr_read_b32 v27, a17
    v_accvgpr_read_b32 v28, a18
    v_accvgpr_read_b32 v29, a19
    v_cvt_pk_bf16_f32 v24, v26, v27
    v_cvt_pk_bf16_f32 v25, v28, v29
    ds_write_b64 v98, v[24:25] offset:32
    v_accvgpr_read_b32 v34, a32
    v_accvgpr_read_b32 v35, a33
    v_accvgpr_read_b32 v36, a34
    v_accvgpr_read_b32 v37, a35
    v_cvt_pk_bf16_f32 v32, v34, v35
    v_cvt_pk_bf16_f32 v33, v36, v37
    ds_write_b64 v98, v[32:33] offset:64
    v_accvgpr_read_b32 v42, a48
    v_accvgpr_read_b32 v43, a49
    v_accvgpr_read_b32 v44, a50
    v_accvgpr_read_b32 v45, a51
    v_cvt_pk_bf16_f32 v40, v42, v43
    v_cvt_pk_bf16_f32 v41, v44, v45
    ds_write_b64 v98, v[40:41] offset:96
    v_accvgpr_read_b32 v18, a4
    v_accvgpr_read_b32 v19, a5
    v_accvgpr_read_b32 v20, a6
    v_accvgpr_read_b32 v21, a7
    v_cvt_pk_bf16_f32 v16, v18, v19
    v_cvt_pk_bf16_f32 v17, v20, v21
    ds_write_b64 v98, v[16:17] offset:2304
    v_accvgpr_read_b32 v26, a20
    v_accvgpr_read_b32 v27, a21
    v_accvgpr_read_b32 v28, a22
    v_accvgpr_read_b32 v29, a23
    v_cvt_pk_bf16_f32 v24, v26, v27
    v_cvt_pk_bf16_f32 v25, v28, v29
    ds_write_b64 v98, v[24:25] offset:2336
    v_accvgpr_read_b32 v34, a36
    v_accvgpr_read_b32 v35, a37
    v_accvgpr_read_b32 v36, a38
    v_accvgpr_read_b32 v37, a39
    v_cvt_pk_bf16_f32 v32, v34, v35
    v_cvt_pk_bf16_f32 v33, v36, v37
    ds_write_b64 v98, v[32:33] offset:2368
    v_accvgpr_read_b32 v42, a52
    v_accvgpr_read_b32 v43, a53
    v_accvgpr_read_b32 v44, a54
    v_accvgpr_read_b32 v45, a55
    v_cvt_pk_bf16_f32 v40, v42, v43
    v_cvt_pk_bf16_f32 v41, v44, v45
    ds_write_b64 v98, v[40:41] offset:2400
    v_accvgpr_read_b32 v18, a8
    v_accvgpr_read_b32 v19, a9
    v_accvgpr_read_b32 v20, a10
    v_accvgpr_read_b32 v21, a11
    v_cvt_pk_bf16_f32 v16, v18, v19
    v_cvt_pk_bf16_f32 v17, v20, v21
    ds_write_b64 v98, v[16:17] offset:4608
    v_accvgpr_read_b32 v26, a24
    v_accvgpr_read_b32 v27, a25
    v_accvgpr_read_b32 v28, a26
    v_accvgpr_read_b32 v29, a27
    v_cvt_pk_bf16_f32 v24, v26, v27
    v_cvt_pk_bf16_f32 v25, v28, v29
    ds_write_b64 v98, v[24:25] offset:4640
    v_accvgpr_read_b32 v34, a40
    v_accvgpr_read_b32 v35, a41
    v_accvgpr_read_b32 v36, a42
    v_accvgpr_read_b32 v37, a43
    v_cvt_pk_bf16_f32 v32, v34, v35
    v_cvt_pk_bf16_f32 v33, v36, v37
    ds_write_b64 v98, v[32:33] offset:4672
    v_accvgpr_read_b32 v42, a56
    v_accvgpr_read_b32 v43, a57
    v_accvgpr_read_b32 v44, a58
    v_accvgpr_read_b32 v45, a59
    v_cvt_pk_bf16_f32 v40, v42, v43
    v_cvt_pk_bf16_f32 v41, v44, v45
    ds_write_b64 v98, v[40:41] offset:4704
    v_accvgpr_read_b32 v18, a12
    v_accvgpr_read_b32 v19, a13
    v_accvgpr_read_b32 v20, a14
    v_accvgpr_read_b32 v21, a15
    v_cvt_pk_bf16_f32 v16, v18, v19
    v_cvt_pk_bf16_f32 v17, v20, v21
    ds_write_b64 v98, v[16:17] offset:6912
    v_accvgpr_read_b32 v26, a28
    v_accvgpr_read_b32 v27, a29
    v_accvgpr_read_b32 v28, a30
    v_accvgpr_read_b32 v29, a31
    v_cvt_pk_bf16_f32 v24, v26, v27
    v_cvt_pk_bf16_f32 v25, v28, v29
    ds_write_b64 v98, v[24:25] offset:6944
    v_accvgpr_read_b32 v34, a44
    v_accvgpr_read_b32 v35, a45
    v_accvgpr_read_b32 v36, a46
    v_accvgpr_read_b32 v37, a47
    v_cvt_pk_bf16_f32 v32, v34, v35
    v_cvt_pk_bf16_f32 v33, v36, v37
    ds_write_b64 v98, v[32:33] offset:6976
    v_accvgpr_read_b32 v42, a60
    v_accvgpr_read_b32 v43, a61
    v_accvgpr_read_b32 v44, a62
    v_accvgpr_read_b32 v45, a63
    v_cvt_pk_bf16_f32 v40, v42, v43
    v_cvt_pk_bf16_f32 v41, v44, v45
    ds_write_b64 v98, v[40:41] offset:7008
    s_waitcnt lgkmcnt(0)
    ds_read_b128 v[16:19], v101 offset:0
    ds_read_b128 v[20:23], v101 offset:1152
    ds_read_b128 v[24:27], v101 offset:2304
    ds_read_b128 v[28:31], v101 offset:3456
    ds_read_b128 v[32:35], v101 offset:4608
    ds_read_b128 v[36:39], v101 offset:5760
    ds_read_b128 v[40:43], v101 offset:6912
    ds_read_b128 v[44:47], v101 offset:8064
    s_waitcnt lgkmcnt(7)
    buffer_store_dwordx4 v[16:19], v99, s[8:11], s45 offen sc1
    s_add_u32 s45, s45, 98304
    s_waitcnt lgkmcnt(6)
    buffer_store_dwordx4 v[20:23], v99, s[8:11], s45 offen sc1
    s_add_u32 s45, s45, 98304
    s_waitcnt lgkmcnt(5)
    buffer_store_dwordx4 v[24:27], v99, s[8:11], s45 offen sc1
    s_add_u32 s45, s45, 98304
    s_waitcnt lgkmcnt(4)
    buffer_store_dwordx4 v[28:31], v99, s[8:11], s45 offen sc1
    s_add_u32 s45, s45, 98304
    s_waitcnt lgkmcnt(3)
    buffer_store_dwordx4 v[32:35], v99, s[8:11], s45 offen sc1
    s_add_u32 s45, s45, 98304
    s_waitcnt lgkmcnt(2)
    buffer_store_dwordx4 v[36:39], v99, s[8:11], s45 offen sc1
    s_add_u32 s45, s45, 98304
    s_waitcnt lgkmcnt(1)
    buffer_store_dwordx4 v[40:43], v99, s[8:11], s45 offen sc1
    s_add_u32 s45, s45, 98304
    s_waitcnt lgkmcnt(0)
    buffer_store_dwordx4 v[44:47], v99, s[8:11], s45 offen sc1
    s_waitcnt vmcnt(0)
    s_barrier
    s_cmp_lg_u32 s96, 0
    s_cbranch_scc1 L_nosig_74
    v_mov_b32 v3, 2
    v_mov_b32 v4, 0
    s_mov_b64 exec, 1
    buffer_atomic_add v3, v4, s[8:11], s95 offen
    s_mov_b64 exec, -1
L_nosig_74:
    s_add_u32 s92, s92, 128
    s_cmp_lt_u32 s92, 1152
    s_cbranch_scc1 L_wq_69
    s_load_dwordx2 s[36:37], s[0:1], 40
    s_load_dwordx4 s[60:63], s[0:1], 64
    s_load_dwordx2 s[64:65], s[0:1], 80
    v_and_b32 v1, 63, v0
    v_and_b32 v8, 15, v1
    v_lshrrev_b32 v9, 4, v1
    v_lshrrev_b32 v3, 2, v8
    v_lshl_add_u32 v3, v9, 3, v3
    v_mul_u32_u24 v2, 1280, v3
    v_and_b32 v3, 3, v1
    v_lshl_add_u32 v2, v3, 3, v2
    s_mul_i32 s93, s96, 160
    v_add_u32 v2, s93, v2
    v_lshlrev_b32 v4, 4, v0
    v_lshlrev_b32 v5, 4, v1
    s_mov_b32 s92, s90
    s_waitcnt lgkmcnt(0)
L_wof_75:
    s_barrier
    s_cmp_ge_u32 s92, 192
    s_cselect_b32 s24, s64, s36
    s_cselect_b32 s25, s65, s37
    s_mov_b32 s26, 7864320
    s_cselect_b32 s26, 1966080, s26
    s_mov_b32 s27, 0x20000
    s_cselect_b32 s93, 192, 0
    s_and_b32 s25, s25, 0xffff
    s_sub_u32 s93, s92, s93
    s_mul_i32 s93, s93, 40960
    s_lshl_b32 s94, s96, 10
    s_add_u32 m0, s94, 0
    s_nop 0
    buffer_load_dwordx4 v4, s[24:27], s93 offen lds
    s_add_u32 s93, s93, 8192
    s_add_u32 m0, s94, 8192
    s_nop 0
    buffer_load_dwordx4 v4, s[24:27], s93 offen lds
    s_add_u32 s93, s93, 8192
    s_add_u32 m0, s94, 16384
    s_nop 0
    buffer_load_dwordx4 v4, s[24:27], s93 offen lds
    s_add_u32 s93, s93, 8192
    s_add_u32 m0, s94, 24576
    s_nop 0
    buffer_load_dwordx4 v4, s[24:27], s93 offen lds
    s_add_u32 s93, s93, 8192
    s_add_u32 m0, s94, 32768
    s_nop 0
    buffer_load_dwordx4 v4, s[24:27], s93 offen lds
    s_waitcnt vmcnt(0)
    s_barrier
    ds_read_b64_tr_b16 v[16:17], v2 offset:0
    ds_read_b64_tr_b16 v[18:19], v2 offset:5120
    ds_read_b64_tr_b16 v[20:21], v2 offset:32
    ds_read_b64_tr_b16 v[22:23], v2 offset:5152
    ds_read_b64_tr_b16 v[24:25], v2 offset:64
    ds_read_b64_tr_b16 v[26:27], v2 offset:5184
    ds_read_b64_tr_b16 v[28:29], v2 offset:96
    ds_read_b64_tr_b16 v[30:31], v2 offset:5216
    ds_read_b64_tr_b16 v[32:33], v2 offset:128
    ds_read_b64_tr_b16 v[34:35], v2 offset:5248
    s_mul_i32 s93, s92, 40960
    s_mul_i32 s94, s96, 5120
    s_add_u32 s93, s93, s94
    s_add_u32 s93, s93, 218103808
    s_add_u32 s94, s93, 4096
    s_waitcnt lgkmcnt(0)
    buffer_store_dwordx4 v[16:19], v5, s[8:11], s93 offen offset:0
    buffer_store_dwordx4 v[20:23], v5, s[8:11], s93 offen offset:1024
    buffer_store_dwordx4 v[24:27], v5, s[8:11], s93 offen offset:2048
    buffer_store_dwordx4 v[28:31], v5, s[8:11], s93 offen offset:3072
    buffer_store_dwordx4 v[32:35], v5, s[8:11], s94 offen offset:0
    s_add_u32 s92, s92, 128
    s_cmp_lt_u32 s92, 240
    s_cbranch_scc1 L_wof_75
    s_sub_u32 s92, 127, s90
    s_cmp_ge_u32 s92, 120
    s_cbranch_scc1 L_wgf_76
    s_cmp_ge_u32 s92, 60
    s_cselect_b32 s24, s62, s60
    s_cselect_b32 s25, s63, s61
    s_mov_b32 s26, 1966080
    s_mov_b32 s27, 0x20000
    s_cselect_b32 s95, 1, 0
    s_cselect_b32 s93, 60, 0
    s_and_b32 s25, s25, 0xffff
    s_sub_u32 s92, s92, s93
    s_mul_hi_u32 s97, s92, 1431655766
    s_mul_i32 s93, s97, 3
    s_sub_u32 s98, s92, s93
    s_lshl_b32 s93, s97, 5
    s_lshl_b32 s94, s96, 2
    s_add_u32 s93, s93, s94
    s_mul_i32 s93, s93, 3072
    s_lshl_b32 s94, s98, 10
    s_add_u32 s93, s93, s94
    s_lshl_b32 s94, s96, 12
    s_barrier
    s_add_u32 m0, s94, 0
    s_nop 0
    buffer_load_dwordx4 v5, s[24:27], s93 offen lds
    s_add_u32 s93, s93, 3072
    s_add_u32 m0, s94, 1024
    s_nop 0
    buffer_load_dwordx4 v5, s[24:27], s93 offen lds
    s_add_u32 s93, s93, 3072
    s_add_u32 m0, s94, 2048
    s_nop 0
    buffer_load_dwordx4 v5, s[24:27], s93 offen lds
    s_add_u32 s93, s93, 3072
    s_add_u32 m0, s94, 3072
    s_nop 0
    buffer_load_dwordx4 v5, s[24:27], s93 offen lds
    v_lshrrev_b32 v3, 2, v8
    v_lshl_add_u32 v3, v9, 3, v3
    v_lshlrev_b32 v2, 10, v3
    v_and_b32 v3, 3, v1
    v_lshl_add_u32 v2, v3, 3, v2
    s_lshl_b32 s93, s96, 7
    v_add_u32 v2, s93, v2
    s_waitcnt vmcnt(0)
    s_barrier
    ds_read_b64_tr_b16 v[16:17], v2 offset:0
    ds_read_b64_tr_b16 v[18:19], v2 offset:4096
    ds_read_b64_tr_b16 v[20:21], v2 offset:32
    ds_read_b64_tr_b16 v[22:23], v2 offset:4128
    ds_read_b64_tr_b16 v[24:25], v2 offset:64
    ds_read_b64_tr_b16 v[26:27], v2 offset:4160
    ds_read_b64_tr_b16 v[28:29], v2 offset:96
    ds_read_b64_tr_b16 v[30:31], v2 offset:4192
    s_mul_i32 s93, s97, 196608
    s_lshl_b32 s94, s98, 16
    s_add_u32 s93, s93, s94
    s_lshl_b32 s94, s96, 13
    s_add_u32 s93, s93, s94
    s_lshl_b32 s94, s95, 10
    s_add_u32 s93, s93, s94
    s_add_u32 s93, s93, 234881024
    s_add_u32 s94, s93, 4096
    s_waitcnt lgkmcnt(0)
    buffer_store_dwordx4 v[16:19], v5, s[8:11], s93 offen offset:0
    buffer_store_dwordx4 v[20:23], v5, s[8:11], s93 offen offset:2048
    buffer_store_dwordx4 v[24:27], v5, s[8:11], s94 offen offset:0
    buffer_store_dwordx4 v[28:31], v5, s[8:11], s94 offen offset:2048
L_wgf_76:
    s_branch L_done_2
.section .rodata,"a"
.p2align 6
.amdhsa_kernel chain_kernel
  .amdhsa_next_free_vgpr 256
  .amdhsa_next_free_sgpr 100
  .amdhsa_accum_offset 108
  .amdhsa_group_segment_fixed_size 0
  .amdhsa_kernarg_size 112
  .amdhsa_user_sgpr_count 2
  .amdhsa_user_sgpr_kernarg_segment_ptr 1
  .amdhsa_system_sgpr_workgroup_id_x 1
.end_amdhsa_kernel
.text
.globl xo_kernel
.p2align 8
.type xo_kernel,@function
xo_kernel:
    s_cmp_ge_u32 s2, 256
    s_cbranch_scc1 L_done_77
    s_load_dwordx2 s[6:7], s[0:1], 104
    v_and_b32 v1, 63, v0
    v_lshrrev_b32 v2, 6, v0
    s_nop 0
    v_readfirstlane_b32 s40, v2
    s_nop 3
    s_and_b32 s62, s2, 7
    s_lshr_b32 s63, s2, 3
    s_lshr_b32 s64, s40, 2
    s_and_b32 s65, s40, 3
    s_lshl_b32 s42, s63, 1
    s_add_u32 s42, s42, s64
    s_lshl_b32 s43, s62, 2
    s_add_u32 s43, s43, s65
    s_mov_b32 s50, 1033096506
    s_mov_b32 s51, 1069066811
    s_waitcnt lgkmcnt(0)
    s_mov_b32 s8, s6
    s_and_b32 s9, s7, 0xffff
    s_mov_b32 s10, 268435456
    s_mov_b32 s11, 0x20000
    s_mul_i32 s44, s42, 393216
    s_mul_i32 s45, s43, 384
    s_add_u32 s44, s44, s45
    s_mul_i32 s46, s42, 98304
    s_add_u32 s46, s46, s45
    s_add_u32 s52, s44, 4194304
    s_add_u32 s53, s44, 29360128
    s_add_u32 s54, s44, 54525952
    s_add_u32 s55, s46, 79691776
    s_add_u32 s56, s46, 85983232
    s_mul_i32 s57, s40, 19968
    v_mov_b32 v4, 0xaaaaaab
    v_add_u32 v3, 0, v1
    v_mul_hi_u32 v5, v3, v4
    v_mul_u32_u24 v6, 24, v5
    v_sub_u32 v6, v3, v6
    v_mul_u32_u24 v236, 416, v5
    v_lshl_add_u32 v236, v6, 4, v236
    v_add_u32 v240, s57, v236
    v_mul_u32_u24 v7, 12288, v5
    v_lshl_add_u32 v7, v6, 4, v7
    buffer_load_dwordx4 v[176:179], v7, s[8:11], s54 offen
    v_add_u32 v3, 64, v1
    v_mul_hi_u32 v5, v3, v4
    v_mul_u32_u24 v6, 24, v5
    v_sub_u32 v6, v3, v6
    v_mul_u32_u24 v236, 416, v5
    v_lshl_add_u32 v236, v6, 4, v236
    v_add_u32 v241, s57, v236
    v_mul_u32_u24 v7, 12288, v5
    v_lshl_add_u32 v7, v6, 4, v7
    buffer_load_dwordx4 v[180:183], v7, s[8:11], s54 offen
    v_add_u32 v3, 128, v1
    v_mul_hi_u32 v5, v3, v4
    v_mul_u32_u24 v6, 24, v5
    v_sub_u32 v6, v3, v6
    v_mul_u32_u24 v236, 416, v5
    v_lshl_add_u32 v236, v6, 4, v236
    v_add_u32 v242, s57, v236
    v_mul_u32_u24 v7, 12288, v5
    v_lshl_add_u32 v7, v6, 4, v7
    buffer_load_dwordx4 v[184:187], v7, s[8:11], s54 offen
    v_add_u32 v3, 192, v1
    v_mul_hi_u32 v5, v3, v4
    v_mul_u32_u24 v6, 24, v5
    v_sub_u32 v6, v3, v6
    v_mul_u32_u24 v236, 416, v5
    v_lshl_add_u32 v236, v6, 4, v236
    v_add_u32 v243, s57, v236
    v_mul_u32_u24 v7, 12288, v5
    v_lshl_add_u32 v7, v6, 4, v7
    buffer_load_dwordx4 v[188:191], v7, s[8:11], s54 offen
    v_add_u32 v3, 256, v1
    v_mul_hi_u32 v5, v3, v4
    v_mul_u32_u24 v6, 24, v5
    v_sub_u32 v6, v3, v6
    v_mul_u32_u24 v236, 416, v5
    v_lshl_add_u32 v236, v6, 4, v236
    v_add_u32 v244, s57, v236
    v_mul_u32_u24 v7, 12288, v5
    v_lshl_add_u32 v7, v6, 4, v7
    buffer_load_dwordx4 v[192:195], v7, s[8:11], s54 offen
    v_add_u32 v3, 320, v1
    v_mul_hi_u32 v5, v3, v4
    v_mul_u32_u24 v6, 24, v5
    v_sub_u32 v6, v3, v6
    v_mul_u32_u24 v236, 416, v5
    v_lshl_add_u32 v236, v6, 4, v236
    v_add_u32 v245, s57, v236
    v_mul_u32_u24 v7, 12288, v5
    v_lshl_add_u32 v7, v6, 4, v7
    buffer_load_dwordx4 v[196:199], v7, s[8:11], s54 offen
    v_add_u32 v3, 384, v1
    v_mul_hi_u32 v5, v3, v4
    v_mul_u32_u24 v6, 24, v5
    v_sub_u32 v6, v3, v6
    v_mul_u32_u24 v236, 416, v5
    v_lshl_add_u32 v236, v6, 4, v236
    v_add_u32 v246, s57, v236
    v_mul_u32_u24 v7, 12288, v5
    v_lshl_add_u32 v7, v6, 4, v7
    buffer_load_dwordx4 v[200:203], v7, s[8:11], s54 offen
    v_add_u32 v3, 448, v1
    v_mul_hi_u32 v5, v3, v4
    v_mul_u32_u24 v6, 24, v5
    v_sub_u32 v6, v3, v6
    v_mul_u32_u24 v236, 416, v5
    v_lshl_add_u32 v236, v6, 4, v236
    v_add_u32 v247, s57, v236
    v_mul_u32_u24 v7, 12288, v5
    v_lshl_add_u32 v7, v6, 4, v7
    buffer_load_dwordx4 v[204:207], v7, s[8:11], s54 offen
    v_add_u32 v3, 512, v1
    v_mul_hi_u32 v5, v3, v4
    v_mul_u32_u24 v6, 24, v5
    v_sub_u32 v6, v3, v6
    v_mul_u32_u24 v236, 416, v5
    v_lshl_add_u32 v236, v6, 4, v236
    v_add_u32 v248, s57, v236
    v_mul_u32_u24 v7, 12288, v5
    v_lshl_add_u32 v7, v6, 4, v7
    buffer_load_dwordx4 v[208:211], v7, s[8:11], s54 offen
    v_add_u32 v3, 576, v1
    v_mul_hi_u32 v5, v3, v4
    v_mul_u32_u24 v6, 24, v5
    v_sub_u32 v6, v3, v6
    v_mul_u32_u24 v236, 416, v5
    v_lshl_add_u32 v236, v6, 4, v236
    v_add_u32 v249, s57, v236
    v_mul_u32_u24 v7, 12288, v5
    v_lshl_add_u32 v7, v6, 4, v7
    buffer_load_dwordx4 v[212:215], v7, s[8:11], s54 offen
    v_add_u32 v3, 640, v1
    v_mul_hi_u32 v5, v3, v4
    v_mul_u32_u24 v6, 24, v5
    v_sub_u32 v6, v3, v6
    v_mul_u32_u24 v236, 416, v5
    v_lshl_add_u32 v236, v6, 4, v236
    v_add_u32 v250, s57, v236
    v_mul_u32_u24 v7, 12288, v5
    v_lshl_add_u32 v7, v6, 4, v7
    buffer_load_dwordx4 v[216:219], v7, s[8:11], s54 offen
    v_add_u32 v3, 704, v1
    v_mul_hi_u32 v5, v3, v4
    v_mul_u32_u24 v6, 24, v5
    v_sub_u32 v6, v3, v6
    v_mul_u32_u24 v236, 416, v5
    v_lshl_add_u32 v236, v6, 4, v236
    v_add_u32 v251, s57, v236
    v_mul_u32_u24 v7, 12288, v5
    v_lshl_add_u32 v7, v6, 4, v7
    buffer_load_dwordx4 v[220:223], v7, s[8:11], s54 offen
    v_add_u32 v3, 768, v1
    v_mul_hi_u32 v5, v3, v4
    v_mul_u32_u24 v6, 24, v5
    v_sub_u32 v6, v3, v6
    v_mul_u32_u24 v236, 416, v5
    v_lshl_add_u32 v236, v6, 4, v236
    v_add_u32 v252, s57, v236
    v_subrev_u32 v5, 32, v5
    v_mul_u32_u24 v7, 12288, v5
    v_lshl_add_u32 v7, v6, 4, v7
    buffer_load_dwordx4 v[224:227], v7, s[8:11], s56 offen
    v_add_u32 v3, 832, v1
    v_mul_hi_u32 v5, v3, v4
    v_mul_u32_u24 v6, 24, v5
    v_sub_u32 v6, v3, v6
    v_mul_u32_u24 v236, 416, v5
    v_lshl_add_u32 v236, v6, 4, v236
    v_add_u32 v253, s57, v236
    v_subrev_u32 v5, 32, v5
    v_mul_u32_u24 v7, 12288, v5
    v_lshl_add_u32 v7, v6, 4, v7
    buffer_load_dwordx4 v[228:231], v7, s[8:11], s56 offen
    v_add_u32 v3, 896, v1
    v_mul_hi_u32 v5, v3, v4
    v_mul_u32_u24 v6, 24, v5
    v_sub_u32 v6, v3, v6
    v_mul_u32_u24 v236, 416, v5
    v_lshl_add_u32 v236, v6, 4, v236
    v_add_u32 v254, s57, v236
    v_subrev_u32 v5, 32, v5
    v_mul_u32_u24 v7, 12288, v5
    v_lshl_add_u32 v7, v6, 4, v7
    buffer_load_dwordx4 v[232:235], v7, s[8:11], s56 offen
    v_and_b32 v8, 15, v1
    v_lshrrev_b32 v9, 4, v1
    v_mul_u32_u24 v10, 12288, v8
    v_lshl_add_u32 v10, v9, 4, v10
    v_and_b32 v11, 7, v8
    v_mul_u32_u24 v11, 12288, v11
    v_lshl_add_u32 v11, v9, 4, v11
    s_add_u32 s58, s52, 0
    buffer_load_dwordx4 v[16:19], v10, s[8:11], s58 offen offset:0
    buffer_load_dwordx4 v[20:23], v10, s[8:11], s58 offen offset:64
    buffer_load_dwordx4 v[24:27], v10, s[8:11], s58 offen offset:128
    buffer_load_dwordx4 v[28:31], v10, s[8:11], s58 offen offset:192
    buffer_load_dwordx4 v[32:35], v10, s[8:11], s58 offen offset:256
    buffer_load_dwordx4 v[36:39], v10, s[8:11], s58 offen offset:320
    s_add_u32 s58, s52, 196608
    buffer_load_dwordx4 v[40:43], v10, s[8:11], s58 offen offset:0
    buffer_load_dwordx4 v[44:47], v10, s[8:11], s58 offen offset:64
    buffer_load_dwordx4 v[48:51], v10, s[8:11], s58 offen offset:128
    buffer_load_dwordx4 v[52:55], v10, s[8:11], s58 offen offset:192
    buffer_load_dwordx4 v[56:59], v10, s[8:11], s58 offen offset:256
    buffer_load_dwordx4 v[60:63], v10, s[8:11], s58 offen offset:320
    s_add_u32 s58, s53, 0
    buffer_load_dwordx4 v[64:67], v10, s[8:11], s58 offen offset:0
    buffer_load_dwordx4 v[68:71], v10, s[8:11], s58 offen offset:64
    buffer_load_dwordx4 v[72:75], v10, s[8:11], s58 offen offset:128
    buffer_load_dwordx4 v[76:79], v10, s[8:11], s58 offen offset:192
    buffer_load_dwordx4 v[80:83], v10, s[8:11], s58 offen offset:256
    buffer_load_dwordx4 v[84:87], v10, s[8:11], s58 offen offset:320
    s_add_u32 s58, s53, 196608
    buffer_load_dwordx4 v[88:91], v10, s[8:11], s58 offen offset:0
    buffer_load_dwordx4 v[92:95], v10, s[8:11], s58 offen offset:64
    buffer_load_dwordx4 v[96:99], v10, s[8:11], s58 offen offset:128
    buffer_load_dwordx4 v[100:103], v10, s[8:11], s58 offen offset:192
    buffer_load_dwordx4 v[104:107], v10, s[8:11], s58 offen offset:256
    buffer_load_dwordx4 v[108:111], v10, s[8:11], s58 offen offset:320
    buffer_load_dwordx4 v[112:115], v11, s[8:11], s55 offen offset:0
    buffer_load_dwordx4 v[116:119], v11, s[8:11], s55 offen offset:64
    buffer_load_dwordx4 v[120:123], v11, s[8:11], s55 offen offset:128
    buffer_load_dwordx4 v[124:127], v11, s[8:11], s55 offen offset:192
    buffer_load_dwordx4 v[128:131], v11, s[8:11], s55 offen offset:256
    buffer_load_dwordx4 v[132:135], v11, s[8:11], s55 offen offset:320
    v_mov_b32 v160, 0
    v_mov_b32 v161, 0
    v_mov_b32 v162, 0
    v_mov_b32 v163, 0
    v_lshlrev_b32 v3, 4, v1
    v_add_u32 v3, s57, v3
    ds_write_b128 v3, v[160:163] offset:16640
    ds_write_b128 v3, v[160:163] offset:17664
    ds_write_b128 v3, v[160:163] offset:18688
    v_cmp_gt_u32 vcc, 16, v1
    s_and_saveexec_b64 s[60:61], vcc
    ds_write_b128 v3, v[160:163] offset:19712
    s_mov_b64 exec, s[60:61]
    s_waitcnt vmcnt(30)
    ds_write_b128 v240, v[176:179]
    ds_write_b128 v241, v[180:183]
    ds_write_b128 v242, v[184:187]
    ds_write_b128 v243, v[188:191]
    ds_write_b128 v244, v[192:195]
    ds_write_b128 v245, v[196:199]
    ds_write_b128 v246, v[200:203]
    ds_write_b128 v247, v[204:207]
    ds_write_b128 v248, v[208:211]
    ds_write_b128 v249, v[212:215]
    ds_write_b128 v250, v[216:219]
    ds_write_b128 v251, v[220:223]
    ds_write_b128 v252, v[224:227]
    ds_write_b128 v253, v[228:231]
    ds_write_b128 v254, v[232:235]
    v_mov_b32 v136, 0
    v_mov_b32 v137, 0
    v_mov_b32 v138, 0
    v_mov_b32 v139, 0
    v_mov_b32 v140, 0
    v_mov_b32 v141, 0
    v_mov_b32 v142, 0
    v_mov_b32 v143, 0
    v_mov_b32 v144, 0
    v_mov_b32 v145, 0
    v_mov_b32 v146, 0
    v_mov_b32 v147, 0
    v_mov_b32 v148, 0
    v_mov_b32 v149, 0
    v_mov_b32 v150, 0
    v_mov_b32 v151, 0
    v_mov_b32 v152, 0
    v_mov_b32 v153, 0
    v_mov_b32 v154, 0
    v_mov_b32 v155, 0
    v_mov_b32 v156, 0
    v_mov_b32 v157, 0
    v_mov_b32 v158, 0
    v_mov_b32 v159, 0
    s_waitcnt vmcnt(0)
    v_mfma_f32_16x16x32_bf16 v[136:139], v[64:67], v[16:19], v[136:139]
    v_mfma_f32_16x16x32_bf16 v[140:143], v[64:67], v[40:43], v[140:143]
    v_mfma_f32_16x16x32_bf16 v[144:147], v[88:91], v[16:19], v[144:147]
    v_mfma_f32_16x16x32_bf16 v[148:151], v[88:91], v[40:43], v[148:151]
    v_mfma_f32_16x16x32_bf16 v[152:155], v[112:115], v[16:19], v[152:155]
    v_mfma_f32_16x16x32_bf16 v[156:159], v[112:115], v[40:43], v[156:159]
    v_mfma_f32_16x16x32_bf16 v[136:139], v[68:71], v[20:23], v[136:139]
    v_mfma_f32_16x16x32_bf16 v[140:143], v[68:71], v[44:47], v[140:143]
    v_mfma_f32_16x16x32_bf16 v[144:147], v[92:95], v[20:23], v[144:147]
    v_mfma_f32_16x16x32_bf16 v[148:151], v[92:95], v[44:47], v[148:151]
    v_mfma_f32_16x16x32_bf16 v[152:155], v[116:119], v[20:23], v[152:155]
    v_mfma_f32_16x16x32_bf16 v[156:159], v[116:119], v[44:47], v[156:159]
    v_mfma_f32_16x16x32_bf16 v[136:139], v[72:75], v[24:27], v[136:139]
    v_mfma_f32_16x16x32_bf16 v[140:143], v[72:75], v[48:51], v[140:143]
    v_mfma_f32_16x16x32_bf16 v[144:147], v[96:99], v[24:27], v[144:147]
    v_mfma_f32_16x16x32_bf16 v[148:151], v[96:99], v[48:51], v[148:151]
    v_mfma_f32_16x16x32_bf16 v[152:155], v[120:123], v[24:27], v[152:155]
    v_mfma_f32_16x16x32_bf16 v[156:159], v[120:123], v[48:51], v[156:159]
    v_mfma_f32_16x16x32_bf16 v[136:139], v[76:79], v[28:31], v[136:139]
    v_mfma_f32_16x16x32_bf16 v[140:143], v[76:79], v[52:55], v[140:143]
    v_mfma_f32_16x16x32_bf16 v[144:147], v[100:103], v[28:31], v[144:147]
    v_mfma_f32_16x16x32_bf16 v[148:151], v[100:103], v[52:55], v[148:151]
    v_mfma_f32_16x16x32_bf16 v[152:155], v[124:127], v[28:31], v[152:155]
    v_mfma_f32_16x16x32_bf16 v[156:159], v[124:127], v[52:55], v[156:159]
    v_mfma_f32_16x16x32_bf16 v[136:139], v[80:83], v[32:35], v[136:139]
    v_mfma_f32_16x16x32_bf16 v[140:143], v[80:83], v[56:59], v[140:143]
    v_mfma_f32_16x16x32_bf16 v[144:147], v[104:107], v[32:35], v[144:147]
    v_mfma_f32_16x16x32_bf16 v[148:151], v[104:107], v[56:59], v[148:151]
    v_mfma_f32_16x16x32_bf16 v[152:155], v[128:131], v[32:35], v[152:155]
    v_mfma_f32_16x16x32_bf16 v[156:159], v[128:131], v[56:59], v[156:159]
    v_mfma_f32_16x16x32_bf16 v[136:139], v[84:87], v[36:39], v[136:139]
    v_mfma_f32_16x16x32_bf16 v[140:143], v[84:87], v[60:63], v[140:143]
    v_mfma_f32_16x16x32_bf16 v[144:147], v[108:111], v[36:39], v[144:147]
    v_mfma_f32_16x16x32_bf16 v[148:151], v[108:111], v[60:63], v[148:151]
    v_mfma_f32_16x16x32_bf16 v[152:155], v[132:135], v[36:39], v[152:155]
    v_mfma_f32_16x16x32_bf16 v[156:159], v[132:135], v[60:63], v[156:159]
    s_mul_i32 s66, s62, 983040
    s_mul_i32 s67, s40, 5120
    s_add_u32 s66, s66, s67
    s_add_u32 s66, s66, 218103808
    v_lshlrev_b32 v2, 4, v1
    s_waitcnt lgkmcnt(0)
    s_add_u32 s67, s66, 0
    buffer_load_dwordx4 v[176:179], v2, s[8:11], s67 offen
    s_add_u32 s67, s66, 1024
    buffer_load_dwordx4 v[180:183], v2, s[8:11], s67 offen
    s_add_u32 s67, s66, 2048
    buffer_load_dwordx4 v[184:187], v2, s[8:11], s67 offen
    s_add_u32 s67, s66, 3072
    buffer_load_dwordx4 v[188:191], v2, s[8:11], s67 offen
    s_add_u32 s67, s66, 4096
    buffer_load_dwordx4 v[192:195], v2, s[8:11], s67 offen
    s_add_u32 s67, s66, 40960
    buffer_load_dwordx4 v[196:199], v2, s[8:11], s67 offen
    s_add_u32 s67, s66, 41984
    buffer_load_dwordx4 v[200:203], v2, s[8:11], s67 offen
    s_add_u32 s67, s66, 43008
    buffer_load_dwordx4 v[204:207], v2, s[8:11], s67 offen
    s_add_u32 s67, s66, 44032
    buffer_load_dwordx4 v[208:211], v2, s[8:11], s67 offen
    s_add_u32 s67, s66, 45056
    buffer_load_dwordx4 v[212:215], v2, s[8:11], s67 offen
    s_add_u32 s67, s66, 81920
    buffer_load_dwordx4 v[216:219], v2, s[8:11], s67 offen
    s_add_u32 s67, s66, 82944
    buffer_load_dwordx4 v[220:223], v2, s[8:11], s67 offen
    s_add_u32 s67, s66, 83968
    buffer_load_dwordx4 v[224:227], v2, s[8:11], s67 offen
    s_add_u32 s67, s66, 84992
    buffer_load_dwordx4 v[228:231], v2, s[8:11], s67 offen
    s_add_u32 s67, s66, 86016
    buffer_load_dwordx4 v[232:235], v2, s[8:11], s67 offen
    s_add_u32 s67, s66, 122880
    buffer_load_dwordx4 v[236:239], v2, s[8:11], s67 offen
    s_add_u32 s67, s66, 123904
    buffer_load_dwordx4 v[240:243], v2, s[8:11], s67 offen
    s_add_u32 s67, s66, 124928
    buffer_load_dwordx4 v[244:247], v2, s[8:11], s67 offen
    s_add_u32 s67, s66, 125952
    buffer_load_dwordx4 v[248:251], v2, s[8:11], s67 offen
    s_add_u32 s67, s66, 126976
    buffer_load_dwordx4 v[252:255], v2, s[8:11], s67 offen
    s_nop 7
    s_nop 1
    v_mov_b32 v12, 3463342888
    v_lshlrev_b32 v13, 2, v9
    v_cvt_pk_bf16_f32 v14, v136, v137
    s_nop 0
    v_lshlrev_b32 v136, 16, v14
    v_and_b32 v137, 0xffff0000, v14
    v_mul_f32 v136, s50, v136
    v_mul_f32 v137, s50, v137
    v_cvt_pk_bf16_f32 v14, v136, v137
    s_nop 0
    v_lshlrev_b32 v136, 16, v14
    v_and_b32 v137, 0xffff0000, v14
    v_cvt_pk_bf16_f32 v14, v138, v139
    s_nop 0
    v_lshlrev_b32 v138, 16, v14
    v_and_b32 v139, 0xffff0000, v14
    v_mul_f32 v138, s50, v138
    v_mul_f32 v139, s50, v139
    v_cvt_pk_bf16_f32 v14, v138, v139
    s_nop 0
    v_lshlrev_b32 v138, 16, v14
    v_and_b32 v139, 0xffff0000, v14
    v_cvt_pk_bf16_f32 v14, v144, v145
    s_nop 0
    v_lshlrev_b32 v144, 16, v14
    v_and_b32 v145, 0xffff0000, v14
    v_mul_f32 v144, s50, v144
    v_mul_f32 v145, s50, v145
    v_cvt_pk_bf16_f32 v14, v144, v145
    s_nop 0
    v_lshlrev_b32 v144, 16, v14
    v_and_b32 v145, 0xffff0000, v14
    v_cvt_pk_bf16_f32 v14, v146, v147
    s_nop 0
    v_lshlrev_b32 v146, 16, v14
    v_and_b32 v147, 0xffff0000, v14
    v_mul_f32 v146, s50, v146
    v_mul_f32 v147, s50, v147
    v_cvt_pk_bf16_f32 v14, v146, v147
    s_nop 0
    v_lshlrev_b32 v146, 16, v14
    v_and_b32 v147, 0xffff0000, v14
    v_cvt_pk_bf16_f32 v14, v152, v153
    s_nop 0
    v_lshlrev_b32 v152, 16, v14
    v_and_b32 v153, 0xffff0000, v14
    v_mul_f32 v152, s50, v152
    v_mul_f32 v153, s50, v153
    v_cvt_pk_bf16_f32 v14, v152, v153
    s_nop 0
    v_lshlrev_b32 v152, 16, v14
    v_and_b32 v153, 0xffff0000, v14
    v_cvt_pk_bf16_f32 v14, v154, v155
    s_nop 0
    v_lshlrev_b32 v154, 16, v14
    v_and_b32 v155, 0xffff0000, v14
    v_mul_f32 v154, s50, v154
    v_mul_f32 v155, s50, v155
    v_cvt_pk_bf16_f32 v14, v154, v155
    s_nop 0
    v_lshlrev_b32 v154, 16, v14
    v_and_b32 v155, 0xffff0000, v14
    v_add_u32 v14, 0, v13
    v_cmp_le_i32 vcc, v14, v8
    s_nop 1
    v_cndmask_b32 v136, v12, v136, vcc
    v_add_u32 v14, 1, v13
    v_cmp_le_i32 vcc, v14, v8
    s_nop 1
    v_cndmask_b32 v137, v12, v137, vcc
    v_add_u32 v14, 2, v13
    v_cmp_le_i32 vcc, v14, v8
    s_nop 1
    v_cndmask_b32 v138, v12, v138, vcc
    v_add_u32 v14, 3, v13
    v_cmp_le_i32 vcc, v14, v8
    s_nop 1
    v_cndmask_b32 v139, v12, v139, vcc
    v_add_u32 v14, 16, v13
    v_cmp_le_i32 vcc, v14, v8
    s_nop 1
    v_cndmask_b32 v144, v12, v144, vcc
    v_add_u32 v14, 17, v13
    v_cmp_le_i32 vcc, v14, v8
    s_nop 1
    v_cndmask_b32 v145, v12, v145, vcc
    v_add_u32 v14, 18, v13
    v_cmp_le_i32 vcc, v14, v8
    s_nop 1
    v_cndmask_b32 v146, v12, v146, vcc
    v_add_u32 v14, 19, v13
    v_cmp_le_i32 vcc, v14, v8
    s_nop 1
    v_cndmask_b32 v147, v12, v147, vcc
    v_cmp_gt_u32 vcc, 2, v9
    s_nop 1
    v_cndmask_b32 v152, v12, v152, vcc
    v_cndmask_b32 v153, v12, v153, vcc
    v_cndmask_b32 v154, v12, v154, vcc
    v_cndmask_b32 v155, v12, v155, vcc
    v_max3_f32 v14, v136, v137, v138
    v_max3_f32 v14, v14, v139, v144
    v_max3_f32 v14, v14, v145, v146
    v_max3_f32 v14, v14, v147, v152
    v_max3_f32 v14, v14, v153, v154
    v_max_f32 v14, v14, v155
    v_mov_b32 v3, v14
    s_nop 1
    v_permlane32_swap_b32 v14, v3
    s_nop 1
    v_max_f32 v14, v14, v3
    v_mov_b32 v3, v14
    s_nop 1
    v_permlane16_swap_b32 v14, v3
    s_nop 1
    v_max_f32 v14, v14, v3
    v_sub_f32 v136, v136, v14
    v_mul_f32 v136, s51, v136
    v_sub_f32 v137, v137, v14
    v_mul_f32 v137, s51, v137
    v_sub_f32 v138, v138, v14
    v_mul_f32 v138, s51, v138
    v_sub_f32 v139, v139, v14
    v_mul_f32 v139, s51, v139
    v_sub_f32 v144, v144, v14
    v_mul_f32 v144, s51, v144
    v_sub_f32 v145, v145, v14
    v_mul_f32 v145, s51, v145
    v_sub_f32 v146, v146, v14
    v_mul_f32 v146, s51, v146
    v_sub_f32 v147, v147, v14
    v_mul_f32 v147, s51, v147
    v_sub_f32 v152, v152, v14
    v_mul_f32 v152, s51, v152
    v_sub_f32 v153, v153, v14
    v_mul_f32 v153, s51, v153
    v_sub_f32 v154, v154, v14
    v_mul_f32 v154, s51, v154
    v_sub_f32 v155, v155, v14
    v_mul_f32 v155, s51, v155
    v_exp_f32 v136, v136
    v_exp_f32 v137, v137
    v_exp_f32 v138, v138
    v_exp_f32 v139, v139
    v_exp_f32 v144, v144
    v_exp_f32 v145, v145
    v_exp_f32 v146, v146
    v_exp_f32 v147, v147
    v_exp_f32 v152, v152
    v_exp_f32 v153, v153
    v_exp_f32 v154, v154
    v_exp_f32 v155, v155
    s_nop 0
    v_add_f32 v15, v136, v137
    v_add_f32 v15, v15, v138
    v_add_f32 v15, v15, v139
    v_add_f32 v15, v15, v144
    v_add_f32 v15, v15, v145
    v_add_f32 v15, v15, v146
    v_add_f32 v15, v15, v147
    v_add_f32 v15, v15, v152
    v_add_f32 v15, v15, v153
    v_add_f32 v15, v15, v154
    v_add_f32 v15, v15, v155
    v_mov_b32 v3, v15
    s_nop 1
    v_permlane32_swap_b32 v15, v3
    s_nop 1
    v_add_f32 v15, v15, v3
    v_mov_b32 v3, v15
    s_nop 1
    v_permlane16_swap_b32 v15, v3
    s_nop 1
    v_add_f32 v15, v15, v3
    v_rcp_f32 v15, v15
    s_nop 0
    v_mul_f32 v136, v136, v15
    v_mul_f32 v137, v137, v15
    v_mul_f32 v138, v138, v15
    v_mul_f32 v139, v139, v15
    v_mul_f32 v144, v144, v15
    v_mul_f32 v145, v145, v15
    v_mul_f32 v146, v146, v15
    v_mul_f32 v147, v147, v15
    v_mul_f32 v152, v152, v15
    v_mul_f32 v153, v153, v15
    v_mul_f32 v154, v154, v15
    v_mul_f32 v155, v155, v15
    v_cvt_pk_bf16_f32 v160, v136, v137
    v_cvt_pk_bf16_f32 v161, v138, v139
    v_cvt_pk_bf16_f32 v162, v144, v145
    v_cvt_pk_bf16_f32 v163, v146, v147
    v_cvt_pk_bf16_f32 v164, v152, v153
    v_cvt_pk_bf16_f32 v165, v154, v155
    v_mov_b32 v166, 0
    v_mov_b32 v167, 0
    v_cvt_pk_bf16_f32 v14, v140, v141
    s_nop 0
    v_lshlrev_b32 v140, 16, v14
    v_and_b32 v141, 0xffff0000, v14
    v_mul_f32 v140, s50, v140
    v_mul_f32 v141, s50, v141
    v_cvt_pk_bf16_f32 v14, v140, v141
    s_nop 0
    v_lshlrev_b32 v140, 16, v14
    v_and_b32 v141, 0xffff0000, v14
    v_cvt_pk_bf16_f32 v14, v142, v143
    s_nop 0
    v_lshlrev_b32 v142, 16, v14
    v_and_b32 v143, 0xffff0000, v14
    v_mul_f32 v142, s50, v142
    v_mul_f32 v143, s50, v143
    v_cvt_pk_bf16_f32 v14, v142, v143
    s_nop 0
    v_lshlrev_b32 v142, 16, v14
    v_and_b32 v143, 0xffff0000, v14
    v_cvt_pk_bf16_f32 v14, v148, v149
    s_nop 0
    v_lshlrev_b32 v148, 16, v14
    v_and_b32 v149, 0xffff0000, v14
    v_mul_f32 v148, s50, v148
    v_mul_f32 v149, s50, v149
    v_cvt_pk_bf16_f32 v14, v148, v149
    s_nop 0
    v_lshlrev_b32 v148, 16, v14
    v_and_b32 v149, 0xffff0000, v14
    v_cvt_pk_bf16_f32 v14, v150, v151
    s_nop 0
    v_lshlrev_b32 v150, 16, v14
    v_and_b32 v151, 0xffff0000, v14
    v_mul_f32 v150, s50, v150
    v_mul_f32 v151, s50, v151
    v_cvt_pk_bf16_f32 v14, v150, v151
    s_nop 0
    v_lshlrev_b32 v150, 16, v14
    v_and_b32 v151, 0xffff0000, v14
    v_cvt_pk_bf16_f32 v14, v156, v157
    s_nop 0
    v_lshlrev_b32 v156, 16, v14
    v_and_b32 v157, 0xffff0000, v14
    v_mul_f32 v156, s50, v156
    v_mul_f32 v157, s50, v157
    v_cvt_pk_bf16_f32 v14, v156, v157
    s_nop 0
    v_lshlrev_b32 v156, 16, v14
    v_and_b32 v157, 0xffff0000, v14
    v_cvt_pk_bf16_f32 v14, v158, v159
    s_nop 0
    v_lshlrev_b32 v158, 16, v14
    v_and_b32 v159, 0xffff0000, v14
    v_mul_f32 v158, s50, v158
    v_mul_f32 v159, s50, v159
    v_cvt_pk_bf16_f32 v14, v158, v159
    s_nop 0
    v_lshlrev_b32 v158, 16, v14
    v_and_b32 v159, 0xffff0000, v14
    v_add_u32 v14, 0, v13
    v_cmp_le_i32 vcc, v14, v8
    s_nop 1
    v_cndmask_b32 v148, v12, v148, vcc
    v_add_u32 v14, 1, v13
    v_cmp_le_i32 vcc, v14, v8
    s_nop 1
    v_cndmask_b32 v149, v12, v149, vcc
    v_add_u32 v14, 2, v13
    v_cmp_le_i32 vcc, v14, v8
    s_nop 1
    v_cndmask_b32 v150, v12, v150, vcc
    v_add_u32 v14, 3, v13
    v_cmp_le_i32 vcc, v14, v8
    s_nop 1
    v_cndmask_b32 v151, v12, v151, vcc
    v_cmp_gt_u32 vcc, 2, v9
    s_nop 1
    v_cndmask_b32 v156, v12, v156, vcc
    v_cndmask_b32 v157, v12, v157, vcc
    v_cndmask_b32 v158, v12, v158, vcc
    v_cndmask_b32 v159, v12, v159, vcc
    v_max3_f32 v14, v140, v141, v142
    v_max3_f32 v14, v14, v143, v148
    v_max3_f32 v14, v14, v149, v150
    v_max3_f32 v14, v14, v151, v156
    v_max3_f32 v14, v14, v157, v158
    v_max_f32 v14, v14, v159
    v_mov_b32 v3, v14
    s_nop 1
    v_permlane32_swap_b32 v14, v3
    s_nop 1
    v_max_f32 v14, v14, v3
    v_mov_b32 v3, v14
    s_nop 1
    v_permlane16_swap_b32 v14, v3
    s_nop 1
    v_max_f32 v14, v14, v3
    v_sub_f32 v140, v140, v14
    v_mul_f32 v140, s51, v140
    v_sub_f32 v141, v141, v14
    v_mul_f32 v141, s51, v141
    v_sub_f32 v142, v142, v14
    v_mul_f32 v142, s51, v142
    v_sub_f32 v143, v143, v14
    v_mul_f32 v143, s51, v143
    v_sub_f32 v148, v148, v14
    v_mul_f32 v148, s51, v148
    v_sub_f32 v149, v149, v14
    v_mul_f32 v149, s51, v149
    v_sub_f32 v150, v150, v14
    v_mul_f32 v150, s51, v150
    v_sub_f32 v151, v151, v14
    v_mul_f32 v151, s51, v151
    v_sub_f32 v156, v156, v14
    v_mul_f32 v156, s51, v156
    v_sub_f32 v157, v157, v14
    v_mul_f32 v157, s51, v157
    v_sub_f32 v158, v158, v14
    v_mul_f32 v158, s51, v158
    v_sub_f32 v159, v159, v14
    v_mul_f32 v159, s51, v159
    v_exp_f32 v140, v140
    v_exp_f32 v141, v141
    v_exp_f32 v142, v142
    v_exp_f32 v143, v143
    v_exp_f32 v148, v148
    v_exp_f32 v149, v149
    v_exp_f32 v150, v150
    v_exp_f32 v151, v151
    v_exp_f32 v156, v156
    v_exp_f32 v157, v157
    v_exp_f32 v158, v158
    v_exp_f32 v159, v159
    s_nop 0
    v_add_f32 v15, v140, v141
    v_add_f32 v15, v15, v142
    v_add_f32 v15, v15, v143
    v_add_f32 v15, v15, v148
    v_add_f32 v15, v15, v149
    v_add_f32 v15, v15, v150
    v_add_f32 v15, v15, v151
    v_add_f32 v15, v15, v156
    v_add_f32 v15, v15, v157
    v_add_f32 v15, v15, v158
    v_add_f32 v15, v15, v159
    v_mov_b32 v3, v15
    s_nop 1
    v_permlane32_swap_b32 v15, v3
    s_nop 1
    v_add_f32 v15, v15, v3
    v_mov_b32 v3, v15
    s_nop 1
    v_permlane16_swap_b32 v15, v3
    s_nop 1
    v_add_f32 v15, v15, v3
    v_rcp_f32 v15, v15
    s_nop 0
    v_mul_f32 v140, v140, v15
    v_mul_f32 v141, v141, v15
    v_mul_f32 v142, v142, v15
    v_mul_f32 v143, v143, v15
    v_mul_f32 v148, v148, v15
    v_mul_f32 v149, v149, v15
    v_mul_f32 v150, v150, v15
    v_mul_f32 v151, v151, v15
    v_mul_f32 v156, v156, v15
    v_mul_f32 v157, v157, v15
    v_mul_f32 v158, v158, v15
    v_mul_f32 v159, v159, v15
    v_cvt_pk_bf16_f32 v168, v140, v141
    v_cvt_pk_bf16_f32 v169, v142, v143
    v_cvt_pk_bf16_f32 v170, v148, v149
    v_cvt_pk_bf16_f32 v171, v150, v151
    v_cvt_pk_bf16_f32 v172, v156, v157
    v_cvt_pk_bf16_f32 v173, v158, v159
    v_mov_b32 v174, 0
    v_mov_b32 v175, 0
    v_mov_b32 v16, 0
    v_mov_b32 v17, 0
    v_mov_b32 v18, 0
    v_mov_b32 v19, 0
    v_mov_b32 v20, 0
    v_mov_b32 v21, 0
    v_mov_b32 v22, 0
    v_mov_b32 v23, 0
    v_mov_b32 v24, 0
    v_mov_b32 v25, 0
    v_mov_b32 v26, 0
    v_mov_b32 v27, 0
    v_mov_b32 v28, 0
    v_mov_b32 v29, 0
    v_mov_b32 v30, 0
    v_mov_b32 v31, 0
    v_mov_b32 v32, 0
    v_mov_b32 v33, 0
    v_mov_b32 v34, 0
    v_mov_b32 v35, 0
    v_mov_b32 v36, 0
    v_mov_b32 v37, 0
    v_mov_b32 v38, 0
    v_mov_b32 v39, 0
    v_mov_b32 v40, 0
    v_mov_b32 v41, 0
    v_mov_b32 v42, 0
    v_mov_b32 v43, 0
    v_mov_b32 v44, 0
    v_mov_b32 v45, 0
    v_mov_b32 v46, 0
    v_mov_b32 v47, 0
    v_mov_b32 v48, 0
    v_mov_b32 v49, 0
    v_mov_b32 v50, 0
    v_mov_b32 v51, 0
    v_mov_b32 v52, 0
    v_mov_b32 v53, 0
    v_mov_b32 v54, 0
    v_mov_b32 v55, 0
    v_mov_b32 v56, 0
    v_mov_b32 v57, 0
    v_mov_b32 v58, 0
    v_mov_b32 v59, 0
    v_mov_b32 v60, 0
    v_mov_b32 v61, 0
    v_mov_b32 v62, 0
    v_mov_b32 v63, 0
    v_mov_b32 v64, 0
    v_mov_b32 v65, 0
    v_mov_b32 v66, 0
    v_mov_b32 v67, 0
    v_mov_b32 v68, 0
    v_mov_b32 v69, 0
    v_mov_b32 v70, 0
    v_mov_b32 v71, 0
    v_mov_b32 v72, 0
    v_mov_b32 v73, 0
    v_mov_b32 v74, 0
    v_mov_b32 v75, 0
    v_mov_b32 v76, 0
    v_mov_b32 v77, 0
    v_mov_b32 v78, 0
    v_mov_b32 v79, 0
    v_mov_b32 v80, 0
    v_mov_b32 v81, 0
    v_mov_b32 v82, 0
    v_mov_b32 v83, 0
    v_mov_b32 v84, 0
    v_mov_b32 v85, 0
    v_mov_b32 v86, 0
    v_mov_b32 v87, 0
    v_mov_b32 v88, 0
    v_mov_b32 v89, 0
    v_mov_b32 v90, 0
    v_mov_b32 v91, 0
    v_mov_b32 v92, 0
    v_mov_b32 v93, 0
    v_mov_b32 v94, 0
    v_mov_b32 v95, 0
    v_mov_b32 v96, 0
    v_mov_b32 v97, 0
    v_mov_b32 v98, 0
    v_mov_b32 v99, 0
    v_mov_b32 v100, 0
    v_mov_b32 v101, 0
    v_mov_b32 v102, 0
    v_mov_b32 v103, 0
    v_mov_b32 v104, 0
    v_mov_b32 v105, 0
    v_mov_b32 v106, 0
    v_mov_b32 v107, 0
    v_mov_b32 v108, 0
    v_mov_b32 v109, 0
    v_mov_b32 v110, 0
    v_mov_b32 v111, 0
    v_lshrrev_b32 v3, 2, v8
    v_add_u32 v3, v13, v3
    v_mul_u32_u24 v3, 416, v3
    v_and_b32 v4, 3, v1
    v_lshl_add_u32 v3, v4, 3, v3
    v_add_u32 v3, s57, v3
    s_waitcnt lgkmcnt(0)
    v_mov_b32 v118, 0
    v_mov_b32 v119, 0
    v_mov_b32 v126, 0
    v_mov_b32 v127, 0
    ds_read_b64_tr_b16 v[112:113], v3 offset:0
    ds_read_b64_tr_b16 v[114:115], v3 offset:6656
    ds_read_b64_tr_b16 v[116:117], v3 offset:13312
    s_waitcnt lgkmcnt(0)
    v_mfma_f32_16x16x32_bf16 v[16:19], v[112:115], v[160:163], v[16:19]
    v_mfma_f32_16x16x32_bf16 v[16:19], v[116:119], v[164:167], v[16:19]
    v_mfma_f32_16x16x32_bf16 v[20:23], v[112:115], v[168:171], v[20:23]
    v_mfma_f32_16x16x32_bf16 v[20:23], v[116:119], v[172:175], v[20:23]
    ds_read_b64_tr_b16 v[120:121], v3 offset:32
    ds_read_b64_tr_b16 v[122:123], v3 offset:6688
    ds_read_b64_tr_b16 v[124:125], v3 offset:13344
    s_waitcnt lgkmcnt(0)
    v_mfma_f32_16x16x32_bf16 v[24:27], v[120:123], v[160:163], v[24:27]
    v_mfma_f32_16x16x32_bf16 v[24:27], v[124:127], v[164:167], v[24:27]
    v_mfma_f32_16x16x32_bf16 v[28:31], v[120:123], v[168:171], v[28:31]
    v_mfma_f32_16x16x32_bf16 v[28:31], v[124:127], v[172:175], v[28:31]
    ds_read_b64_tr_b16 v[112:113], v3 offset:64
    ds_read_b64_tr_b16 v[114:115], v3 offset:6720
    ds_read_b64_tr_b16 v[116:117], v3 offset:13376
    s_waitcnt lgkmcnt(0)
    v_mfma_f32_16x16x32_bf16 v[32:35], v[112:115], v[160:163], v[32:35]
    v_mfma_f32_16x16x32_bf16 v[32:35], v[116:119], v[164:167], v[32:35]
    v_mfma_f32_16x16x32_bf16 v[36:39], v[112:115], v[168:171], v[36:39]
    v_mfma_f32_16x16x32_bf16 v[36:39], v[116:119], v[172:175], v[36:39]
    ds_read_b64_tr_b16 v[120:121], v3 offset:96
    ds_read_b64_tr_b16 v[122:123], v3 offset:6752
    ds_read_b64_tr_b16 v[124:125], v3 offset:13408
    s_waitcnt lgkmcnt(0)
    v_mfma_f32_16x16x32_bf16 v[40:43], v[120:123], v[160:163], v[40:43]
    v_mfma_f32_16x16x32_bf16 v[40:43], v[124:127], v[164:167], v[40:43]
    v_mfma_f32_16x16x32_bf16 v[44:47], v[120:123], v[168:171], v[44:47]
    v_mfma_f32_16x16x32_bf16 v[44:47], v[124:127], v[172:175], v[44:47]
    ds_read_b64_tr_b16 v[112:113], v3 offset:128
    ds_read_b64_tr_b16 v[114:115], v3 offset:6784
    ds_read_b64_tr_b16 v[116:117], v3 offset:13440
    s_waitcnt lgkmcnt(0)
    v_mfma_f32_16x16x32_bf16 v[48:51], v[112:115], v[160:163], v[48:51]
    v_mfma_f32_16x16x32_bf16 v[48:51], v[116:119], v[164:167], v[48:51]
    v_mfma_f32_16x16x32_bf16 v[52:55], v[112:115], v[168:171], v[52:55]
    v_mfma_f32_16x16x32_bf16 v[52:55], v[116:119], v[172:175], v[52:55]
    ds_read_b64_tr_b16 v[120:121], v3 offset:160
    ds_read_b64_tr_b16 v[122:123], v3 offset:6816
    ds_read_b64_tr_b16 v[124:125], v3 offset:13472
    s_waitcnt lgkmcnt(0)
    v_mfma_f32_16x16x32_bf16 v[56:59], v[120:123], v[160:163], v[56:59]
    v_mfma_f32_16x16x32_bf16 v[56:59], v[124:127], v[164:167], v[56:59]
    v_mfma_f32_16x16x32_bf16 v[60:63], v[120:123], v[168:171], v[60:63]
    v_mfma_f32_16x16x32_bf16 v[60:63], v[124:127], v[172:175], v[60:63]
    ds_read_b64_tr_b16 v[112:113], v3 offset:192
    ds_read_b64_tr_b16 v[114:115], v3 offset:6848
    ds_read_b64_tr_b16 v[116:117], v3 offset:13504
    s_waitcnt lgkmcnt(0)
    v_mfma_f32_16x16x32_bf16 v[64:67], v[112:115], v[160:163], v[64:67]
    v_mfma_f32_16x16x32_bf16 v[64:67], v[116:119], v[164:167], v[64:67]
    v_mfma_f32_16x16x32_bf16 v[68:71], v[112:115], v[168:171], v[68:71]
    v_mfma_f32_16x16x32_bf16 v[68:71], v[116:119], v[172:175], v[68:71]
    ds_read_b64_tr_b16 v[120:121], v3 offset:224
    ds_read_b64_tr_b16 v[122:123], v3 offset:6880
    ds_read_b64_tr_b16 v[124:125], v3 offset:13536
    s_waitcnt lgkmcnt(0)
    v_mfma_f32_16x16x32_bf16 v[72:75], v[120:123], v[160:163], v[72:75]
    v_mfma_f32_16x16x32_bf16 v[72:75], v[124:127], v[164:167], v[72:75]
    v_mfma_f32_16x16x32_bf16 v[76:79], v[120:123], v[168:171], v[76:79]
    v_mfma_f32_16x16x32_bf16 v[76:79], v[124:127], v[172:175], v[76:79]
    ds_read_b64_tr_b16 v[112:113], v3 offset:256
    ds_read_b64_tr_b16 v[114:115], v3 offset:6912
    ds_read_b64_tr_b16 v[116:117], v3 offset:13568
    s_waitcnt lgkmcnt(0)
    v_mfma_f32_16x16x32_bf16 v[80:83], v[112:115], v[160:163], v[80:83]
    v_mfma_f32_16x16x32_bf16 v[80:83], v[116:119], v[164:167], v[80:83]
    v_mfma_f32_16x16x32_bf16 v[84:87], v[112:115], v[168:171], v[84:87]
    v_mfma_f32_16x16x32_bf16 v[84:87], v[116:119], v[172:175], v[84:87]
    ds_read_b64_tr_b16 v[120:121], v3 offset:288
    ds_read_b64_tr_b16 v[122:123], v3 offset:6944
    ds_read_b64_tr_b16 v[124:125], v3 offset:13600
    s_waitcnt lgkmcnt(0)
    v_mfma_f32_16x16x32_bf16 v[88:91], v[120:123], v[160:163], v[88:91]
    v_mfma_f32_16x16x32_bf16 v[88:91], v[124:127], v[164:167], v[88:91]
    v_mfma_f32_16x16x32_bf16 v[92:95], v[120:123], v[168:171], v[92:95]
    v_mfma_f32_16x16x32_bf16 v[92:95], v[124:127], v[172:175], v[92:95]
    ds_read_b64_tr_b16 v[112:113], v3 offset:320
    ds_read_b64_tr_b16 v[114:115], v3 offset:6976
    ds_read_b64_tr_b16 v[116:117], v3 offset:13632
    s_waitcnt lgkmcnt(0)
    v_mfma_f32_16x16x32_bf16 v[96:99], v[112:115], v[160:163], v[96:99]
    v_mfma_f32_16x16x32_bf16 v[96:99], v[116:119], v[164:167], v[96:99]
    v_mfma_f32_16x16x32_bf16 v[100:103], v[112:115], v[168:171], v[100:103]
    v_mfma_f32_16x16x32_bf16 v[100:103], v[116:119], v[172:175], v[100:103]
    ds_read_b64_tr_b16 v[120:121], v3 offset:352
    ds_read_b64_tr_b16 v[122:123], v3 offset:7008
    ds_read_b64_tr_b16 v[124:125], v3 offset:13664
    s_waitcnt lgkmcnt(0)
    v_mfma_f32_16x16x32_bf16 v[104:107], v[120:123], v[160:163], v[104:107]
    v_mfma_f32_16x16x32_bf16 v[104:107], v[124:127], v[164:167], v[104:107]
    v_mfma_f32_16x16x32_bf16 v[108:111], v[120:123], v[168:171], v[108:111]
    v_mfma_f32_16x16x32_bf16 v[108:111], v[124:127], v[172:175], v[108:111]
    s_nop 7
    s_nop 1
    s_barrier
    v_mul_u32_u24 v10, 1552, v8
    v_lshl_add_u32 v11, v9, 4, v10
    v_lshl_add_u32 v10, v9, 3, v10
    s_mul_i32 s58, s64, 49664
    s_mul_i32 s59, s65, 384
    s_add_u32 s58, s58, s59
    v_add_u32 v10, s58, v10
    v_cvt_pk_bf16_f32 v128, v16, v17
    v_cvt_pk_bf16_f32 v129, v18, v19
    ds_write_b64 v10, v[128:129] offset:0
    v_cvt_pk_bf16_f32 v130, v20, v21
    v_cvt_pk_bf16_f32 v131, v22, v23
    ds_write_b64 v10, v[130:131] offset:24832
    v_cvt_pk_bf16_f32 v132, v24, v25
    v_cvt_pk_bf16_f32 v133, v26, v27
    ds_write_b64 v10, v[132:133] offset:32
    v_cvt_pk_bf16_f32 v134, v28, v29
    v_cvt_pk_bf16_f32 v135, v30, v31
    ds_write_b64 v10, v[134:135] offset:24864
    v_cvt_pk_bf16_f32 v128, v32, v33
    v_cvt_pk_bf16_f32 v129, v34, v35
    ds_write_b64 v10, v[128:129] offset:64
    v_cvt_pk_bf16_f32 v130, v36, v37
    v_cvt_pk_bf16_f32 v131, v38, v39
    ds_write_b64 v10, v[130:131] offset:24896
    v_cvt_pk_bf16_f32 v132, v40, v41
    v_cvt_pk_bf16_f32 v133, v42, v43
    ds_write_b64 v10, v[132:133] offset:96
    v_cvt_pk_bf16_f32 v134, v44, v45
    v_cvt_pk_bf16_f32 v135, v46, v47
    ds_write_b64 v10, v[134:135] offset:24928
    v_cvt_pk_bf16_f32 v128, v48, v49
    v_cvt_pk_bf16_f32 v129, v50, v51
    ds_write_b64 v10, v[128:129] offset:128
    v_cvt_pk_bf16_f32 v130, v52, v53
    v_cvt_pk_bf16_f32 v131, v54, v55
    ds_write_b64 v10, v[130:131] offset:24960
    v_cvt_pk_bf16_f32 v132, v56, v57
    v_cvt_pk_bf16_f32 v133, v58, v59
    ds_write_b64 v10, v[132:133] offset:160
    v_cvt_pk_bf16_f32 v134, v60, v61
    v_cvt_pk_bf16_f32 v135, v62, v63
    ds_write_b64 v10, v[134:135] offset:24992
    v_cvt_pk_bf16_f32 v128, v64, v65
    v_cvt_pk_bf16_f32 v129, v66, v67
    ds_write_b64 v10, v[128:129] offset:192
    v_cvt_pk_bf16_f32 v130, v68, v69
    v_cvt_pk_bf16_f32 v131, v70, v71
    ds_write_b64 v10, v[130:131] offset:25024
    v_cvt_pk_bf16_f32 v132, v72, v73
    v_cvt_pk_bf16_f32 v133, v74, v75
    ds_write_b64 v10, v[132:133] offset:224
    v_cvt_pk_bf16_f32 v134, v76, v77
    v_cvt_pk_bf16_f32 v135, v78, v79
    ds_write_b64 v10, v[134:135] offset:25056
    v_cvt_pk_bf16_f32 v128, v80, v81
    v_cvt_pk_bf16_f32 v129, v82, v83
    ds_write_b64 v10, v[128:129] offset:256
    v_cvt_pk_bf16_f32 v130, v84, v85
    v_cvt_pk_bf16_f32 v131, v86, v87
    ds_write_b64 v10, v[130:131] offset:25088
    v_cvt_pk_bf16_f32 v132, v88, v89
    v_cvt_pk_bf16_f32 v133, v90, v91
    ds_write_b64 v10, v[132:133] offset:288
    v_cvt_pk_bf16_f32 v134, v92, v93
    v_cvt_pk_bf16_f32 v135, v94, v95
    ds_write_b64 v10, v[134:135] offset:25120
    v_cvt_pk_bf16_f32 v128, v96, v97
    v_cvt_pk_bf16_f32 v129, v98, v99
    ds_write_b64 v10, v[128:129] offset:320
    v_cvt_pk_bf16_f32 v130, v100, v101
    v_cvt_pk_bf16_f32 v131, v102, v103
    ds_write_b64 v10, v[130:131] offset:25152
    v_cvt_pk_bf16_f32 v132, v104, v105
    v_cvt_pk_bf16_f32 v133, v106, v107
    ds_write_b64 v10, v[132:133] offset:352
    v_cvt_pk_bf16_f32 v134, v108, v109
    v_cvt_pk_bf16_f32 v135, v110, v111
    ds_write_b64 v10, v[134:135] offset:25184
    v_add_u32 v12, 49664, v11
    s_waitcnt lgkmcnt(0)
    s_barrier
    v_mul_u32_u24 v10, 2560, v8
    v_lshl_add_u32 v10, v9, 4, v10
    s_mul_i32 s58, s62, 5242880
    s_mul_i32 s59, s63, 163840
    s_add_u32 s58, s58, s59
    s_mul_i32 s59, s40, 320
    s_add_u32 s58, s58, s59
    s_add_u32 s58, s58, 150994944
    ds_read_b128 v[96:99], v11 offset:0
    ds_read_b128 v[100:103], v11 offset:24832
    ds_read_b128 v[104:107], v12 offset:0
    ds_read_b128 v[108:111], v12 offset:24832
    ds_read_b128 v[112:115], v11 offset:64
    ds_read_b128 v[116:119], v11 offset:24896
    ds_read_b128 v[120:123], v12 offset:64
    ds_read_b128 v[124:127], v12 offset:24896
    s_waitcnt vmcnt(15) lgkmcnt(4)
    v_mfma_f32_16x16x32_bf16 v[16:19], v[176:179], v[96:99], 0
    v_mfma_f32_16x16x32_bf16 v[20:23], v[176:179], v[100:103], 0
    v_mfma_f32_16x16x32_bf16 v[24:27], v[176:179], v[104:107], 0
    v_mfma_f32_16x16x32_bf16 v[28:31], v[176:179], v[108:111], 0
    v_mfma_f32_16x16x32_bf16 v[32:35], v[180:183], v[96:99], 0
    v_mfma_f32_16x16x32_bf16 v[36:39], v[180:183], v[100:103], 0
    v_mfma_f32_16x16x32_bf16 v[40:43], v[180:183], v[104:107], 0
    v_mfma_f32_16x16x32_bf16 v[44:47], v[180:183], v[108:111], 0
    v_mfma_f32_16x16x32_bf16 v[48:51], v[184:187], v[96:99], 0
    v_mfma_f32_16x16x32_bf16 v[52:55], v[184:187], v[100:103], 0
    v_mfma_f32_16x16x32_bf16 v[56:59], v[184:187], v[104:107], 0
    v_mfma_f32_16x16x32_bf16 v[60:63], v[184:187], v[108:111], 0
    v_mfma_f32_16x16x32_bf16 v[64:67], v[188:191], v[96:99], 0
    v_mfma_f32_16x16x32_bf16 v[68:71], v[188:191], v[100:103], 0
    v_mfma_f32_16x16x32_bf16 v[72:75], v[188:191], v[104:107], 0
    v_mfma_f32_16x16x32_bf16 v[76:79], v[188:191], v[108:111], 0
    v_mfma_f32_16x16x32_bf16 v[80:83], v[192:195], v[96:99], 0
    v_mfma_f32_16x16x32_bf16 v[84:87], v[192:195], v[100:103], 0
    v_mfma_f32_16x16x32_bf16 v[88:91], v[192:195], v[104:107], 0
    v_mfma_f32_16x16x32_bf16 v[92:95], v[192:195], v[108:111], 0
    s_add_u32 s67, s66, 163840
    buffer_load_dwordx4 v[176:179], v2, s[8:11], s67 offen
    s_add_u32 s67, s66, 164864
    buffer_load_dwordx4 v[180:183], v2, s[8:11], s67 offen
    s_add_u32 s67, s66, 165888
    buffer_load_dwordx4 v[184:187], v2, s[8:11], s67 offen
    s_add_u32 s67, s66, 166912
    buffer_load_dwordx4 v[188:191], v2, s[8:11], s67 offen
    s_add_u32 s67, s66, 167936
    buffer_load_dwordx4 v[192:195], v2, s[8:11], s67 offen
    ds_read_b128 v[96:99], v11 offset:128
    ds_read_b128 v[100:103], v11 offset:24960
    ds_read_b128 v[104:107], v12 offset:128
    ds_read_b128 v[108:111], v12 offset:24960
    s_waitcnt vmcnt(15) lgkmcnt(4)
    v_mfma_f32_16x16x32_bf16 v[16:19], v[196:199], v[112:115], v[16:19]
    v_mfma_f32_16x16x32_bf16 v[20:23], v[196:199], v[116:119], v[20:23]
    v_mfma_f32_16x16x32_bf16 v[24:27], v[196:199], v[120:123], v[24:27]
    v_mfma_f32_16x16x32_bf16 v[28:31], v[196:199], v[124:127], v[28:31]
    v_mfma_f32_16x16x32_bf16 v[32:35], v[200:203], v[112:115], v[32:35]
    v_mfma_f32_16x16x32_bf16 v[36:39], v[200:203], v[116:119], v[36:39]
    v_mfma_f32_16x16x32_bf16 v[40:43], v[200:203], v[120:123], v[40:43]
    v_mfma_f32_16x16x32_bf16 v[44:47], v[200:203], v[124:127], v[44:47]
    v_mfma_f32_16x16x32_bf16 v[48:51], v[204:207], v[112:115], v[48:51]
    v_mfma_f32_16x16x32_bf16 v[52:55], v[204:207], v[116:119], v[52:55]
    v_mfma_f32_16x16x32_bf16 v[56:59], v[204:207], v[120:123], v[56:59]
    v_mfma_f32_16x16x32_bf16 v[60:63], v[204:207], v[124:127], v[60:63]
    v_mfma_f32_16x16x32_bf16 v[64:67], v[208:211], v[112:115], v[64:67]
    v_mfma_f32_16x16x32_bf16 v[68:71], v[208:211], v[116:119], v[68:71]
    v_mfma_f32_16x16x32_bf16 v[72:75], v[208:211], v[120:123], v[72:75]
    v_mfma_f32_16x16x32_bf16 v[76:79], v[208:211], v[124:127], v[76:79]
    v_mfma_f32_16x16x32_bf16 v[80:83], v[212:215], v[112:115], v[80:83]
    v_mfma_f32_16x16x32_bf16 v[84:87], v[212:215], v[116:119], v[84:87]
    v_mfma_f32_16x16x32_bf16 v[88:91], v[212:215], v[120:123], v[88:91]
    v_mfma_f32_16x16x32_bf16 v[92:95], v[212:215], v[124:127], v[92:95]
    s_add_u32 s67, s66, 204800
    buffer_load_dwordx4 v[196:199], v2, s[8:11], s67 offen
    s_add_u32 s67, s66, 205824
    buffer_load_dwordx4 v[200:203], v2, s[8:11], s67 offen
    s_add_u32 s67, s66, 206848
    buffer_load_dwordx4 v[204:207], v2, s[8:11], s67 offen
    s_add_u32 s67, s66, 207872
    buffer_load_dwordx4 v[208:211], v2, s[8:11], s67 offen
    s_add_u32 s67, s66, 208896
    buffer_load_dwordx4 v[212:215], v2, s[8:11], s67 offen
    ds_read_b128 v[112:115], v11 offset:192
    ds_read_b128 v[116:119], v11 offset:25024
    ds_read_b128 v[120:123], v12 offset:192
    ds_read_b128 v[124:127], v12 offset:25024
    s_waitcnt vmcnt(15) lgkmcnt(4)
    v_mfma_f32_16x16x32_bf16 v[16:19], v[216:219], v[96:99], v[16:19]
    v_mfma_f32_16x16x32_bf16 v[20:23], v[216:219], v[100:103], v[20:23]
    v_mfma_f32_16x16x32_bf16 v[24:27], v[216:219], v[104:107], v[24:27]
    v_mfma_f32_16x16x32_bf16 v[28:31], v[216:219], v[108:111], v[28:31]
    v_mfma_f32_16x16x32_bf16 v[32:35], v[220:223], v[96:99], v[32:35]
    v_mfma_f32_16x16x32_bf16 v[36:39], v[220:223], v[100:103], v[36:39]
    v_mfma_f32_16x16x32_bf16 v[40:43], v[220:223], v[104:107], v[40:43]
    v_mfma_f32_16x16x32_bf16 v[44:47], v[220:223], v[108:111], v[44:47]
    v_mfma_f32_16x16x32_bf16 v[48:51], v[224:227], v[96:99], v[48:51]
    v_mfma_f32_16x16x32_bf16 v[52:55], v[224:227], v[100:103], v[52:55]
    v_mfma_f32_16x16x32_bf16 v[56:59], v[224:227], v[104:107], v[56:59]
    v_mfma_f32_16x16x32_bf16 v[60:63], v[224:227], v[108:111], v[60:63]
    v_mfma_f32_16x16x32_bf16 v[64:67], v[228:231], v[96:99], v[64:67]
    v_mfma_f32_16x16x32_bf16 v[68:71], v[228:231], v[100:103], v[68:71]
    v_mfma_f32_16x16x32_bf16 v[72:75], v[228:231], v[104:107], v[72:75]
    v_mfma_f32_16x16x32_bf16 v[76:79], v[228:231], v[108:111], v[76:79]
    v_mfma_f32_16x16x32_bf16 v[80:83], v[232:235], v[96:99], v[80:83]
    v_mfma_f32_16x16x32_bf16 v[84:87], v[232:235], v[100:103], v[84:87]
    v_mfma_f32_16x16x32_bf16 v[88:91], v[232:235], v[104:107], v[88:91]
    v_mfma_f32_16x16x32_bf16 v[92:95], v[232:235], v[108:111], v[92:95]
    s_add_u32 s67, s66, 245760
    buffer_load_dwordx4 v[216:219], v2, s[8:11], s67 offen
    s_add_u32 s67, s66, 246784
    buffer_load_dwordx4 v[220:223], v2, s[8:11], s67 offen
    s_add_u32 s67, s66, 247808
    buffer_load_dwordx4 v[224:227], v2, s[8:11], s67 offen
    s_add_u32 s67, s66, 248832
    buffer_load_dwordx4 v[228:231], v2, s[8:11], s67 offen
    s_add_u32 s67, s66, 249856
    buffer_load_dwordx4 v[232:235], v2, s[8:11], s67 offen
    ds_read_b128 v[96:99], v11 offset:256
    ds_read_b128 v[100:103], v11 offset:25088
    ds_read_b128 v[104:107], v12 offset:256
    ds_read_b128 v[108:111], v12 offset:25088
    s_waitcnt vmcnt(15) lgkmcnt(4)
    v_mfma_f32_16x16x32_bf16 v[16:19], v[236:239], v[112:115], v[16:19]
    v_mfma_f32_16x16x32_bf16 v[20:23], v[236:239], v[116:119], v[20:23]
    v_mfma_f32_16x16x32_bf16 v[24:27], v[236:239], v[120:123], v[24:27]
    v_mfma_f32_16x16x32_bf16 v[28:31], v[236:239], v[124:127], v[28:31]
    v_mfma_f32_16x16x32_bf16 v[32:35], v[240:243], v[112:115], v[32:35]
    v_mfma_f32_16x16x32_bf16 v[36:39], v[240:243], v[116:119], v[36:39]
    v_mfma_f32_16x16x32_bf16 v[40:43], v[240:243], v[120:123], v[40:43]
    v_mfma_f32_16x16x32_bf16 v[44:47], v[240:243], v[124:127], v[44:47]
    v_mfma_f32_16x16x32_bf16 v[48:51], v[244:247], v[112:115], v[48:51]
    v_mfma_f32_16x16x32_bf16 v[52:55], v[244:247], v[116:119], v[52:55]
    v_mfma_f32_16x16x32_bf16 v[56:59], v[244:247], v[120:123], v[56:59]
    v_mfma_f32_16x16x32_bf16 v[60:63], v[244:247], v[124:127], v[60:63]
    v_mfma_f32_16x16x32_bf16 v[64:67], v[248:251], v[112:115], v[64:67]
    v_mfma_f32_16x16x32_bf16 v[68:71], v[248:251], v[116:119], v[68:71]
    v_mfma_f32_16x16x32_bf16 v[72:75], v[248:251], v[120:123], v[72:75]
    v_mfma_f32_16x16x32_bf16 v[76:79], v[248:251], v[124:127], v[76:79]
    v_mfma_f32_16x16x32_bf16 v[80:83], v[252:255], v[112:115], v[80:83]
    v_mfma_f32_16x16x32_bf16 v[84:87], v[252:255], v[116:119], v[84:87]
    v_mfma_f32_16x16x32_bf16 v[88:91], v[252:255], v[120:123], v[88:91]
    v_mfma_f32_16x16x32_bf16 v[92:95], v[252:255], v[124:127], v[92:95]
    s_add_u32 s67, s66, 286720
    buffer_load_dwordx4 v[236:239], v2, s[8:11], s67 offen
    s_add_u32 s67, s66, 287744
    buffer_load_dwordx4 v[240:243], v2, s[8:11], s67 offen
    s_add_u32 s67, s66, 288768
    buffer_load_dwordx4 v[244:247], v2, s[8:11], s67 offen
    s_add_u32 s67, s66, 289792
    buffer_load_dwordx4 v[248:251], v2, s[8:11], s67 offen
    s_add_u32 s67, s66, 290816
    buffer_load_dwordx4 v[252:255], v2, s[8:11], s67 offen
    ds_read_b128 v[112:115], v11 offset:320
    ds_read_b128 v[116:119], v11 offset:25152
    ds_read_b128 v[120:123], v12 offset:320
    ds_read_b128 v[124:127], v12 offset:25152
    s_waitcnt vmcnt(15) lgkmcnt(4)
    v_mfma_f32_16x16x32_bf16 v[16:19], v[176:179], v[96:99], v[16:19]
    v_mfma_f32_16x16x32_bf16 v[20:23], v[176:179], v[100:103], v[20:23]
    v_mfma_f32_16x16x32_bf16 v[24:27], v[176:179], v[104:107], v[24:27]
    v_mfma_f32_16x16x32_bf16 v[28:31], v[176:179], v[108:111], v[28:31]
    v_mfma_f32_16x16x32_bf16 v[32:35], v[180:183], v[96:99], v[32:35]
    v_mfma_f32_16x16x32_bf16 v[36:39], v[180:183], v[100:103], v[36:39]
    v_mfma_f32_16x16x32_bf16 v[40:43], v[180:183], v[104:107], v[40:43]
    v_mfma_f32_16x16x32_bf16 v[44:47], v[180:183], v[108:111], v[44:47]
    v_mfma_f32_16x16x32_bf16 v[48:51], v[184:187], v[96:99], v[48:51]
    v_mfma_f32_16x16x32_bf16 v[52:55], v[184:187], v[100:103], v[52:55]
    v_mfma_f32_16x16x32_bf16 v[56:59], v[184:187], v[104:107], v[56:59]
    v_mfma_f32_16x16x32_bf16 v[60:63], v[184:187], v[108:111], v[60:63]
    v_mfma_f32_16x16x32_bf16 v[64:67], v[188:191], v[96:99], v[64:67]
    v_mfma_f32_16x16x32_bf16 v[68:71], v[188:191], v[100:103], v[68:71]
    v_mfma_f32_16x16x32_bf16 v[72:75], v[188:191], v[104:107], v[72:75]
    v_mfma_f32_16x16x32_bf16 v[76:79], v[188:191], v[108:111], v[76:79]
    v_mfma_f32_16x16x32_bf16 v[80:83], v[192:195], v[96:99], v[80:83]
    v_mfma_f32_16x16x32_bf16 v[84:87], v[192:195], v[100:103], v[84:87]
    v_mfma_f32_16x16x32_bf16 v[88:91], v[192:195], v[104:107], v[88:91]
    v_mfma_f32_16x16x32_bf16 v[92:95], v[192:195], v[108:111], v[92:95]
    s_add_u32 s67, s66, 327680
    buffer_load_dwordx4 v[176:179], v2, s[8:11], s67 offen
    s_add_u32 s67, s66, 328704
    buffer_load_dwordx4 v[180:183], v2, s[8:11], s67 offen
    s_add_u32 s67, s66, 329728
    buffer_load_dwordx4 v[184:187], v2, s[8:11], s67 offen
    s_add_u32 s67, s66, 330752
    buffer_load_dwordx4 v[188:191], v2, s[8:11], s67 offen
    s_add_u32 s67, s66, 331776
    buffer_load_dwordx4 v[192:195], v2, s[8:11], s67 offen
    ds_read_b128 v[96:99], v11 offset:384
    ds_read_b128 v[100:103], v11 offset:25216
    ds_read_b128 v[104:107], v12 offset:384
    ds_read_b128 v[108:111], v12 offset:25216
    s_waitcnt vmcnt(15) lgkmcnt(4)
    v_mfma_f32_16x16x32_bf16 v[16:19], v[196:199], v[112:115], v[16:19]
    v_mfma_f32_16x16x32_bf16 v[20:23], v[196:199], v[116:119], v[20:23]
    v_mfma_f32_16x16x32_bf16 v[24:27], v[196:199], v[120:123], v[24:27]
    v_mfma_f32_16x16x32_bf16 v[28:31], v[196:199], v[124:127], v[28:31]
    v_mfma_f32_16x16x32_bf16 v[32:35], v[200:203], v[112:115], v[32:35]
    v_mfma_f32_16x16x32_bf16 v[36:39], v[200:203], v[116:119], v[36:39]
    v_mfma_f32_16x16x32_bf16 v[40:43], v[200:203], v[120:123], v[40:43]
    v_mfma_f32_16x16x32_bf16 v[44:47], v[200:203], v[124:127], v[44:47]
    v_mfma_f32_16x16x32_bf16 v[48:51], v[204:207], v[112:115], v[48:51]
    v_mfma_f32_16x16x32_bf16 v[52:55], v[204:207], v[116:119], v[52:55]
    v_mfma_f32_16x16x32_bf16 v[56:59], v[204:207], v[120:123], v[56:59]
    v_mfma_f32_16x16x32_bf16 v[60:63], v[204:207], v[124:127], v[60:63]
    v_mfma_f32_16x16x32_bf16 v[64:67], v[208:211], v[112:115], v[64:67]
    v_mfma_f32_16x16x32_bf16 v[68:71], v[208:211], v[116:119], v[68:71]
    v_mfma_f32_16x16x32_bf16 v[72:75], v[208:211], v[120:123], v[72:75]
    v_mfma_f32_16x16x32_bf16 v[76:79], v[208:211], v[124:127], v[76:79]
    v_mfma_f32_16x16x32_bf16 v[80:83], v[212:215], v[112:115], v[80:83]
    v_mfma_f32_16x16x32_bf16 v[84:87], v[212:215], v[116:119], v[84:87]
    v_mfma_f32_16x16x32_bf16 v[88:91], v[212:215], v[120:123], v[88:91]
    v_mfma_f32_16x16x32_bf16 v[92:95], v[212:215], v[124:127], v[92:95]
    s_add_u32 s67, s66, 368640
    buffer_load_dwordx4 v[196:199], v2, s[8:11], s67 offen
    s_add_u32 s67, s66, 369664
    buffer_load_dwordx4 v[200:203], v2, s[8:11], s67 offen
    s_add_u32 s67, s66, 370688
    buffer_load_dwordx4 v[204:207], v2, s[8:11], s67 offen
    s_add_u32 s67, s66, 371712
    buffer_load_dwordx4 v[208:211], v2, s[8:11], s67 offen
    s_add_u32 s67, s66, 372736
    buffer_load_dwordx4 v[212:215], v2, s[8:11], s67 offen
    ds_read_b128 v[112:115], v11 offset:448
    ds_read_b128 v[116:119], v11 offset:25280
    ds_read_b128 v[120:123], v12 offset:448
    ds_read_b128 v[124:127], v12 offset:25280
    s_waitcnt vmcnt(15) lgkmcnt(4)
    v_mfma_f32_16x16x32_bf16 v[16:19], v[216:219], v[96:99], v[16:19]
    v_mfma_f32_16x16x32_bf16 v[20:23], v[216:219], v[100:103], v[20:23]
    v_mfma_f32_16x16x32_bf16 v[24:27], v[216:219], v[104:107], v[24:27]
    v_mfma_f32_16x16x32_bf16 v[28:31], v[216:219], v[108:111], v[28:31]
    v_mfma_f32_16x16x32_bf16 v[32:35], v[220:223], v[96:99], v[32:35]
    v_mfma_f32_16x16x32_bf16 v[36:39], v[220:223], v[100:103], v[36:39]
    v_mfma_f32_16x16x32_bf16 v[40:43], v[220:223], v[104:107], v[40:43]
    v_mfma_f32_16x16x32_bf16 v[44:47], v[220:223], v[108:111], v[44:47]
    v_mfma_f32_16x16x32_bf16 v[48:51], v[224:227], v[96:99], v[48:51]
    v_mfma_f32_16x16x32_bf16 v[52:55], v[224:227], v[100:103], v[52:55]
    v_mfma_f32_16x16x32_bf16 v[56:59], v[224:227], v[104:107], v[56:59]
    v_mfma_f32_16x16x32_bf16 v[60:63], v[224:227], v[108:111], v[60:63]
    v_mfma_f32_16x16x32_bf16 v[64:67], v[228:231], v[96:99], v[64:67]
    v_mfma_f32_16x16x32_bf16 v[68:71], v[228:231], v[100:103], v[68:71]
    v_mfma_f32_16x16x32_bf16 v[72:75], v[228:231], v[104:107], v[72:75]
    v_mfma_f32_16x16x32_bf16 v[76:79], v[228:231], v[108:111], v[76:79]
    v_mfma_f32_16x16x32_bf16 v[80:83], v[232:235], v[96:99], v[80:83]
    v_mfma_f32_16x16x32_bf16 v[84:87], v[232:235], v[100:103], v[84:87]
    v_mfma_f32_16x16x32_bf16 v[88:91], v[232:235], v[104:107], v[88:91]
    v_mfma_f32_16x16x32_bf16 v[92:95], v[232:235], v[108:111], v[92:95]
    s_add_u32 s67, s66, 409600
    buffer_load_dwordx4 v[216:219], v2, s[8:11], s67 offen
    s_add_u32 s67, s66, 410624
    buffer_load_dwordx4 v[220:223], v2, s[8:11], s67 offen
    s_add_u32 s67, s66, 411648
    buffer_load_dwordx4 v[224:227], v2, s[8:11], s67 offen
    s_add_u32 s67, s66, 412672
    buffer_load_dwordx4 v[228:231], v2, s[8:11], s67 offen
    s_add_u32 s67, s66, 413696
    buffer_load_dwordx4 v[232:235], v2, s[8:11], s67 offen
    ds_read_b128 v[96:99], v11 offset:512
    ds_read_b128 v[100:103], v11 offset:25344
    ds_read_b128 v[104:107], v12 offset:512
    ds_read_b128 v[108:111], v12 offset:25344
    s_waitcnt vmcnt(15) lgkmcnt(4)
    v_mfma_f32_16x16x32_bf16 v[16:19], v[236:239], v[112:115], v[16:19]
    v_mfma_f32_16x16x32_bf16 v[20:23], v[236:239], v[116:119], v[20:23]
    v_mfma_f32_16x16x32_bf16 v[24:27], v[236:239], v[120:123], v[24:27]
    v_mfma_f32_16x16x32_bf16 v[28:31], v[236:239], v[124:127], v[28:31]
    v_mfma_f32_16x16x32_bf16 v[32:35], v[240:243], v[112:115], v[32:35]
    v_mfma_f32_16x16x32_bf16 v[36:39], v[240:243], v[116:119], v[36:39]
    v_mfma_f32_16x16x32_bf16 v[40:43], v[240:243], v[120:123], v[40:43]
    v_mfma_f32_16x16x32_bf16 v[44:47], v[240:243], v[124:127], v[44:47]
    v_mfma_f32_16x16x32_bf16 v[48:51], v[244:247], v[112:115], v[48:51]
    v_mfma_f32_16x16x32_bf16 v[52:55], v[244:247], v[116:119], v[52:55]
    v_mfma_f32_16x16x32_bf16 v[56:59], v[244:247], v[120:123], v[56:59]
    v_mfma_f32_16x16x32_bf16 v[60:63], v[244:247], v[124:127], v[60:63]
    v_mfma_f32_16x16x32_bf16 v[64:67], v[248:251], v[112:115], v[64:67]
    v_mfma_f32_16x16x32_bf16 v[68:71], v[248:251], v[116:119], v[68:71]
    v_mfma_f32_16x16x32_bf16 v[72:75], v[248:251], v[120:123], v[72:75]
    v_mfma_f32_16x16x32_bf16 v[76:79], v[248:251], v[124:127], v[76:79]
    v_mfma_f32_16x16x32_bf16 v[80:83], v[252:255], v[112:115], v[80:83]
    v_mfma_f32_16x16x32_bf16 v[84:87], v[252:255], v[116:119], v[84:87]
    v_mfma_f32_16x16x32_bf16 v[88:91], v[252:255], v[120:123], v[88:91]
    v_mfma_f32_16x16x32_bf16 v[92:95], v[252:255], v[124:127], v[92:95]
    s_add_u32 s67, s66, 450560
    buffer_load_dwordx4 v[236:239], v2, s[8:11], s67 offen
    s_add_u32 s67, s66, 451584
    buffer_load_dwordx4 v[240:243], v2, s[8:11], s67 offen
    s_add_u32 s67, s66, 452608
    buffer_load_dwordx4 v[244:247], v2, s[8:11], s67 offen
    s_add_u32 s67, s66, 453632
    buffer_load_dwordx4 v[248:251], v2, s[8:11], s67 offen
    s_add_u32 s67, s66, 454656
    buffer_load_dwordx4 v[252:255], v2, s[8:11], s67 offen
    ds_read_b128 v[112:115], v11 offset:576
    ds_read_b128 v[116:119], v11 offset:25408
    ds_read_b128 v[120:123], v12 offset:576
    ds_read_b128 v[124:127], v12 offset:25408
    s_waitcnt vmcnt(15) lgkmcnt(4)
    v_mfma_f32_16x16x32_bf16 v[16:19], v[176:179], v[96:99], v[16:19]
    v_mfma_f32_16x16x32_bf16 v[20:23], v[176:179], v[100:103], v[20:23]
    v_mfma_f32_16x16x32_bf16 v[24:27], v[176:179], v[104:107], v[24:27]
    v_mfma_f32_16x16x32_bf16 v[28:31], v[176:179], v[108:111], v[28:31]
    v_mfma_f32_16x16x32_bf16 v[32:35], v[180:183], v[96:99], v[32:35]
    v_mfma_f32_16x16x32_bf16 v[36:39], v[180:183], v[100:103], v[36:39]
    v_mfma_f32_16x16x32_bf16 v[40:43], v[180:183], v[104:107], v[40:43]
    v_mfma_f32_16x16x32_bf16 v[44:47], v[180:183], v[108:111], v[44:47]
    v_mfma_f32_16x16x32_bf16 v[48:51], v[184:187], v[96:99], v[48:51]
    v_mfma_f32_16x16x32_bf16 v[52:55], v[184:187], v[100:103], v[52:55]
    v_mfma_f32_16x16x32_bf16 v[56:59], v[184:187], v[104:107], v[56:59]
    v_mfma_f32_16x16x32_bf16 v[60:63], v[184:187], v[108:111], v[60:63]
    v_mfma_f32_16x16x32_bf16 v[64:67], v[188:191], v[96:99], v[64:67]
    v_mfma_f32_16x16x32_bf16 v[68:71], v[188:191], v[100:103], v[68:71]
    v_mfma_f32_16x16x32_bf16 v[72:75], v[188:191], v[104:107], v[72:75]
    v_mfma_f32_16x16x32_bf16 v[76:79], v[188:191], v[108:111], v[76:79]
    v_mfma_f32_16x16x32_bf16 v[80:83], v[192:195], v[96:99], v[80:83]
    v_mfma_f32_16x16x32_bf16 v[84:87], v[192:195], v[100:103], v[84:87]
    v_mfma_f32_16x16x32_bf16 v[88:91], v[192:195], v[104:107], v[88:91]
    v_mfma_f32_16x16x32_bf16 v[92:95], v[192:195], v[108:111], v[92:95]
    s_add_u32 s67, s66, 491520
    buffer_load_dwordx4 v[176:179], v2, s[8:11], s67 offen
    s_add_u32 s67, s66, 492544
    buffer_load_dwordx4 v[180:183], v2, s[8:11], s67 offen
    s_add_u32 s67, s66, 493568
    buffer_load_dwordx4 v[184:187], v2, s[8:11], s67 offen
    s_add_u32 s67, s66, 494592
    buffer_load_dwordx4 v[188:191], v2, s[8:11], s67 offen
    s_add_u32 s67, s66, 495616
    buffer_load_dwordx4 v[192:195], v2, s[8:11], s67 offen
    ds_read_b128 v[96:99], v11 offset:640
    ds_read_b128 v[100:103], v11 offset:25472
    ds_read_b128 v[104:107], v12 offset:640
    ds_read_b128 v[108:111], v12 offset:25472
    s_waitcnt vmcnt(15) lgkmcnt(4)
    v_mfma_f32_16x16x32_bf16 v[16:19], v[196:199], v[112:115], v[16:19]
    v_mfma_f32_16x16x32_bf16 v[20:23], v[196:199], v[116:119], v[20:23]
    v_mfma_f32_16x16x32_bf16 v[24:27], v[196:199], v[120:123], v[24:27]
    v_mfma_f32_16x16x32_bf16 v[28:31], v[196:199], v[124:127], v[28:31]
    v_mfma_f32_16x16x32_bf16 v[32:35], v[200:203], v[112:115], v[32:35]
    v_mfma_f32_16x16x32_bf16 v[36:39], v[200:203], v[116:119], v[36:39]
    v_mfma_f32_16x16x32_bf16 v[40:43], v[200:203], v[120:123], v[40:43]
    v_mfma_f32_16x16x32_bf16 v[44:47], v[200:203], v[124:127], v[44:47]
    v_mfma_f32_16x16x32_bf16 v[48:51], v[204:207], v[112:115], v[48:51]
    v_mfma_f32_16x16x32_bf16 v[52:55], v[204:207], v[116:119], v[52:55]
    v_mfma_f32_16x16x32_bf16 v[56:59], v[204:207], v[120:123], v[56:59]
    v_mfma_f32_16x16x32_bf16 v[60:63], v[204:207], v[124:127], v[60:63]
    v_mfma_f32_16x16x32_bf16 v[64:67], v[208:211], v[112:115], v[64:67]
    v_mfma_f32_16x16x32_bf16 v[68:71], v[208:211], v[116:119], v[68:71]
    v_mfma_f32_16x16x32_bf16 v[72:75], v[208:211], v[120:123], v[72:75]
    v_mfma_f32_16x16x32_bf16 v[76:79], v[208:211], v[124:127], v[76:79]
    v_mfma_f32_16x16x32_bf16 v[80:83], v[212:215], v[112:115], v[80:83]
    v_mfma_f32_16x16x32_bf16 v[84:87], v[212:215], v[116:119], v[84:87]
    v_mfma_f32_16x16x32_bf16 v[88:91], v[212:215], v[120:123], v[88:91]
    v_mfma_f32_16x16x32_bf16 v[92:95], v[212:215], v[124:127], v[92:95]
    s_add_u32 s67, s66, 532480
    buffer_load_dwordx4 v[196:199], v2, s[8:11], s67 offen
    s_add_u32 s67, s66, 533504
    buffer_load_dwordx4 v[200:203], v2, s[8:11], s67 offen
    s_add_u32 s67, s66, 534528
    buffer_load_dwordx4 v[204:207], v2, s[8:11], s67 offen
    s_add_u32 s67, s66, 535552
    buffer_load_dwordx4 v[208:211], v2, s[8:11], s67 offen
    s_add_u32 s67, s66, 536576
    buffer_load_dwordx4 v[212:215], v2, s[8:11], s67 offen
    ds_read_b128 v[112:115], v11 offset:704
    ds_read_b128 v[116:119], v11 offset:25536
    ds_read_b128 v[120:123], v12 offset:704
    ds_read_b128 v[124:127], v12 offset:25536
    s_waitcnt vmcnt(15) lgkmcnt(4)
    v_mfma_f32_16x16x32_bf16 v[16:19], v[216:219], v[96:99], v[16:19]
    v_mfma_f32_16x16x32_bf16 v[20:23], v[216:219], v[100:103], v[20:23]
    v_mfma_f32_16x16x32_bf16 v[24:27], v[216:219], v[104:107], v[24:27]
    v_mfma_f32_16x16x32_bf16 v[28:31], v[216:219], v[108:111], v[28:31]
    v_mfma_f32_16x16x32_bf16 v[32:35], v[220:223], v[96:99], v[32:35]
    v_mfma_f32_16x16x32_bf16 v[36:39], v[220:223], v[100:103], v[36:39]
    v_mfma_f32_16x16x32_bf16 v[40:43], v[220:223], v[104:107], v[40:43]
    v_mfma_f32_16x16x32_bf16 v[44:47], v[220:223], v[108:111], v[44:47]
    v_mfma_f32_16x16x32_bf16 v[48:51], v[224:227], v[96:99], v[48:51]
    v_mfma_f32_16x16x32_bf16 v[52:55], v[224:227], v[100:103], v[52:55]
    v_mfma_f32_16x16x32_bf16 v[56:59], v[224:227], v[104:107], v[56:59]
    v_mfma_f32_16x16x32_bf16 v[60:63], v[224:227], v[108:111], v[60:63]
    v_mfma_f32_16x16x32_bf16 v[64:67], v[228:231], v[96:99], v[64:67]
    v_mfma_f32_16x16x32_bf16 v[68:71], v[228:231], v[100:103], v[68:71]
    v_mfma_f32_16x16x32_bf16 v[72:75], v[228:231], v[104:107], v[72:75]
    v_mfma_f32_16x16x32_bf16 v[76:79], v[228:231], v[108:111], v[76:79]
    v_mfma_f32_16x16x32_bf16 v[80:83], v[232:235], v[96:99], v[80:83]
    v_mfma_f32_16x16x32_bf16 v[84:87], v[232:235], v[100:103], v[84:87]
    v_mfma_f32_16x16x32_bf16 v[88:91], v[232:235], v[104:107], v[88:91]
    v_mfma_f32_16x16x32_bf16 v[92:95], v[232:235], v[108:111], v[92:95]
    s_add_u32 s67, s66, 573440
    buffer_load_dwordx4 v[216:219], v2, s[8:11], s67 offen
    s_add_u32 s67, s66, 574464
    buffer_load_dwordx4 v[220:223], v2, s[8:11], s67 offen
    s_add_u32 s67, s66, 575488
    buffer_load_dwordx4 v[224:227], v2, s[8:11], s67 offen
    s_add_u32 s67, s66, 576512
    buffer_load_dwordx4 v[228:231], v2, s[8:11], s67 offen
    s_add_u32 s67, s66, 577536
    buffer_load_dwordx4 v[232:235], v2, s[8:11], s67 offen
    ds_read_b128 v[96:99], v11 offset:768
    ds_read_b128 v[100:103], v11 offset:25600
    ds_read_b128 v[104:107], v12 offset:768
    ds_read_b128 v[108:111], v12 offset:25600
    s_waitcnt vmcnt(15) lgkmcnt(4)
    v_mfma_f32_16x16x32_bf16 v[16:19], v[236:239], v[112:115], v[16:19]
    v_mfma_f32_16x16x32_bf16 v[20:23], v[236:239], v[116:119], v[20:23]
    v_mfma_f32_16x16x32_bf16 v[24:27], v[236:239], v[120:123], v[24:27]
    v_mfma_f32_16x16x32_bf16 v[28:31], v[236:239], v[124:127], v[28:31]
    v_mfma_f32_16x16x32_bf16 v[32:35], v[240:243], v[112:115], v[32:35]
    v_mfma_f32_16x16x32_bf16 v[36:39], v[240:243], v[116:119], v[36:39]
    v_mfma_f32_16x16x32_bf16 v[40:43], v[240:243], v[120:123], v[40:43]
    v_mfma_f32_16x16x32_bf16 v[44:47], v[240:243], v[124:127], v[44:47]
    v_mfma_f32_16x16x32_bf16 v[48:51], v[244:247], v[112:115], v[48:51]
    v_mfma_f32_16x16x32_bf16 v[52:55], v[244:247], v[116:119], v[52:55]
    v_mfma_f32_16x16x32_bf16 v[56:59], v[244:247], v[120:123], v[56:59]
    v_mfma_f32_16x16x32_bf16 v[60:63], v[244:247], v[124:127], v[60:63]
    v_mfma_f32_16x16x32_bf16 v[64:67], v[248:251], v[112:115], v[64:67]
    v_mfma_f32_16x16x32_bf16 v[68:71], v[248:251], v[116:119], v[68:71]
    v_mfma_f32_16x16x32_bf16 v[72:75], v[248:251], v[120:123], v[72:75]
    v_mfma_f32_16x16x32_bf16 v[76:79], v[248:251], v[124:127], v[76:79]
    v_mfma_f32_16x16x32_bf16 v[80:83], v[252:255], v[112:115], v[80:83]
    v_mfma_f32_16x16x32_bf16 v[84:87], v[252:255], v[116:119], v[84:87]
    v_mfma_f32_16x16x32_bf16 v[88:91], v[252:255], v[120:123], v[88:91]
    v_mfma_f32_16x16x32_bf16 v[92:95], v[252:255], v[124:127], v[92:95]
    s_add_u32 s67, s66, 614400
    buffer_load_dwordx4 v[236:239], v2, s[8:11], s67 offen
    s_add_u32 s67, s66, 615424
    buffer_load_dwordx4 v[240:243], v2, s[8:11], s67 offen
    s_add_u32 s67, s66, 616448
    buffer_load_dwordx4 v[244:247], v2, s[8:11], s67 offen
    s_add_u32 s67, s66, 617472
    buffer_load_dwordx4 v[248:251], v2, s[8:11], s67 offen
    s_add_u32 s67, s66, 618496
    buffer_load_dwordx4 v[252:255], v2, s[8:11], s67 offen
    ds_read_b128 v[112:115], v11 offset:832
    ds_read_b128 v[116:119], v11 offset:25664
    ds_read_b128 v[120:123], v12 offset:832
    ds_read_b128 v[124:127], v12 offset:25664
    s_waitcnt vmcnt(15) lgkmcnt(4)
    v_mfma_f32_16x16x32_bf16 v[16:19], v[176:179], v[96:99], v[16:19]
    v_mfma_f32_16x16x32_bf16 v[20:23], v[176:179], v[100:103], v[20:23]
    v_mfma_f32_16x16x32_bf16 v[24:27], v[176:179], v[104:107], v[24:27]
    v_mfma_f32_16x16x32_bf16 v[28:31], v[176:179], v[108:111], v[28:31]
    v_mfma_f32_16x16x32_bf16 v[32:35], v[180:183], v[96:99], v[32:35]
    v_mfma_f32_16x16x32_bf16 v[36:39], v[180:183], v[100:103], v[36:39]
    v_mfma_f32_16x16x32_bf16 v[40:43], v[180:183], v[104:107], v[40:43]
    v_mfma_f32_16x16x32_bf16 v[44:47], v[180:183], v[108:111], v[44:47]
    v_mfma_f32_16x16x32_bf16 v[48:51], v[184:187], v[96:99], v[48:51]
    v_mfma_f32_16x16x32_bf16 v[52:55], v[184:187], v[100:103], v[52:55]
    v_mfma_f32_16x16x32_bf16 v[56:59], v[184:187], v[104:107], v[56:59]
    v_mfma_f32_16x16x32_bf16 v[60:63], v[184:187], v[108:111], v[60:63]
    v_mfma_f32_16x16x32_bf16 v[64:67], v[188:191], v[96:99], v[64:67]
    v_mfma_f32_16x16x32_bf16 v[68:71], v[188:191], v[100:103], v[68:71]
    v_mfma_f32_16x16x32_bf16 v[72:75], v[188:191], v[104:107], v[72:75]
    v_mfma_f32_16x16x32_bf16 v[76:79], v[188:191], v[108:111], v[76:79]
    v_mfma_f32_16x16x32_bf16 v[80:83], v[192:195], v[96:99], v[80:83]
    v_mfma_f32_16x16x32_bf16 v[84:87], v[192:195], v[100:103], v[84:87]
    v_mfma_f32_16x16x32_bf16 v[88:91], v[192:195], v[104:107], v[88:91]
    v_mfma_f32_16x16x32_bf16 v[92:95], v[192:195], v[108:111], v[92:95]
    s_add_u32 s67, s66, 655360
    buffer_load_dwordx4 v[176:179], v2, s[8:11], s67 offen
    s_add_u32 s67, s66, 656384
    buffer_load_dwordx4 v[180:183], v2, s[8:11], s67 offen
    s_add_u32 s67, s66, 657408
    buffer_load_dwordx4 v[184:187], v2, s[8:11], s67 offen
    s_add_u32 s67, s66, 658432
    buffer_load_dwordx4 v[188:191], v2, s[8:11], s67 offen
    s_add_u32 s67, s66, 659456
    buffer_load_dwordx4 v[192:195], v2, s[8:11], s67 offen
    ds_read_b128 v[96:99], v11 offset:896
    ds_read_b128 v[100:103], v11 offset:25728
    ds_read_b128 v[104:107], v12 offset:896
    ds_read_b128 v[108:111], v12 offset:25728
    s_waitcnt vmcnt(15) lgkmcnt(4)
    v_mfma_f32_16x16x32_bf16 v[16:19], v[196:199], v[112:115], v[16:19]
    v_mfma_f32_16x16x32_bf16 v[20:23], v[196:199], v[116:119], v[20:23]
    v_mfma_f32_16x16x32_bf16 v[24:27], v[196:199], v[120:123], v[24:27]
    v_mfma_f32_16x16x32_bf16 v[28:31], v[196:199], v[124:127], v[28:31]
    v_mfma_f32_16x16x32_bf16 v[32:35], v[200:203], v[112:115], v[32:35]
    v_mfma_f32_16x16x32_bf16 v[36:39], v[200:203], v[116:119], v[36:39]
    v_mfma_f32_16x16x32_bf16 v[40:43], v[200:203], v[120:123], v[40:43]
    v_mfma_f32_16x16x32_bf16 v[44:47], v[200:203], v[124:127], v[44:47]
    v_mfma_f32_16x16x32_bf16 v[48:51], v[204:207], v[112:115], v[48:51]
    v_mfma_f32_16x16x32_bf16 v[52:55], v[204:207], v[116:119], v[52:55]
    v_mfma_f32_16x16x32_bf16 v[56:59], v[204:207], v[120:123], v[56:59]
    v_mfma_f32_16x16x32_bf16 v[60:63], v[204:207], v[124:127], v[60:63]
    v_mfma_f32_16x16x32_bf16 v[64:67], v[208:211], v[112:115], v[64:67]
    v_mfma_f32_16x16x32_bf16 v[68:71], v[208:211], v[116:119], v[68:71]
    v_mfma_f32_16x16x32_bf16 v[72:75], v[208:211], v[120:123], v[72:75]
    v_mfma_f32_16x16x32_bf16 v[76:79], v[208:211], v[124:127], v[76:79]
    v_mfma_f32_16x16x32_bf16 v[80:83], v[212:215], v[112:115], v[80:83]
    v_mfma_f32_16x16x32_bf16 v[84:87], v[212:215], v[116:119], v[84:87]
    v_mfma_f32_16x16x32_bf16 v[88:91], v[212:215], v[120:123], v[88:91]
    v_mfma_f32_16x16x32_bf16 v[92:95], v[212:215], v[124:127], v[92:95]
    s_add_u32 s67, s66, 696320
    buffer_load_dwordx4 v[196:199], v2, s[8:11], s67 offen
    s_add_u32 s67, s66, 697344
    buffer_load_dwordx4 v[200:203], v2, s[8:11], s67 offen
    s_add_u32 s67, s66, 698368
    buffer_load_dwordx4 v[204:207], v2, s[8:11], s67 offen
    s_add_u32 s67, s66, 699392
    buffer_load_dwordx4 v[208:211], v2, s[8:11], s67 offen
    s_add_u32 s67, s66, 700416
    buffer_load_dwordx4 v[212:215], v2, s[8:11], s67 offen
    ds_read_b128 v[112:115], v11 offset:960
    ds_read_b128 v[116:119], v11 offset:25792
    ds_read_b128 v[120:123], v12 offset:960
    ds_read_b128 v[124:127], v12 offset:25792
    s_waitcnt vmcnt(15) lgkmcnt(4)
    v_mfma_f32_16x16x32_bf16 v[16:19], v[216:219], v[96:99], v[16:19]
    v_mfma_f32_16x16x32_bf16 v[20:23], v[216:219], v[100:103], v[20:23]
    v_mfma_f32_16x16x32_bf16 v[24:27], v[216:219], v[104:107], v[24:27]
    v_mfma_f32_16x16x32_bf16 v[28:31], v[216:219], v[108:111], v[28:31]
    v_mfma_f32_16x16x32_bf16 v[32:35], v[220:223], v[96:99], v[32:35]
    v_mfma_f32_16x16x32_bf16 v[36:39], v[220:223], v[100:103], v[36:39]
    v_mfma_f32_16x16x32_bf16 v[40:43], v[220:223], v[104:107], v[40:43]
    v_mfma_f32_16x16x32_bf16 v[44:47], v[220:223], v[108:111], v[44:47]
    v_mfma_f32_16x16x32_bf16 v[48:51], v[224:227], v[96:99], v[48:51]
    v_mfma_f32_16x16x32_bf16 v[52:55], v[224:227], v[100:103], v[52:55]
    v_mfma_f32_16x16x32_bf16 v[56:59], v[224:227], v[104:107], v[56:59]
    v_mfma_f32_16x16x32_bf16 v[60:63], v[224:227], v[108:111], v[60:63]
    v_mfma_f32_16x16x32_bf16 v[64:67], v[228:231], v[96:99], v[64:67]
    v_mfma_f32_16x16x32_bf16 v[68:71], v[228:231], v[100:103], v[68:71]
    v_mfma_f32_16x16x32_bf16 v[72:75], v[228:231], v[104:107], v[72:75]
    v_mfma_f32_16x16x32_bf16 v[76:79], v[228:231], v[108:111], v[76:79]
    v_mfma_f32_16x16x32_bf16 v[80:83], v[232:235], v[96:99], v[80:83]
    v_mfma_f32_16x16x32_bf16 v[84:87], v[232:235], v[100:103], v[84:87]
    v_mfma_f32_16x16x32_bf16 v[88:91], v[232:235], v[104:107], v[88:91]
    v_mfma_f32_16x16x32_bf16 v[92:95], v[232:235], v[108:111], v[92:95]
    s_add_u32 s67, s66, 737280
    buffer_load_dwordx4 v[216:219], v2, s[8:11], s67 offen
    s_add_u32 s67, s66, 738304
    buffer_load_dwordx4 v[220:223], v2, s[8:11], s67 offen
    s_add_u32 s67, s66, 739328
    buffer_load_dwordx4 v[224:227], v2, s[8:11], s67 offen
    s_add_u32 s67, s66, 740352
    buffer_load_dwordx4 v[228:231], v2, s[8:11], s67 offen
    s_add_u32 s67, s66, 741376
    buffer_load_dwordx4 v[232:235], v2, s[8:11], s67 offen
    ds_read_b128 v[96:99], v11 offset:1024
    ds_read_b128 v[100:103], v11 offset:25856
    ds_read_b128 v[104:107], v12 offset:1024
    ds_read_b128 v[108:111], v12 offset:25856
    s_waitcnt vmcnt(15) lgkmcnt(4)
    v_mfma_f32_16x16x32_bf16 v[16:19], v[236:239], v[112:115], v[16:19]
    v_mfma_f32_16x16x32_bf16 v[20:23], v[236:239], v[116:119], v[20:23]
    v_mfma_f32_16x16x32_bf16 v[24:27], v[236:239], v[120:123], v[24:27]
    v_mfma_f32_16x16x32_bf16 v[28:31], v[236:239], v[124:127], v[28:31]
    v_mfma_f32_16x16x32_bf16 v[32:35], v[240:243], v[112:115], v[32:35]
    v_mfma_f32_16x16x32_bf16 v[36:39], v[240:243], v[116:119], v[36:39]
    v_mfma_f32_16x16x32_bf16 v[40:43], v[240:243], v[120:123], v[40:43]
    v_mfma_f32_16x16x32_bf16 v[44:47], v[240:243], v[124:127], v[44:47]
    v_mfma_f32_16x16x32_bf16 v[48:51], v[244:247], v[112:115], v[48:51]
    v_mfma_f32_16x16x32_bf16 v[52:55], v[244:247], v[116:119], v[52:55]
    v_mfma_f32_16x16x32_bf16 v[56:59], v[244:247], v[120:123], v[56:59]
    v_mfma_f32_16x16x32_bf16 v[60:63], v[244:247], v[124:127], v[60:63]
    v_mfma_f32_16x16x32_bf16 v[64:67], v[248:251], v[112:115], v[64:67]
    v_mfma_f32_16x16x32_bf16 v[68:71], v[248:251], v[116:119], v[68:71]
    v_mfma_f32_16x16x32_bf16 v[72:75], v[248:251], v[120:123], v[72:75]
    v_mfma_f32_16x16x32_bf16 v[76:79], v[248:251], v[124:127], v[76:79]
    v_mfma_f32_16x16x32_bf16 v[80:83], v[252:255], v[112:115], v[80:83]
    v_mfma_f32_16x16x32_bf16 v[84:87], v[252:255], v[116:119], v[84:87]
    v_mfma_f32_16x16x32_bf16 v[88:91], v[252:255], v[120:123], v[88:91]
    v_mfma_f32_16x16x32_bf16 v[92:95], v[252:255], v[124:127], v[92:95]
    s_add_u32 s67, s66, 778240
    buffer_load_dwordx4 v[236:239], v2, s[8:11], s67 offen
    s_add_u32 s67, s66, 779264
    buffer_load_dwordx4 v[240:243], v2, s[8:11], s67 offen
    s_add_u32 s67, s66, 780288
    buffer_load_dwordx4 v[244:247], v2, s[8:11], s67 offen
    s_add_u32 s67, s66, 781312
    buffer_load_dwordx4 v[248:251], v2, s[8:11], s67 offen
    s_add_u32 s67, s66, 782336
    buffer_load_dwordx4 v[252:255], v2, s[8:11], s67 offen
    ds_read_b128 v[112:115], v11 offset:1088
    ds_read_b128 v[116:119], v11 offset:25920
    ds_read_b128 v[120:123], v12 offset:1088
    ds_read_b128 v[124:127], v12 offset:25920
    s_waitcnt vmcnt(15) lgkmcnt(4)
    v_mfma_f32_16x16x32_bf16 v[16:19], v[176:179], v[96:99], v[16:19]
    v_mfma_f32_16x16x32_bf16 v[20:23], v[176:179], v[100:103], v[20:23]
    v_mfma_f32_16x16x32_bf16 v[24:27], v[176:179], v[104:107], v[24:27]
    v_mfma_f32_16x16x32_bf16 v[28:31], v[176:179], v[108:111], v[28:31]
    v_mfma_f32_16x16x32_bf16 v[32:35], v[180:183], v[96:99], v[32:35]
    v_mfma_f32_16x16x32_bf16 v[36:39], v[180:183], v[100:103], v[36:39]
    v_mfma_f32_16x16x32_bf16 v[40:43], v[180:183], v[104:107], v[40:43]
    v_mfma_f32_16x16x32_bf16 v[44:47], v[180:183], v[108:111], v[44:47]
    v_mfma_f32_16x16x32_bf16 v[48:51], v[184:187], v[96:99], v[48:51]
    v_mfma_f32_16x16x32_bf16 v[52:55], v[184:187], v[100:103], v[52:55]
    v_mfma_f32_16x16x32_bf16 v[56:59], v[184:187], v[104:107], v[56:59]
    v_mfma_f32_16x16x32_bf16 v[60:63], v[184:187], v[108:111], v[60:63]
    v_mfma_f32_16x16x32_bf16 v[64:67], v[188:191], v[96:99], v[64:67]
    v_mfma_f32_16x16x32_bf16 v[68:71], v[188:191], v[100:103], v[68:71]
    v_mfma_f32_16x16x32_bf16 v[72:75], v[188:191], v[104:107], v[72:75]
    v_mfma_f32_16x16x32_bf16 v[76:79], v[188:191], v[108:111], v[76:79]
    v_mfma_f32_16x16x32_bf16 v[80:83], v[192:195], v[96:99], v[80:83]
    v_mfma_f32_16x16x32_bf16 v[84:87], v[192:195], v[100:103], v[84:87]
    v_mfma_f32_16x16x32_bf16 v[88:91], v[192:195], v[104:107], v[88:91]
    v_mfma_f32_16x16x32_bf16 v[92:95], v[192:195], v[108:111], v[92:95]
    s_add_u32 s67, s66, 819200
    buffer_load_dwordx4 v[176:179], v2, s[8:11], s67 offen
    s_add_u32 s67, s66, 820224
    buffer_load_dwordx4 v[180:183], v2, s[8:11], s67 offen
    s_add_u32 s67, s66, 821248
    buffer_load_dwordx4 v[184:187], v2, s[8:11], s67 offen
    s_add_u32 s67, s66, 822272
    buffer_load_dwordx4 v[188:191], v2, s[8:11], s67 offen
    s_add_u32 s67, s66, 823296
    buffer_load_dwordx4 v[192:195], v2, s[8:11], s67 offen
    ds_read_b128 v[96:99], v11 offset:1152
    ds_read_b128 v[100:103], v11 offset:25984
    ds_read_b128 v[104:107], v12 offset:1152
    ds_read_b128 v[108:111], v12 offset:25984
    s_waitcnt vmcnt(15) lgkmcnt(4)
    v_mfma_f32_16x16x32_bf16 v[16:19], v[196:199], v[112:115], v[16:19]
    v_mfma_f32_16x16x32_bf16 v[20:23], v[196:199], v[116:119], v[20:23]
    v_mfma_f32_16x16x32_bf16 v[24:27], v[196:199], v[120:123], v[24:27]
    v_mfma_f32_16x16x32_bf16 v[28:31], v[196:199], v[124:127], v[28:31]
    v_mfma_f32_16x16x32_bf16 v[32:35], v[200:203], v[112:115], v[32:35]
    v_mfma_f32_16x16x32_bf16 v[36:39], v[200:203], v[116:119], v[36:39]
    v_mfma_f32_16x16x32_bf16 v[40:43], v[200:203], v[120:123], v[40:43]
    v_mfma_f32_16x16x32_bf16 v[44:47], v[200:203], v[124:127], v[44:47]
    v_mfma_f32_16x16x32_bf16 v[48:51], v[204:207], v[112:115], v[48:51]
    v_mfma_f32_16x16x32_bf16 v[52:55], v[204:207], v[116:119], v[52:55]
    v_mfma_f32_16x16x32_bf16 v[56:59], v[204:207], v[120:123], v[56:59]
    v_mfma_f32_16x16x32_bf16 v[60:63], v[204:207], v[124:127], v[60:63]
    v_mfma_f32_16x16x32_bf16 v[64:67], v[208:211], v[112:115], v[64:67]
    v_mfma_f32_16x16x32_bf16 v[68:71], v[208:211], v[116:119], v[68:71]
    v_mfma_f32_16x16x32_bf16 v[72:75], v[208:211], v[120:123], v[72:75]
    v_mfma_f32_16x16x32_bf16 v[76:79], v[208:211], v[124:127], v[76:79]
    v_mfma_f32_16x16x32_bf16 v[80:83], v[212:215], v[112:115], v[80:83]
    v_mfma_f32_16x16x32_bf16 v[84:87], v[212:215], v[116:119], v[84:87]
    v_mfma_f32_16x16x32_bf16 v[88:91], v[212:215], v[120:123], v[88:91]
    v_mfma_f32_16x16x32_bf16 v[92:95], v[212:215], v[124:127], v[92:95]
    s_add_u32 s67, s66, 860160
    buffer_load_dwordx4 v[196:199], v2, s[8:11], s67 offen
    s_add_u32 s67, s66, 861184
    buffer_load_dwordx4 v[200:203], v2, s[8:11], s67 offen
    s_add_u32 s67, s66, 862208
    buffer_load_dwordx4 v[204:207], v2, s[8:11], s67 offen
    s_add_u32 s67, s66, 863232
    buffer_load_dwordx4 v[208:211], v2, s[8:11], s67 offen
    s_add_u32 s67, s66, 864256
    buffer_load_dwordx4 v[212:215], v2, s[8:11], s67 offen
    ds_read_b128 v[112:115], v11 offset:1216
    ds_read_b128 v[116:119], v11 offset:26048
    ds_read_b128 v[120:123], v12 offset:1216
    ds_read_b128 v[124:127], v12 offset:26048
    s_waitcnt vmcnt(15) lgkmcnt(4)
    v_mfma_f32_16x16x32_bf16 v[16:19], v[216:219], v[96:99], v[16:19]
    v_mfma_f32_16x16x32_bf16 v[20:23], v[216:219], v[100:103], v[20:23]
    v_mfma_f32_16x16x32_bf16 v[24:27], v[216:219], v[104:107], v[24:27]
    v_mfma_f32_16x16x32_bf16 v[28:31], v[216:219], v[108:111], v[28:31]
    v_mfma_f32_16x16x32_bf16 v[32:35], v[220:223], v[96:99], v[32:35]
    v_mfma_f32_16x16x32_bf16 v[36:39], v[220:223], v[100:103], v[36:39]
    v_mfma_f32_16x16x32_bf16 v[40:43], v[220:223], v[104:107], v[40:43]
    v_mfma_f32_16x16x32_bf16 v[44:47], v[220:223], v[108:111], v[44:47]
    v_mfma_f32_16x16x32_bf16 v[48:51], v[224:227], v[96:99], v[48:51]
    v_mfma_f32_16x16x32_bf16 v[52:55], v[224:227], v[100:103], v[52:55]
    v_mfma_f32_16x16x32_bf16 v[56:59], v[224:227], v[104:107], v[56:59]
    v_mfma_f32_16x16x32_bf16 v[60:63], v[224:227], v[108:111], v[60:63]
    v_mfma_f32_16x16x32_bf16 v[64:67], v[228:231], v[96:99], v[64:67]
    v_mfma_f32_16x16x32_bf16 v[68:71], v[228:231], v[100:103], v[68:71]
    v_mfma_f32_16x16x32_bf16 v[72:75], v[228:231], v[104:107], v[72:75]
    v_mfma_f32_16x16x32_bf16 v[76:79], v[228:231], v[108:111], v[76:79]
    v_mfma_f32_16x16x32_bf16 v[80:83], v[232:235], v[96:99], v[80:83]
    v_mfma_f32_16x16x32_bf16 v[84:87], v[232:235], v[100:103], v[84:87]
    v_mfma_f32_16x16x32_bf16 v[88:91], v[232:235], v[104:107], v[88:91]
    v_mfma_f32_16x16x32_bf16 v[92:95], v[232:235], v[108:111], v[92:95]
    s_add_u32 s67, s66, 901120
    buffer_load_dwordx4 v[216:219], v2, s[8:11], s67 offen
    s_add_u32 s67, s66, 902144
    buffer_load_dwordx4 v[220:223], v2, s[8:11], s67 offen
    s_add_u32 s67, s66, 903168
    buffer_load_dwordx4 v[224:227], v2, s[8:11], s67 offen
    s_add_u32 s67, s66, 904192
    buffer_load_dwordx4 v[228:231], v2, s[8:11], s67 offen
    s_add_u32 s67, s66, 905216
    buffer_load_dwordx4 v[232:235], v2, s[8:11], s67 offen
    ds_read_b128 v[96:99], v11 offset:1280
    ds_read_b128 v[100:103], v11 offset:26112
    ds_read_b128 v[104:107], v12 offset:1280
    ds_read_b128 v[108:111], v12 offset:26112
    s_waitcnt vmcnt(15) lgkmcnt(4)
    v_mfma_f32_16x16x32_bf16 v[16:19], v[236:239], v[112:115], v[16:19]
    v_mfma_f32_16x16x32_bf16 v[20:23], v[236:239], v[116:119], v[20:23]
    v_mfma_f32_16x16x32_bf16 v[24:27], v[236:239], v[120:123], v[24:27]
    v_mfma_f32_16x16x32_bf16 v[28:31], v[236:239], v[124:127], v[28:31]
    v_mfma_f32_16x16x32_bf16 v[32:35], v[240:243], v[112:115], v[32:35]
    v_mfma_f32_16x16x32_bf16 v[36:39], v[240:243], v[116:119], v[36:39]
    v_mfma_f32_16x16x32_bf16 v[40:43], v[240:243], v[120:123], v[40:43]
    v_mfma_f32_16x16x32_bf16 v[44:47], v[240:243], v[124:127], v[44:47]
    v_mfma_f32_16x16x32_bf16 v[48:51], v[244:247], v[112:115], v[48:51]
    v_mfma_f32_16x16x32_bf16 v[52:55], v[244:247], v[116:119], v[52:55]
    v_mfma_f32_16x16x32_bf16 v[56:59], v[244:247], v[120:123], v[56:59]
    v_mfma_f32_16x16x32_bf16 v[60:63], v[244:247], v[124:127], v[60:63]
    v_mfma_f32_16x16x32_bf16 v[64:67], v[248:251], v[112:115], v[64:67]
    v_mfma_f32_16x16x32_bf16 v[68:71], v[248:251], v[116:119], v[68:71]
    v_mfma_f32_16x16x32_bf16 v[72:75], v[248:251], v[120:123], v[72:75]
    v_mfma_f32_16x16x32_bf16 v[76:79], v[248:251], v[124:127], v[76:79]
    v_mfma_f32_16x16x32_bf16 v[80:83], v[252:255], v[112:115], v[80:83]
    v_mfma_f32_16x16x32_bf16 v[84:87], v[252:255], v[116:119], v[84:87]
    v_mfma_f32_16x16x32_bf16 v[88:91], v[252:255], v[120:123], v[88:91]
    v_mfma_f32_16x16x32_bf16 v[92:95], v[252:255], v[124:127], v[92:95]
    s_add_u32 s67, s66, 942080
    buffer_load_dwordx4 v[236:239], v2, s[8:11], s67 offen
    s_add_u32 s67, s66, 943104
    buffer_load_dwordx4 v[240:243], v2, s[8:11], s67 offen
    s_add_u32 s67, s66, 944128
    buffer_load_dwordx4 v[244:247], v2, s[8:11], s67 offen
    s_add_u32 s67, s66, 945152
    buffer_load_dwordx4 v[248:251], v2, s[8:11], s67 offen
    s_add_u32 s67, s66, 946176
    buffer_load_dwordx4 v[252:255], v2, s[8:11], s67 offen
    ds_read_b128 v[112:115], v11 offset:1344
    ds_read_b128 v[116:119], v11 offset:26176
    ds_read_b128 v[120:123], v12 offset:1344
    ds_read_b128 v[124:127], v12 offset:26176
    s_waitcnt vmcnt(15) lgkmcnt(4)
    v_mfma_f32_16x16x32_bf16 v[16:19], v[176:179], v[96:99], v[16:19]
    v_mfma_f32_16x16x32_bf16 v[20:23], v[176:179], v[100:103], v[20:23]
    v_mfma_f32_16x16x32_bf16 v[24:27], v[176:179], v[104:107], v[24:27]
    v_mfma_f32_16x16x32_bf16 v[28:31], v[176:179], v[108:111], v[28:31]
    v_mfma_f32_16x16x32_bf16 v[32:35], v[180:183], v[96:99], v[32:35]
    v_mfma_f32_16x16x32_bf16 v[36:39], v[180:183], v[100:103], v[36:39]
    v_mfma_f32_16x16x32_bf16 v[40:43], v[180:183], v[104:107], v[40:43]
    v_mfma_f32_16x16x32_bf16 v[44:47], v[180:183], v[108:111], v[44:47]
    v_mfma_f32_16x16x32_bf16 v[48:51], v[184:187], v[96:99], v[48:51]
    v_mfma_f32_16x16x32_bf16 v[52:55], v[184:187], v[100:103], v[52:55]
    v_mfma_f32_16x16x32_bf16 v[56:59], v[184:187], v[104:107], v[56:59]
    v_mfma_f32_16x16x32_bf16 v[60:63], v[184:187], v[108:111], v[60:63]
    v_mfma_f32_16x16x32_bf16 v[64:67], v[188:191], v[96:99], v[64:67]
    v_mfma_f32_16x16x32_bf16 v[68:71], v[188:191], v[100:103], v[68:71]
    v_mfma_f32_16x16x32_bf16 v[72:75], v[188:191], v[104:107], v[72:75]
    v_mfma_f32_16x16x32_bf16 v[76:79], v[188:191], v[108:111], v[76:79]
    v_mfma_f32_16x16x32_bf16 v[80:83], v[192:195], v[96:99], v[80:83]
    v_mfma_f32_16x16x32_bf16 v[84:87], v[192:195], v[100:103], v[84:87]
    v_mfma_f32_16x16x32_bf16 v[88:91], v[192:195], v[104:107], v[88:91]
    v_mfma_f32_16x16x32_bf16 v[92:95], v[192:195], v[108:111], v[92:95]
    ds_read_b128 v[96:99], v11 offset:1408
    ds_read_b128 v[100:103], v11 offset:26240
    ds_read_b128 v[104:107], v12 offset:1408
    ds_read_b128 v[108:111], v12 offset:26240
    s_waitcnt vmcnt(10) lgkmcnt(4)
    v_mfma_f32_16x16x32_bf16 v[16:19], v[196:199], v[112:115], v[16:19]
    v_mfma_f32_16x16x32_bf16 v[20:23], v[196:199], v[116:119], v[20:23]
    v_mfma_f32_16x16x32_bf16 v[24:27], v[196:199], v[120:123], v[24:27]
    v_mfma_f32_16x16x32_bf16 v[28:31], v[196:199], v[124:127], v[28:31]
    v_mfma_f32_16x16x32_bf16 v[32:35], v[200:203], v[112:115], v[32:35]
    v_mfma_f32_16x16x32_bf16 v[36:39], v[200:203], v[116:119], v[36:39]
    v_mfma_f32_16x16x32_bf16 v[40:43], v[200:203], v[120:123], v[40:43]
    v_mfma_f32_16x16x32_bf16 v[44:47], v[200:203], v[124:127], v[44:47]
    v_mfma_f32_16x16x32_bf16 v[48:51], v[204:207], v[112:115], v[48:51]
    v_mfma_f32_16x16x32_bf16 v[52:55], v[204:207], v[116:119], v[52:55]
    v_mfma_f32_16x16x32_bf16 v[56:59], v[204:207], v[120:123], v[56:59]
    v_mfma_f32_16x16x32_bf16 v[60:63], v[204:207], v[124:127], v[60:63]
    v_mfma_f32_16x16x32_bf16 v[64:67], v[208:211], v[112:115], v[64:67]
    v_mfma_f32_16x16x32_bf16 v[68:71], v[208:211], v[116:119], v[68:71]
    v_mfma_f32_16x16x32_bf16 v[72:75], v[208:211], v[120:123], v[72:75]
    v_mfma_f32_16x16x32_bf16 v[76:79], v[208:211], v[124:127], v[76:79]
    v_mfma_f32_16x16x32_bf16 v[80:83], v[212:215], v[112:115], v[80:83]
    v_mfma_f32_16x16x32_bf16 v[84:87], v[212:215], v[116:119], v[84:87]
    v_mfma_f32_16x16x32_bf16 v[88:91], v[212:215], v[120:123], v[88:91]
    v_mfma_f32_16x16x32_bf16 v[92:95], v[212:215], v[124:127], v[92:95]
    ds_read_b128 v[112:115], v11 offset:1472
    ds_read_b128 v[116:119], v11 offset:26304
    ds_read_b128 v[120:123], v12 offset:1472
    ds_read_b128 v[124:127], v12 offset:26304
    s_waitcnt vmcnt(5) lgkmcnt(4)
    v_mfma_f32_16x16x32_bf16 v[16:19], v[216:219], v[96:99], v[16:19]
    v_mfma_f32_16x16x32_bf16 v[20:23], v[216:219], v[100:103], v[20:23]
    v_mfma_f32_16x16x32_bf16 v[24:27], v[216:219], v[104:107], v[24:27]
    v_mfma_f32_16x16x32_bf16 v[28:31], v[216:219], v[108:111], v[28:31]
    v_mfma_f32_16x16x32_bf16 v[32:35], v[220:223], v[96:99], v[32:35]
    v_mfma_f32_16x16x32_bf16 v[36:39], v[220:223], v[100:103], v[36:39]
    v_mfma_f32_16x16x32_bf16 v[40:43], v[220:223], v[104:107], v[40:43]
    v_mfma_f32_16x16x32_bf16 v[44:47], v[220:223], v[108:111], v[44:47]
    v_mfma_f32_16x16x32_bf16 v[48:51], v[224:227], v[96:99], v[48:51]
    v_mfma_f32_16x16x32_bf16 v[52:55], v[224:227], v[100:103], v[52:55]
    v_mfma_f32_16x16x32_bf16 v[56:59], v[224:227], v[104:107], v[56:59]
    v_mfma_f32_16x16x32_bf16 v[60:63], v[224:227], v[108:111], v[60:63]
    v_mfma_f32_16x16x32_bf16 v[64:67], v[228:231], v[96:99], v[64:67]
    v_mfma_f32_16x16x32_bf16 v[68:71], v[228:231], v[100:103], v[68:71]
    v_mfma_f32_16x16x32_bf16 v[72:75], v[228:231], v[104:107], v[72:75]
    v_mfma_f32_16x16x32_bf16 v[76:79], v[228:231], v[108:111], v[76:79]
    v_mfma_f32_16x16x32_bf16 v[80:83], v[232:235], v[96:99], v[80:83]
    v_mfma_f32_16x16x32_bf16 v[84:87], v[232:235], v[100:103], v[84:87]
    v_mfma_f32_16x16x32_bf16 v[88:91], v[232:235], v[104:107], v[88:91]
    v_mfma_f32_16x16x32_bf16 v[92:95], v[232:235], v[108:111], v[92:95]
    s_waitcnt vmcnt(0) lgkmcnt(0)
    v_mfma_f32_16x16x32_bf16 v[16:19], v[236:239], v[112:115], v[16:19]
    v_mfma_f32_16x16x32_bf16 v[20:23], v[236:239], v[116:119], v[20:23]
    v_mfma_f32_16x16x32_bf16 v[24:27], v[236:239], v[120:123], v[24:27]
    v_mfma_f32_16x16x32_bf16 v[28:31], v[236:239], v[124:127], v[28:31]
    v_mfma_f32_16x16x32_bf16 v[32:35], v[240:243], v[112:115], v[32:35]
    v_mfma_f32_16x16x32_bf16 v[36:39], v[240:243], v[116:119], v[36:39]
    v_mfma_f32_16x16x32_bf16 v[40:43], v[240:243], v[120:123], v[40:43]
    v_mfma_f32_16x16x32_bf16 v[44:47], v[240:243], v[124:127], v[44:47]
    v_mfma_f32_16x16x32_bf16 v[48:51], v[244:247], v[112:115], v[48:51]
    v_mfma_f32_16x16x32_bf16 v[52:55], v[244:247], v[116:119], v[52:55]
    v_mfma_f32_16x16x32_bf16 v[56:59], v[244:247], v[120:123], v[56:59]
    v_mfma_f32_16x16x32_bf16 v[60:63], v[244:247], v[124:127], v[60:63]
    v_mfma_f32_16x16x32_bf16 v[64:67], v[248:251], v[112:115], v[64:67]
    v_mfma_f32_16x16x32_bf16 v[68:71], v[248:251], v[116:119], v[68:71]
    v_mfma_f32_16x16x32_bf16 v[72:75], v[248:251], v[120:123], v[72:75]
    v_mfma_f32_16x16x32_bf16 v[76:79], v[248:251], v[124:127], v[76:79]
    v_mfma_f32_16x16x32_bf16 v[80:83], v[252:255], v[112:115], v[80:83]
    v_mfma_f32_16x16x32_bf16 v[84:87], v[252:255], v[116:119], v[84:87]
    v_mfma_f32_16x16x32_bf16 v[88:91], v[252:255], v[120:123], v[88:91]
    v_mfma_f32_16x16x32_bf16 v[92:95], v[252:255], v[124:127], v[92:95]
    s_nop 7
    s_nop 7
    s_add_u32 s59, s58, 0
    buffer_store_dwordx4 v[16:19], v10, s[8:11], s59 offen offset:0 sc1
    s_add_u32 s59, s58, 0
    buffer_store_dwordx4 v[32:35], v10, s[8:11], s59 offen offset:64 sc1
    s_add_u32 s59, s58, 0
    buffer_store_dwordx4 v[48:51], v10, s[8:11], s59 offen offset:128 sc1
    s_add_u32 s59, s58, 0
    buffer_store_dwordx4 v[64:67], v10, s[8:11], s59 offen offset:192 sc1
    s_add_u32 s59, s58, 0
    buffer_store_dwordx4 v[80:83], v10, s[8:11], s59 offen offset:256 sc1
    s_add_u32 s59, s58, 40960
    buffer_store_dwordx4 v[20:23], v10, s[8:11], s59 offen offset:0 sc1
    s_add_u32 s59, s58, 40960
    buffer_store_dwordx4 v[36:39], v10, s[8:11], s59 offen offset:64 sc1
    s_add_u32 s59, s58, 40960
    buffer_store_dwordx4 v[52:55], v10, s[8:11], s59 offen offset:128 sc1
    s_add_u32 s59, s58, 40960
    buffer_store_dwordx4 v[68:71], v10, s[8:11], s59 offen offset:192 sc1
    s_add_u32 s59, s58, 40960
    buffer_store_dwordx4 v[84:87], v10, s[8:11], s59 offen offset:256 sc1
    s_add_u32 s59, s58, 81920
    buffer_store_dwordx4 v[24:27], v10, s[8:11], s59 offen offset:0 sc1
    s_add_u32 s59, s58, 81920
    buffer_store_dwordx4 v[40:43], v10, s[8:11], s59 offen offset:64 sc1
    s_add_u32 s59, s58, 81920
    buffer_store_dwordx4 v[56:59], v10, s[8:11], s59 offen offset:128 sc1
    s_add_u32 s59, s58, 81920
    buffer_store_dwordx4 v[72:75], v10, s[8:11], s59 offen offset:192 sc1
    s_add_u32 s59, s58, 81920
    buffer_store_dwordx4 v[88:91], v10, s[8:11], s59 offen offset:256 sc1
    s_add_u32 s59, s58, 122880
    buffer_store_dwordx4 v[28:31], v10, s[8:11], s59 offen offset:0 sc1
    s_add_u32 s59, s58, 122880
    buffer_store_dwordx4 v[44:47], v10, s[8:11], s59 offen offset:64 sc1
    s_add_u32 s59, s58, 122880
    buffer_store_dwordx4 v[60:63], v10, s[8:11], s59 offen offset:128 sc1
    s_add_u32 s59, s58, 122880
    buffer_store_dwordx4 v[76:79], v10, s[8:11], s59 offen offset:192 sc1
    s_add_u32 s59, s58, 122880
    buffer_store_dwordx4 v[92:95], v10, s[8:11], s59 offen offset:256 sc1
    s_load_dwordx2 s[4:5], s[0:1], 88
    s_load_dwordx2 s[74:75], s[0:1], 0
    s_lshl_b32 s70, s63, 9
    s_add_u32 s70, s70, 135921664
    s_waitcnt vmcnt(0)
    s_barrier
    s_cmp_lg_u32 s40, 0
    s_cbranch_scc1 L_nosig_78
    v_mov_b32 v3, 1
    v_mov_b32 v4, 0
    s_mov_b64 exec, 1
    buffer_atomic_add v3, v4, s[8:11], s70 offen
    s_mov_b64 exec, -1
L_nosig_78:
    s_waitcnt lgkmcnt(0)
    s_mov_b32 s12, s4
    s_and_b32 s13, s5, 0xffff
    s_mov_b32 s14, 2621440
    s_mov_b32 s15, 0x20000
    s_mov_b32 s76, s74
    s_and_b32 s77, s75, 0xffff
    s_mov_b32 s78, 2621440
    s_mov_b32 s79, 0x20000
    s_cmp_lg_u32 s40, 0
    s_cbranch_scc1 L_gws_79
    v_mov_b32 v4, 0
    s_mov_b32 s71, 0
L_gwp_80:
    s_mov_b64 exec, 1
    buffer_load_dword v3, v4, s[8:11], s70 offen sc1
    s_mov_b64 exec, -1
    s_waitcnt vmcnt(0)
    v_readfirstlane_b32 s72, v3
    s_cmp_ge_u32 s72, 8
    s_cbranch_scc1 L_gws_79
    s_sleep 2
    s_add_u32 s71, s71, 1
    s_cmp_lt_u32 s71, 1048576
    s_cbranch_scc1 L_gwp_80
L_gws_79:
    s_barrier
    s_lshl_b32 s41, s63, 6
    s_lshl_b32 s42, s62, 3
    s_add_u32 s41, s41, s42
    s_add_u32 s41, s41, s40
    s_mul_i32 s41, s41, 1280
    v_lshlrev_b32 v3, 2, v1
    v_add_u32 v3, s41, v3
    s_mov_b32 s16, 0
    s_mov_b32 s17, 121634816
    buffer_load_dword v4, v3, s[76:79], s16 offen offset:0
    buffer_load_dword v5, v3, s[76:79], s16 offen offset:256
    buffer_load_dword v6, v3, s[76:79], s16 offen offset:512
    buffer_load_dword v7, v3, s[76:79], s16 offen offset:768
    buffer_load_dword v8, v3, s[76:79], s16 offen offset:1024
    v_lshlrev_b32 v40, 1, v3
    s_mov_b32 s18, 150994944
    buffer_load_dwordx2 v[48:49], v40, s[8:11], s18 offen offset:0 sc1
    buffer_load_dwordx2 v[50:51], v40, s[8:11], s18 offen offset:512 sc1
    buffer_load_dwordx2 v[52:53], v40, s[8:11], s18 offen offset:1024 sc1
    buffer_load_dwordx2 v[54:55], v40, s[8:11], s18 offen offset:1536 sc1
    buffer_load_dwordx2 v[56:57], v40, s[8:11], s18 offen offset:2048 sc1
    s_add_u32 s18, s18, 5242880
    buffer_load_dwordx2 v[58:59], v40, s[8:11], s18 offen offset:0 sc1
    buffer_load_dwordx2 v[60:61], v40, s[8:11], s18 offen offset:512 sc1
    buffer_load_dwordx2 v[62:63], v40, s[8:11], s18 offen offset:1024 sc1
    buffer_load_dwordx2 v[64:65], v40, s[8:11], s18 offen offset:1536 sc1
    buffer_load_dwordx2 v[66:67], v40, s[8:11], s18 offen offset:2048 sc1
    s_add_u32 s18, s18, 5242880
    buffer_load_dwordx2 v[68:69], v40, s[8:11], s18 offen offset:0 sc1
    buffer_load_dwordx2 v[70:71], v40, s[8:11], s18 offen offset:512 sc1
    buffer_load_dwordx2 v[72:73], v40, s[8:11], s18 offen offset:1024 sc1
    buffer_load_dwordx2 v[74:75], v40, s[8:11], s18 offen offset:1536 sc1
    buffer_load_dwordx2 v[76:77], v40, s[8:11], s18 offen offset:2048 sc1
    s_add_u32 s18, s18, 5242880
    buffer_load_dwordx2 v[78:79], v40, s[8:11], s18 offen offset:0 sc1
    buffer_load_dwordx2 v[80:81], v40, s[8:11], s18 offen offset:512 sc1
    buffer_load_dwordx2 v[82:83], v40, s[8:11], s18 offen offset:1024 sc1
    buffer_load_dwordx2 v[84:85], v40, s[8:11], s18 offen offset:1536 sc1
    buffer_load_dwordx2 v[86:87], v40, s[8:11], s18 offen offset:2048 sc1
    s_add_u32 s18, s18, 5242880
    buffer_load_dwordx2 v[88:89], v40, s[8:11], s18 offen offset:0 sc1
    buffer_load_dwordx2 v[90:91], v40, s[8:11], s18 offen offset:512 sc1
    buffer_load_dwordx2 v[92:93], v40, s[8:11], s18 offen offset:1024 sc1
    buffer_load_dwordx2 v[94:95], v40, s[8:11], s18 offen offset:1536 sc1
    buffer_load_dwordx2 v[96:97], v40, s[8:11], s18 offen offset:2048 sc1
    s_add_u32 s18, s18, 5242880
    buffer_load_dwordx2 v[98:99], v40, s[8:11], s18 offen offset:0 sc1
    buffer_load_dwordx2 v[100:101], v40, s[8:11], s18 offen offset:512 sc1
    buffer_load_dwordx2 v[102:103], v40, s[8:11], s18 offen offset:1024 sc1
    buffer_load_dwordx2 v[104:105], v40, s[8:11], s18 offen offset:1536 sc1
    buffer_load_dwordx2 v[106:107], v40, s[8:11], s18 offen offset:2048 sc1
    s_add_u32 s18, s18, 5242880
    buffer_load_dwordx2 v[108:109], v40, s[8:11], s18 offen offset:0 sc1
    buffer_load_dwordx2 v[110:111], v40, s[8:11], s18 offen offset:512 sc1
    buffer_load_dwordx2 v[112:113], v40, s[8:11], s18 offen offset:1024 sc1
    buffer_load_dwordx2 v[114:115], v40, s[8:11], s18 offen offset:1536 sc1
    buffer_load_dwordx2 v[116:117], v40, s[8:11], s18 offen offset:2048 sc1
    s_add_u32 s18, s18, 5242880
    buffer_load_dwordx2 v[118:119], v40, s[8:11], s18 offen offset:0 sc1
    buffer_load_dwordx2 v[120:121], v40, s[8:11], s18 offen offset:512 sc1
    buffer_load_dwordx2 v[122:123], v40, s[8:11], s18 offen offset:1024 sc1
    buffer_load_dwordx2 v[124:125], v40, s[8:11], s18 offen offset:1536 sc1
    buffer_load_dwordx2 v[126:127], v40, s[8:11], s18 offen offset:2048 sc1
    s_waitcnt vmcnt(0)
    v_add_f32 v48, v48, v58
    v_add_f32 v49, v49, v59
    v_add_f32 v50, v50, v60
    v_add_f32 v51, v51, v61
    v_add_f32 v52, v52, v62
    v_add_f32 v53, v53, v63
    v_add_f32 v54, v54, v64
    v_add_f32 v55, v55, v65
    v_add_f32 v56, v56, v66
    v_add_f32 v57, v57, v67
    v_add_f32 v48, v48, v68
    v_add_f32 v49, v49, v69
    v_add_f32 v50, v50, v70
    v_add_f32 v51, v51, v71
    v_add_f32 v52, v52, v72
    v_add_f32 v53, v53, v73
    v_add_f32 v54, v54, v74
    v_add_f32 v55, v55, v75
    v_add_f32 v56, v56, v76
    v_add_f32 v57, v57, v77
    v_add_f32 v48, v48, v78
    v_add_f32 v49, v49, v79
    v_add_f32 v50, v50, v80
    v_add_f32 v51, v51, v81
    v_add_f32 v52, v52, v82
    v_add_f32 v53, v53, v83
    v_add_f32 v54, v54, v84
    v_add_f32 v55, v55, v85
    v_add_f32 v56, v56, v86
    v_add_f32 v57, v57, v87
    v_add_f32 v48, v48, v88
    v_add_f32 v49, v49, v89
    v_add_f32 v50, v50, v90
    v_add_f32 v51, v51, v91
    v_add_f32 v52, v52, v92
    v_add_f32 v53, v53, v93
    v_add_f32 v54, v54, v94
    v_add_f32 v55, v55, v95
    v_add_f32 v56, v56, v96
    v_add_f32 v57, v57, v97
    v_add_f32 v48, v48, v98
    v_add_f32 v49, v49, v99
    v_add_f32 v50, v50, v100
    v_add_f32 v51, v51, v101
    v_add_f32 v52, v52, v102
    v_add_f32 v53, v53, v103
    v_add_f32 v54, v54, v104
    v_add_f32 v55, v55, v105
    v_add_f32 v56, v56, v106
    v_add_f32 v57, v57, v107
    v_add_f32 v48, v48, v108
    v_add_f32 v49, v49, v109
    v_add_f32 v50, v50, v110
    v_add_f32 v51, v51, v111
    v_add_f32 v52, v52, v112
    v_add_f32 v53, v53, v113
    v_add_f32 v54, v54, v114
    v_add_f32 v55, v55, v115
    v_add_f32 v56, v56, v116
    v_add_f32 v57, v57, v117
    v_add_f32 v48, v48, v118
    v_add_f32 v49, v49, v119
    v_add_f32 v50, v50, v120
    v_add_f32 v51, v51, v121
    v_add_f32 v52, v52, v122
    v_add_f32 v53, v53, v123
    v_add_f32 v54, v54, v124
    v_add_f32 v55, v55, v125
    v_add_f32 v56, v56, v126
    v_add_f32 v57, v57, v127
    v_cvt_pk_bf16_f32 v30, v48, v49
    s_nop 0
    v_lshlrev_b32 v31, 16, v30
    v_and_b32 v32, 0xffff0000, v30
    v_lshlrev_b32 v33, 16, v4
    v_and_b32 v34, 0xffff0000, v4
    v_add_f32 v31, v31, v33
    v_add_f32 v32, v32, v34
    v_cvt_pk_bf16_f32 v4, v31, v32
    v_cvt_pk_bf16_f32 v30, v50, v51
    s_nop 0
    v_lshlrev_b32 v31, 16, v30
    v_and_b32 v32, 0xffff0000, v30
    v_lshlrev_b32 v33, 16, v5
    v_and_b32 v34, 0xffff0000, v5
    v_add_f32 v31, v31, v33
    v_add_f32 v32, v32, v34
    v_cvt_pk_bf16_f32 v5, v31, v32
    v_cvt_pk_bf16_f32 v30, v52, v53
    s_nop 0
    v_lshlrev_b32 v31, 16, v30
    v_and_b32 v32, 0xffff0000, v30
    v_lshlrev_b32 v33, 16, v6
    v_and_b32 v34, 0xffff0000, v6
    v_add_f32 v31, v31, v33
    v_add_f32 v32, v32, v34
    v_cvt_pk_bf16_f32 v6, v31, v32
    v_cvt_pk_bf16_f32 v30, v54, v55
    s_nop 0
    v_lshlrev_b32 v31, 16, v30
    v_and_b32 v32, 0xffff0000, v30
    v_lshlrev_b32 v33, 16, v7
    v_and_b32 v34, 0xffff0000, v7
    v_add_f32 v31, v31, v33
    v_add_f32 v32, v32, v34
    v_cvt_pk_bf16_f32 v7, v31, v32
    v_cvt_pk_bf16_f32 v30, v56, v57
    s_nop 0
    v_lshlrev_b32 v31, 16, v30
    v_and_b32 v32, 0xffff0000, v30
    v_lshlrev_b32 v33, 16, v8
    v_and_b32 v34, 0xffff0000, v8
    v_add_f32 v31, v31, v33
    v_add_f32 v32, v32, v34
    v_cvt_pk_bf16_f32 v8, v31, v32
    s_mov_b32 s18, 117440512
    s_nop 0
    buffer_store_dword v4, v3, s[8:11], s18 offen offset:0 sc1
    buffer_store_dword v5, v3, s[8:11], s18 offen offset:256 sc1
    buffer_store_dword v6, v3, s[8:11], s18 offen offset:512 sc1
    buffer_store_dword v7, v3, s[8:11], s18 offen offset:768 sc1
    buffer_store_dword v8, v3, s[8:11], s18 offen offset:1024 sc1
    v_lshlrev_b32 v10, 16, v4
    v_and_b32 v11, 0xffff0000, v4
    v_lshlrev_b32 v12, 16, v5
    v_and_b32 v13, 0xffff0000, v5
    v_lshlrev_b32 v14, 16, v6
    v_and_b32 v15, 0xffff0000, v6
    v_lshlrev_b32 v16, 16, v7
    v_and_b32 v17, 0xffff0000, v7
    v_lshlrev_b32 v18, 16, v8
    v_and_b32 v19, 0xffff0000, v8
    v_add_f32 v20, v10, v11
    v_add_f32 v20, v20, v12
    v_add_f32 v20, v20, v13
    v_add_f32 v20, v20, v14
    v_add_f32 v20, v20, v15
    v_add_f32 v20, v20, v16
    v_add_f32 v20, v20, v17
    v_add_f32 v20, v20, v18
    v_add_f32 v20, v20, v19
    s_nop 1
    v_add_f32_dpp v20, v20, v20 row_shr:1 row_mask:0xf bank_mask:0xf bound_ctrl:0
    s_nop 1
    v_add_f32_dpp v20, v20, v20 row_shr:2 row_mask:0xf bank_mask:0xf bound_ctrl:0
    s_nop 1
    v_add_f32_dpp v20, v20, v20 row_shr:4 row_mask:0xf bank_mask:0xf bound_ctrl:0
    s_nop 1
    v_add_f32_dpp v20, v20, v20 row_shr:8 row_mask:0xf bank_mask:0xf bound_ctrl:0
    s_nop 1
    v_add_f32_dpp v20, v20, v20 row_bcast:15 row_mask:0xa bank_mask:0xf
    s_nop 1
    v_add_f32_dpp v20, v20, v20 row_bcast:31 row_mask:0xc bank_mask:0xf
    s_nop 1
    v_readlane_b32 s20, v20, 63
    s_nop 3
    v_mov_b32 v21, 0x3acccccd
    v_mov_b32 v22, 0x44200000
    v_rcp_f32 v23, v22
    s_nop 0
    v_mul_f32 v24, s20, v23
    v_fma_f32 v25, -v24, v22, s20
    v_fma_f32 v24, v25, v23, v24
    v_sub_f32 v26, v10, v24
    v_mul_f32 v20, v26, v26
    v_sub_f32 v26, v11, v24
    v_fma_f32 v20, v26, v26, v20
    v_sub_f32 v26, v12, v24
    v_fma_f32 v20, v26, v26, v20
    v_sub_f32 v26, v13, v24
    v_fma_f32 v20, v26, v26, v20
    v_sub_f32 v26, v14, v24
    v_fma_f32 v20, v26, v26, v20
    v_sub_f32 v26, v15, v24
    v_fma_f32 v20, v26, v26, v20
    v_sub_f32 v26, v16, v24
    v_fma_f32 v20, v26, v26, v20
    v_sub_f32 v26, v17, v24
    v_fma_f32 v20, v26, v26, v20
    v_sub_f32 v26, v18, v24
    v_fma_f32 v20, v26, v26, v20
    v_sub_f32 v26, v19, v24
    v_fma_f32 v20, v26, v26, v20
    s_nop 1
    v_add_f32_dpp v20, v20, v20 row_shr:1 row_mask:0xf bank_mask:0xf bound_ctrl:0
    s_nop 1
    v_add_f32_dpp v20, v20, v20 row_shr:2 row_mask:0xf bank_mask:0xf bound_ctrl:0
    s_nop 1
    v_add_f32_dpp v20, v20, v20 row_shr:4 row_mask:0xf bank_mask:0xf bound_ctrl:0
    s_nop 1
    v_add_f32_dpp v20, v20, v20 row_shr:8 row_mask:0xf bank_mask:0xf bound_ctrl:0
    s_nop 1
    v_add_f32_dpp v20, v20, v20 row_bcast:15 row_mask:0xa bank_mask:0xf
    s_nop 1
    v_add_f32_dpp v20, v20, v20 row_bcast:31 row_mask:0xc bank_mask:0xf
    s_nop 1
    v_readlane_b32 s21, v20, 63
    s_nop 3
    v_mul_f32 v27, s21, v23
    v_fma_f32 v25, -v27, v22, s21
    v_fma_f32 v27, v25, v23, v27
    v_cvt_pk_bf16_f32 v28, v24, v27
    s_nop 0
    v_lshlrev_b32 v24, 16, v28
    v_and_b32 v27, 0xffff0000, v28
    v_add_f32 v27, 0x3727c5ac, v27
    v_cvt_pk_bf16_f32 v28, v27, v27
    s_nop 0
    v_lshlrev_b32 v27, 16, v28
    v_sqrt_f32 v27, v27
    s_nop 0
    v_cvt_pk_bf16_f32 v28, v27, v27
    s_nop 0
    v_lshlrev_b32 v27, 16, v28
    v_rcp_f32 v29, v27
    s_nop 0
    v_sub_f32 v30, v10, v24
    v_sub_f32 v31, v11, v24
    v_cvt_pk_bf16_f32 v32, v30, v31
    s_nop 0
    v_lshlrev_b32 v30, 16, v32
    v_and_b32 v31, 0xffff0000, v32
    v_mul_f32 v33, v30, v29
    v_mul_f32 v34, v31, v29
    v_fma_f32 v35, -v33, v27, v30
    v_fma_f32 v36, -v34, v27, v31
    v_fma_f32 v33, v35, v29, v33
    v_fma_f32 v34, v36, v29, v34
    v_cvt_pk_bf16_f32 v4, v33, v34
    v_sub_f32 v30, v12, v24
    v_sub_f32 v31, v13, v24
    v_cvt_pk_bf16_f32 v32, v30, v31
    s_nop 0
    v_lshlrev_b32 v30, 16, v32
    v_and_b32 v31, 0xffff0000, v32
    v_mul_f32 v33, v30, v29
    v_mul_f32 v34, v31, v29
    v_fma_f32 v35, -v33, v27, v30
    v_fma_f32 v36, -v34, v27, v31
    v_fma_f32 v33, v35, v29, v33
    v_fma_f32 v34, v36, v29, v34
    v_cvt_pk_bf16_f32 v5, v33, v34
    v_sub_f32 v30, v14, v24
    v_sub_f32 v31, v15, v24
    v_cvt_pk_bf16_f32 v32, v30, v31
    s_nop 0
    v_lshlrev_b32 v30, 16, v32
    v_and_b32 v31, 0xffff0000, v32
    v_mul_f32 v33, v30, v29
    v_mul_f32 v34, v31, v29
    v_fma_f32 v35, -v33, v27, v30
    v_fma_f32 v36, -v34, v27, v31
    v_fma_f32 v33, v35, v29, v33
    v_fma_f32 v34, v36, v29, v34
    v_cvt_pk_bf16_f32 v6, v33, v34
    v_sub_f32 v30, v16, v24
    v_sub_f32 v31, v17, v24
    v_cvt_pk_bf16_f32 v32, v30, v31
    s_nop 0
    v_lshlrev_b32 v30, 16, v32
    v_and_b32 v31, 0xffff0000, v32
    v_mul_f32 v33, v30, v29
    v_mul_f32 v34, v31, v29
    v_fma_f32 v35, -v33, v27, v30
    v_fma_f32 v36, -v34, v27, v31
    v_fma_f32 v33, v35, v29, v33
    v_fma_f32 v34, v36, v29, v34
    v_cvt_pk_bf16_f32 v7, v33, v34
    v_sub_f32 v30, v18, v24
    v_sub_f32 v31, v19, v24
    v_cvt_pk_bf16_f32 v32, v30, v31
    s_nop 0
    v_lshlrev_b32 v30, 16, v32
    v_and_b32 v31, 0xffff0000, v32
    v_mul_f32 v33, v30, v29
    v_mul_f32 v34, v31, v29
    v_fma_f32 v35, -v33, v27, v30
    v_fma_f32 v36, -v34, v27, v31
    v_fma_f32 v33, v35, v29, v33
    v_fma_f32 v34, v36, v29, v34
    v_cvt_pk_bf16_f32 v8, v33, v34
    s_nop 1
    buffer_store_dword v4, v3, s[8:11], s17 offen offset:0 sc1
    buffer_store_dword v5, v3, s[8:11], s17 offen offset:256 sc1
    buffer_store_dword v6, v3, s[8:11], s17 offen offset:512 sc1
    buffer_store_dword v7, v3, s[8:11], s17 offen offset:768 sc1
    buffer_store_dword v8, v3, s[8:11], s17 offen offset:1024 sc1
    s_waitcnt vmcnt(0)
    s_barrier
    s_cmp_lg_u32 s40, 0
    s_cbranch_scc1 L_nosig_81
    v_mov_b32 v3, 1
    v_mov_b32 v4, 128
    s_mov_b64 exec, 1
    buffer_atomic_add v3, v4, s[8:11], s70 offen
    s_mov_b64 exec, -1
L_nosig_81:
    v_and_b32 v8, 15, v1
    v_lshrrev_b32 v9, 4, v1
    v_lshlrev_b32 v2, 4, v1
    s_cmp_ge_u32 s62, 6
    s_cbranch_scc1 L_noglu_82
    s_mov_b32 s41, s63
    s_mov_b32 s42, s62
    s_mul_i32 s44, s41, 81920
    s_add_u32 s44, s44, 121634816
    s_lshl_b32 s45, s42, 15
    s_lshl_b32 s46, s40, 12
    s_add_u32 s45, s45, s46
    s_add_u32 s45, s45, 234881024
    buffer_load_dwordx4 v[128:131], v2, s[8:11], s45 offen offset:0
    buffer_load_dwordx4 v[132:135], v2, s[8:11], s45 offen offset:1024
    buffer_load_dwordx4 v[136:139], v2, s[8:11], s45 offen offset:2048
    buffer_load_dwordx4 v[140:143], v2, s[8:11], s45 offen offset:3072
    s_add_u32 s45, s45, 196608
    buffer_load_dwordx4 v[144:147], v2, s[8:11], s45 offen offset:0
    buffer_load_dwordx4 v[148:151], v2, s[8:11], s45 offen offset:1024
    buffer_load_dwordx4 v[152:155], v2, s[8:11], s45 offen offset:2048
    buffer_load_dwordx4 v[156:159], v2, s[8:11], s45 offen offset:3072
    s_add_u32 s45, s45, 196608
    buffer_load_dwordx4 v[160:163], v2, s[8:11], s45 offen offset:0
    buffer_load_dwordx4 v[164:167], v2, s[8:11], s45 offen offset:1024
    buffer_load_dwordx4 v[168:171], v2, s[8:11], s45 offen offset:2048
    buffer_load_dwordx4 v[172:175], v2, s[8:11], s45 offen offset:3072
    s_add_u32 s45, s45, 196608
    buffer_load_dwordx4 v[176:179], v2, s[8:11], s45 offen offset:0
    buffer_load_dwordx4 v[180:183], v2, s[8:11], s45 offen offset:1024
    buffer_load_dwordx4 v[184:187], v2, s[8:11], s45 offen offset:2048
    buffer_load_dwordx4 v[188:191], v2, s[8:11], s45 offen offset:3072
    s_add_u32 s45, s45, 196608
    buffer_load_dwordx4 v[192:195], v2, s[8:11], s45 offen offset:0
    buffer_load_dwordx4 v[196:199], v2, s[8:11], s45 offen offset:1024
    buffer_load_dwordx4 v[200:203], v2, s[8:11], s45 offen offset:2048
    buffer_load_dwordx4 v[204:207], v2, s[8:11], s45 offen offset:3072
    s_add_u32 s45, s45, 196608
    buffer_load_dwordx4 v[208:211], v2, s[8:11], s45 offen offset:0
    buffer_load_dwordx4 v[212:215], v2, s[8:11], s45 offen offset:1024
    buffer_load_dwordx4 v[216:219], v2, s[8:11], s45 offen offset:2048
    buffer_load_dwordx4 v[220:223], v2, s[8:11], s45 offen offset:3072
    s_add_u32 s45, s45, 196608
    v_mul_u32_u24 v11, 1296, v8
    v_lshl_add_u32 v11, v9, 4, v11
    s_cmp_lg_u32 s40, 0
    s_cbranch_scc1 L_gws_83
    v_mov_b32 v4, 128
    s_mov_b32 s71, 0
L_gwp_84:
    s_mov_b64 exec, 1
    buffer_load_dword v3, v4, s[8:11], s70 offen sc1
    s_mov_b64 exec, -1
    s_waitcnt vmcnt(0)
    v_readfirstlane_b32 s72, v3
    s_cmp_ge_u32 s72, 8
    s_cbranch_scc1 L_gws_83
    s_sleep 2
    s_add_u32 s71, s71, 1
    s_cmp_lt_u32 s71, 1048576
    s_cbranch_scc1 L_gwp_84
L_gws_83:
    s_barrier
    v_mov_b32 v7, 53687092
    v_lshlrev_b32 v3, 4, v0
    buffer_load_dwordx4 v[16:19], v3, s[8:11], s44 offen sc1
    s_add_u32 s44, s44, 8192
    buffer_load_dwordx4 v[20:23], v3, s[8:11], s44 offen sc1
    s_add_u32 s44, s44, 8192
    buffer_load_dwordx4 v[24:27], v3, s[8:11], s44 offen sc1
    s_add_u32 s44, s44, 8192
    buffer_load_dwordx4 v[28:31], v3, s[8:11], s44 offen sc1
    s_add_u32 s44, s44, 8192
    buffer_load_dwordx4 v[32:35], v3, s[8:11], s44 offen sc1
    s_add_u32 s44, s44, 8192
    buffer_load_dwordx4 v[36:39], v3, s[8:11], s44 offen sc1
    s_add_u32 s44, s44, 8192
    buffer_load_dwordx4 v[40:43], v3, s[8:11], s44 offen sc1
    s_add_u32 s44, s44, 8192
    buffer_load_dwordx4 v[44:47], v3, s[8:11], s44 offen sc1
    s_add_u32 s44, s44, 8192
    buffer_load_dwordx4 v[48:51], v3, s[8:11], s44 offen sc1
    s_add_u32 s44, s44, 8192
    buffer_load_dwordx4 v[52:55], v3, s[8:11], s44 offen sc1
    v_add_u32 v3, 0, v0
    v_mul_hi_u32 v4, v3, v7
    v_mul_u32_u24 v4, 16, v4
    v_lshl_add_u32 v4, v3, 4, v4
    s_waitcnt vmcnt(9)
    ds_write_b128 v4, v[16:19]
    v_add_u32 v3, 512, v0
    v_mul_hi_u32 v4, v3, v7
    v_mul_u32_u24 v4, 16, v4
    v_lshl_add_u32 v4, v3, 4, v4
    s_waitcnt vmcnt(8)
    ds_write_b128 v4, v[20:23]
    v_add_u32 v3, 1024, v0
    v_mul_hi_u32 v4, v3, v7
    v_mul_u32_u24 v4, 16, v4
    v_lshl_add_u32 v4, v3, 4, v4
    s_waitcnt vmcnt(7)
    ds_write_b128 v4, v[24:27]
    v_add_u32 v3, 1536, v0
    v_mul_hi_u32 v4, v3, v7
    v_mul_u32_u24 v4, 16, v4
    v_lshl_add_u32 v4, v3, 4, v4
    s_waitcnt vmcnt(6)
    ds_write_b128 v4, v[28:31]
    v_add_u32 v3, 2048, v0
    v_mul_hi_u32 v4, v3, v7
    v_mul_u32_u24 v4, 16, v4
    v_lshl_add_u32 v4, v3, 4, v4
    s_waitcnt vmcnt(5)
    ds_write_b128 v4, v[32:35]
    v_add_u32 v3, 2560, v0
    v_mul_hi_u32 v4, v3, v7
    v_mul_u32_u24 v4, 16, v4
    v_lshl_add_u32 v4, v3, 4, v4
    s_waitcnt vmcnt(4)
    ds_write_b128 v4, v[36:39]
    v_add_u32 v3, 3072, v0
    v_mul_hi_u32 v4, v3, v7
    v_mul_u32_u24 v4, 16, v4
    v_lshl_add_u32 v4, v3, 4, v4
    s_waitcnt vmcnt(3)
    ds_write_b128 v4, v[40:43]
    v_add_u32 v3, 3584, v0
    v_mul_hi_u32 v4, v3, v7
    v_mul_u32_u24 v4, 16, v4
    v_lshl_add_u32 v4, v3, 4, v4
    s_waitcnt vmcnt(2)
    ds_write_b128 v4, v[44:47]
    v_add_u32 v3, 4096, v0
    v_mul_hi_u32 v4, v3, v7
    v_mul_u32_u24 v4, 16, v4
    v_lshl_add_u32 v4, v3, 4, v4
    s_waitcnt vmcnt(1)
    ds_write_b128 v4, v[48:51]
    v_add_u32 v3, 4608, v0
    v_mul_hi_u32 v4, v3, v7
    v_mul_u32_u24 v4, 16, v4
    v_lshl_add_u32 v4, v3, 4, v4
    s_waitcnt vmcnt(0)
    ds_write_b128 v4, v[52:55]
    s_waitcnt lgkmcnt(0)
    s_barrier
    ds_read_b128 v[80:83], v11 offset:0
    ds_read_b128 v[84:87], v11 offset:20736
    ds_read_b128 v[88:91], v11 offset:41472
    ds_read_b128 v[92:95], v11 offset:62208
    ds_read_b128 v[96:99], v11 offset:64
    ds_read_b128 v[100:103], v11 offset:20800
    ds_read_b128 v[104:107], v11 offset:41536
    ds_read_b128 v[108:111], v11 offset:62272
    s_waitcnt vmcnt(20) lgkmcnt(4)
    v_mfma_f32_16x16x32_bf16 v[16:19], v[128:131], v[80:83], 0
    v_mfma_f32_16x16x32_bf16 v[20:23], v[128:131], v[84:87], 0
    v_mfma_f32_16x16x32_bf16 v[24:27], v[128:131], v[88:91], 0
    v_mfma_f32_16x16x32_bf16 v[28:31], v[128:131], v[92:95], 0
    v_mfma_f32_16x16x32_bf16 v[32:35], v[132:135], v[80:83], 0
    v_mfma_f32_16x16x32_bf16 v[36:39], v[132:135], v[84:87], 0
    v_mfma_f32_16x16x32_bf16 v[40:43], v[132:135], v[88:91], 0
    v_mfma_f32_16x16x32_bf16 v[44:47], v[132:135], v[92:95], 0
    v_mfma_f32_16x16x32_bf16 v[48:51], v[136:139], v[80:83], 0
    v_mfma_f32_16x16x32_bf16 v[52:55], v[136:139], v[84:87], 0
    v_mfma_f32_16x16x32_bf16 v[56:59], v[136:139], v[88:91], 0
    v_mfma_f32_16x16x32_bf16 v[60:63], v[136:139], v[92:95], 0
    v_mfma_f32_16x16x32_bf16 v[64:67], v[140:143], v[80:83], 0
    v_mfma_f32_16x16x32_bf16 v[68:71], v[140:143], v[84:87], 0
    v_mfma_f32_16x16x32_bf16 v[72:75], v[140:143], v[88:91], 0
    v_mfma_f32_16x16x32_bf16 v[76:79], v[140:143], v[92:95], 0
    buffer_load_dwordx4 v[128:131], v2, s[8:11], s45 offen offset:0
    buffer_load_dwordx4 v[132:135], v2, s[8:11], s45 offen offset:1024
    buffer_load_dwordx4 v[136:139], v2, s[8:11], s45 offen offset:2048
    buffer_load_dwordx4 v[140:143], v2, s[8:11], s45 offen offset:3072
    s_add_u32 s45, s45, 196608
    ds_read_b128 v[80:83], v11 offset:128
    ds_read_b128 v[84:87], v11 offset:20864
    ds_read_b128 v[88:91], v11 offset:41600
    ds_read_b128 v[92:95], v11 offset:62336
    s_waitcnt vmcnt(20) lgkmcnt(4)
    v_mfma_f32_16x16x32_bf16 v[16:19], v[144:147], v[96:99], v[16:19]
    v_mfma_f32_16x16x32_bf16 v[20:23], v[144:147], v[100:103], v[20:23]
    v_mfma_f32_16x16x32_bf16 v[24:27], v[144:147], v[104:107], v[24:27]
    v_mfma_f32_16x16x32_bf16 v[28:31], v[144:147], v[108:111], v[28:31]
    v_mfma_f32_16x16x32_bf16 v[32:35], v[148:151], v[96:99], v[32:35]
    v_mfma_f32_16x16x32_bf16 v[36:39], v[148:151], v[100:103], v[36:39]
    v_mfma_f32_16x16x32_bf16 v[40:43], v[148:151], v[104:107], v[40:43]
    v_mfma_f32_16x16x32_bf16 v[44:47], v[148:151], v[108:111], v[44:47]
    v_mfma_f32_16x16x32_bf16 v[48:51], v[152:155], v[96:99], v[48:51]
    v_mfma_f32_16x16x32_bf16 v[52:55], v[152:155], v[100:103], v[52:55]
    v_mfma_f32_16x16x32_bf16 v[56:59], v[152:155], v[104:107], v[56:59]
    v_mfma_f32_16x16x32_bf16 v[60:63], v[152:155], v[108:111], v[60:63]
    v_mfma_f32_16x16x32_bf16 v[64:67], v[156:159], v[96:99], v[64:67]
    v_mfma_f32_16x16x32_bf16 v[68:71], v[156:159], v[100:103], v[68:71]
    v_mfma_f32_16x16x32_bf16 v[72:75], v[156:159], v[104:107], v[72:75]
    v_mfma_f32_16x16x32_bf16 v[76:79], v[156:159], v[108:111], v[76:79]
    buffer_load_dwordx4 v[144:147], v2, s[8:11], s45 offen offset:0
    buffer_load_dwordx4 v[148:151], v2, s[8:11], s45 offen offset:1024
    buffer_load_dwordx4 v[152:155], v2, s[8:11], s45 offen offset:2048
    buffer_load_dwordx4 v[156:159], v2, s[8:11], s45 offen offset:3072
    s_add_u32 s45, s45, 196608
    ds_read_b128 v[96:99], v11 offset:192
    ds_read_b128 v[100:103], v11 offset:20928
    ds_read_b128 v[104:107], v11 offset:41664
    ds_read_b128 v[108:111], v11 offset:62400
    s_waitcnt vmcnt(20) lgkmcnt(4)
    v_mfma_f32_16x16x32_bf16 v[16:19], v[160:163], v[80:83], v[16:19]
    v_mfma_f32_16x16x32_bf16 v[20:23], v[160:163], v[84:87], v[20:23]
    v_mfma_f32_16x16x32_bf16 v[24:27], v[160:163], v[88:91], v[24:27]
    v_mfma_f32_16x16x32_bf16 v[28:31], v[160:163], v[92:95], v[28:31]
    v_mfma_f32_16x16x32_bf16 v[32:35], v[164:167], v[80:83], v[32:35]
    v_mfma_f32_16x16x32_bf16 v[36:39], v[164:167], v[84:87], v[36:39]
    v_mfma_f32_16x16x32_bf16 v[40:43], v[164:167], v[88:91], v[40:43]
    v_mfma_f32_16x16x32_bf16 v[44:47], v[164:167], v[92:95], v[44:47]
    v_mfma_f32_16x16x32_bf16 v[48:51], v[168:171], v[80:83], v[48:51]
    v_mfma_f32_16x16x32_bf16 v[52:55], v[168:171], v[84:87], v[52:55]
    v_mfma_f32_16x16x32_bf16 v[56:59], v[168:171], v[88:91], v[56:59]
    v_mfma_f32_16x16x32_bf16 v[60:63], v[168:171], v[92:95], v[60:63]
    v_mfma_f32_16x16x32_bf16 v[64:67], v[172:175], v[80:83], v[64:67]
    v_mfma_f32_16x16x32_bf16 v[68:71], v[172:175], v[84:87], v[68:71]
    v_mfma_f32_16x16x32_bf16 v[72:75], v[172:175], v[88:91], v[72:75]
    v_mfma_f32_16x16x32_bf16 v[76:79], v[172:175], v[92:95], v[76:79]
    buffer_load_dwordx4 v[160:163], v2, s[8:11], s45 offen offset:0
    buffer_load_dwordx4 v[164:167], v2, s[8:11], s45 offen offset:1024
    buffer_load_dwordx4 v[168:171], v2, s[8:11], s45 offen offset:2048
    buffer_load_dwordx4 v[172:175], v2, s[8:11], s45 offen offset:3072
    s_add_u32 s45, s45, 196608
    ds_read_b128 v[80:83], v11 offset:256
    ds_read_b128 v[84:87], v11 offset:20992
    ds_read_b128 v[88:91], v11 offset:41728
    ds_read_b128 v[92:95], v11 offset:62464
    s_waitcnt vmcnt(20) lgkmcnt(4)
    v_mfma_f32_16x16x32_bf16 v[16:19], v[176:179], v[96:99], v[16:19]
    v_mfma_f32_16x16x32_bf16 v[20:23], v[176:179], v[100:103], v[20:23]
    v_mfma_f32_16x16x32_bf16 v[24:27], v[176:179], v[104:107], v[24:27]
    v_mfma_f32_16x16x32_bf16 v[28:31], v[176:179], v[108:111], v[28:31]
    v_mfma_f32_16x16x32_bf16 v[32:35], v[180:183], v[96:99], v[32:35]
    v_mfma_f32_16x16x32_bf16 v[36:39], v[180:183], v[100:103], v[36:39]
    v_mfma_f32_16x16x32_bf16 v[40:43], v[180:183], v[104:107], v[40:43]
    v_mfma_f32_16x16x32_bf16 v[44:47], v[180:183], v[108:111], v[44:47]
    v_mfma_f32_16x16x32_bf16 v[48:51], v[184:187], v[96:99], v[48:51]
    v_mfma_f32_16x16x32_bf16 v[52:55], v[184:187], v[100:103], v[52:55]
    v_mfma_f32_16x16x32_bf16 v[56:59], v[184:187], v[104:107], v[56:59]
    v_mfma_f32_16x16x32_bf16 v[60:63], v[184:187], v[108:111], v[60:63]
    v_mfma_f32_16x16x32_bf16 v[64:67], v[188:191], v[96:99], v[64:67]
    v_mfma_f32_16x16x32_bf16 v[68:71], v[188:191], v[100:103], v[68:71]
    v_mfma_f32_16x16x32_bf16 v[72:75], v[188:191], v[104:107], v[72:75]
    v_mfma_f32_16x16x32_bf16 v[76:79], v[188:191], v[108:111], v[76:79]
    buffer_load_dwordx4 v[176:179], v2, s[8:11], s45 offen offset:0
    buffer_load_dwordx4 v[180:183], v2, s[8:11], s45 offen offset:1024
    buffer_load_dwordx4 v[184:187], v2, s[8:11], s45 offen offset:2048
    buffer_load_dwordx4 v[188:191], v2, s[8:11], s45 offen offset:3072
    s_add_u32 s45, s45, 196608
    ds_read_b128 v[96:99], v11 offset:320
    ds_read_b128 v[100:103], v11 offset:21056
    ds_read_b128 v[104:107], v11 offset:41792
    ds_read_b128 v[108:111], v11 offset:62528
    s_waitcnt vmcnt(20) lgkmcnt(4)
    v_mfma_f32_16x16x32_bf16 v[16:19], v[192:195], v[80:83], v[16:19]
    v_mfma_f32_16x16x32_bf16 v[20:23], v[192:195], v[84:87], v[20:23]
    v_mfma_f32_16x16x32_bf16 v[24:27], v[192:195], v[88:91], v[24:27]
    v_mfma_f32_16x16x32_bf16 v[28:31], v[192:195], v[92:95], v[28:31]
    v_mfma_f32_16x16x32_bf16 v[32:35], v[196:199], v[80:83], v[32:35]
    v_mfma_f32_16x16x32_bf16 v[36:39], v[196:199], v[84:87], v[36:39]
    v_mfma_f32_16x16x32_bf16 v[40:43], v[196:199], v[88:91], v[40:43]
    v_mfma_f32_16x16x32_bf16 v[44:47], v[196:199], v[92:95], v[44:47]
    v_mfma_f32_16x16x32_bf16 v[48:51], v[200:203], v[80:83], v[48:51]
    v_mfma_f32_16x16x32_bf16 v[52:55], v[200:203], v[84:87], v[52:55]
    v_mfma_f32_16x16x32_bf16 v[56:59], v[200:203], v[88:91], v[56:59]
    v_mfma_f32_16x16x32_bf16 v[60:63], v[200:203], v[92:95], v[60:63]
    v_mfma_f32_16x16x32_bf16 v[64:67], v[204:207], v[80:83], v[64:67]
    v_mfma_f32_16x16x32_bf16 v[68:71], v[204:207], v[84:87], v[68:71]
    v_mfma_f32_16x16x32_bf16 v[72:75], v[204:207], v[88:91], v[72:75]
    v_mfma_f32_16x16x32_bf16 v[76:79], v[204:207], v[92:95], v[76:79]
    buffer_load_dwordx4 v[192:195], v2, s[8:11], s45 offen offset:0
    buffer_load_dwordx4 v[196:199], v2, s[8:11], s45 offen offset:1024
    buffer_load_dwordx4 v[200:203], v2, s[8:11], s45 offen offset:2048
    buffer_load_dwordx4 v[204:207], v2, s[8:11], s45 offen offset:3072
    s_add_u32 s45, s45, 196608
    ds_read_b128 v[80:83], v11 offset:384
    ds_read_b128 v[84:87], v11 offset:21120
    ds_read_b128 v[88:91], v11 offset:41856
    ds_read_b128 v[92:95], v11 offset:62592
    s_waitcnt vmcnt(20) lgkmcnt(4)
    v_mfma_f32_16x16x32_bf16 v[16:19], v[208:211], v[96:99], v[16:19]
    v_mfma_f32_16x16x32_bf16 v[20:23], v[208:211], v[100:103], v[20:23]
    v_mfma_f32_16x16x32_bf16 v[24:27], v[208:211], v[104:107], v[24:27]
    v_mfma_f32_16x16x32_bf16 v[28:31], v[208:211], v[108:111], v[28:31]
    v_mfma_f32_16x16x32_bf16 v[32:35], v[212:215], v[96:99], v[32:35]
    v_mfma_f32_16x16x32_bf16 v[36:39], v[212:215], v[100:103], v[36:39]
    v_mfma_f32_16x16x32_bf16 v[40:43], v[212:215], v[104:107], v[40:43]
    v_mfma_f32_16x16x32_bf16 v[44:47], v[212:215], v[108:111], v[44:47]
    v_mfma_f32_16x16x32_bf16 v[48:51], v[216:219], v[96:99], v[48:51]
    v_mfma_f32_16x16x32_bf16 v[52:55], v[216:219], v[100:103], v[52:55]
    v_mfma_f32_16x16x32_bf16 v[56:59], v[216:219], v[104:107], v[56:59]
    v_mfma_f32_16x16x32_bf16 v[60:63], v[216:219], v[108:111], v[60:63]
    v_mfma_f32_16x16x32_bf16 v[64:67], v[220:223], v[96:99], v[64:67]
    v_mfma_f32_16x16x32_bf16 v[68:71], v[220:223], v[100:103], v[68:71]
    v_mfma_f32_16x16x32_bf16 v[72:75], v[220:223], v[104:107], v[72:75]
    v_mfma_f32_16x16x32_bf16 v[76:79], v[220:223], v[108:111], v[76:79]
    buffer_load_dwordx4 v[208:211], v2, s[8:11], s45 offen offset:0
    buffer_load_dwordx4 v[212:215], v2, s[8:11], s45 offen offset:1024
    buffer_load_dwordx4 v[216:219], v2, s[8:11], s45 offen offset:2048
    buffer_load_dwordx4 v[220:223], v2, s[8:11], s45 offen offset:3072
    s_add_u32 s45, s45, 196608
    ds_read_b128 v[96:99], v11 offset:448
    ds_read_b128 v[100:103], v11 offset:21184
    ds_read_b128 v[104:107], v11 offset:41920
    ds_read_b128 v[108:111], v11 offset:62656
    s_waitcnt vmcnt(20) lgkmcnt(4)
    v_mfma_f32_16x16x32_bf16 v[16:19], v[128:131], v[80:83], v[16:19]
    v_mfma_f32_16x16x32_bf16 v[20:23], v[128:131], v[84:87], v[20:23]
    v_mfma_f32_16x16x32_bf16 v[24:27], v[128:131], v[88:91], v[24:27]
    v_mfma_f32_16x16x32_bf16 v[28:31], v[128:131], v[92:95], v[28:31]
    v_mfma_f32_16x16x32_bf16 v[32:35], v[132:135], v[80:83], v[32:35]
    v_mfma_f32_16x16x32_bf16 v[36:39], v[132:135], v[84:87], v[36:39]
    v_mfma_f32_16x16x32_bf16 v[40:43], v[132:135], v[88:91], v[40:43]
    v_mfma_f32_16x16x32_bf16 v[44:47], v[132:135], v[92:95], v[44:47]
    v_mfma_f32_16x16x32_bf16 v[48:51], v[136:139], v[80:83], v[48:51]
    v_mfma_f32_16x16x32_bf16 v[52:55], v[136:139], v[84:87], v[52:55]
    v_mfma_f32_16x16x32_bf16 v[56:59], v[136:139], v[88:91], v[56:59]
    v_mfma_f32_16x16x32_bf16 v[60:63], v[136:139], v[92:95], v[60:63]
    v_mfma_f32_16x16x32_bf16 v[64:67], v[140:143], v[80:83], v[64:67]
    v_mfma_f32_16x16x32_bf16 v[68:71], v[140:143], v[84:87], v[68:71]
    v_mfma_f32_16x16x32_bf16 v[72:75], v[140:143], v[88:91], v[72:75]
    v_mfma_f32_16x16x32_bf16 v[76:79], v[140:143], v[92:95], v[76:79]
    buffer_load_dwordx4 v[128:131], v2, s[8:11], s45 offen offset:0
    buffer_load_dwordx4 v[132:135], v2, s[8:11], s45 offen offset:1024
    buffer_load_dwordx4 v[136:139], v2, s[8:11], s45 offen offset:2048
    buffer_load_dwordx4 v[140:143], v2, s[8:11], s45 offen offset:3072
    s_add_u32 s45, s45, 196608
    ds_read_b128 v[80:83], v11 offset:512
    ds_read_b128 v[84:87], v11 offset:21248
    ds_read_b128 v[88:91], v11 offset:41984
    ds_read_b128 v[92:95], v11 offset:62720
    s_waitcnt vmcnt(20) lgkmcnt(4)
    v_mfma_f32_16x16x32_bf16 v[16:19], v[144:147], v[96:99], v[16:19]
    v_mfma_f32_16x16x32_bf16 v[20:23], v[144:147], v[100:103], v[20:23]
    v_mfma_f32_16x16x32_bf16 v[24:27], v[144:147], v[104:107], v[24:27]
    v_mfma_f32_16x16x32_bf16 v[28:31], v[144:147], v[108:111], v[28:31]
    v_mfma_f32_16x16x32_bf16 v[32:35], v[148:151], v[96:99], v[32:35]
    v_mfma_f32_16x16x32_bf16 v[36:39], v[148:151], v[100:103], v[36:39]
    v_mfma_f32_16x16x32_bf16 v[40:43], v[148:151], v[104:107], v[40:43]
    v_mfma_f32_16x16x32_bf16 v[44:47], v[148:151], v[108:111], v[44:47]
    v_mfma_f32_16x16x32_bf16 v[48:51], v[152:155], v[96:99], v[48:51]
    v_mfma_f32_16x16x32_bf16 v[52:55], v[152:155], v[100:103], v[52:55]
    v_mfma_f32_16x16x32_bf16 v[56:59], v[152:155], v[104:107], v[56:59]
    v_mfma_f32_16x16x32_bf16 v[60:63], v[152:155], v[108:111], v[60:63]
    v_mfma_f32_16x16x32_bf16 v[64:67], v[156:159], v[96:99], v[64:67]
    v_mfma_f32_16x16x32_bf16 v[68:71], v[156:159], v[100:103], v[68:71]
    v_mfma_f32_16x16x32_bf16 v[72:75], v[156:159], v[104:107], v[72:75]
    v_mfma_f32_16x16x32_bf16 v[76:79], v[156:159], v[108:111], v[76:79]
    buffer_load_dwordx4 v[144:147], v2, s[8:11], s45 offen offset:0
    buffer_load_dwordx4 v[148:151], v2, s[8:11], s45 offen offset:1024
    buffer_load_dwordx4 v[152:155], v2, s[8:11], s45 offen offset:2048
    buffer_load_dwordx4 v[156:159], v2, s[8:11], s45 offen offset:3072
    s_add_u32 s45, s45, 196608
    ds_read_b128 v[96:99], v11 offset:576
    ds_read_b128 v[100:103], v11 offset:21312
    ds_read_b128 v[104:107], v11 offset:42048
    ds_read_b128 v[108:111], v11 offset:62784
    s_waitcnt vmcnt(20) lgkmcnt(4)
    v_mfma_f32_16x16x32_bf16 v[16:19], v[160:163], v[80:83], v[16:19]
    v_mfma_f32_16x16x32_bf16 v[20:23], v[160:163], v[84:87], v[20:23]
    v_mfma_f32_16x16x32_bf16 v[24:27], v[160:163], v[88:91], v[24:27]
    v_mfma_f32_16x16x32_bf16 v[28:31], v[160:163], v[92:95], v[28:31]
    v_mfma_f32_16x16x32_bf16 v[32:35], v[164:167], v[80:83], v[32:35]
    v_mfma_f32_16x16x32_bf16 v[36:39], v[164:167], v[84:87], v[36:39]
    v_mfma_f32_16x16x32_bf16 v[40:43], v[164:167], v[88:91], v[40:43]
    v_mfma_f32_16x16x32_bf16 v[44:47], v[164:167], v[92:95], v[44:47]
    v_mfma_f32_16x16x32_bf16 v[48:51], v[168:171], v[80:83], v[48:51]
    v_mfma_f32_16x16x32_bf16 v[52:55], v[168:171], v[84:87], v[52:55]
    v_mfma_f32_16x16x32_bf16 v[56:59], v[168:171], v[88:91], v[56:59]
    v_mfma_f32_16x16x32_bf16 v[60:63], v[168:171], v[92:95], v[60:63]
    v_mfma_f32_16x16x32_bf16 v[64:67], v[172:175], v[80:83], v[64:67]
    v_mfma_f32_16x16x32_bf16 v[68:71], v[172:175], v[84:87], v[68:71]
    v_mfma_f32_16x16x32_bf16 v[72:75], v[172:175], v[88:91], v[72:75]
    v_mfma_f32_16x16x32_bf16 v[76:79], v[172:175], v[92:95], v[76:79]
    buffer_load_dwordx4 v[160:163], v2, s[8:11], s45 offen offset:0
    buffer_load_dwordx4 v[164:167], v2, s[8:11], s45 offen offset:1024
    buffer_load_dwordx4 v[168:171], v2, s[8:11], s45 offen offset:2048
    buffer_load_dwordx4 v[172:175], v2, s[8:11], s45 offen offset:3072
    s_add_u32 s45, s45, 196608
    ds_read_b128 v[80:83], v11 offset:640
    ds_read_b128 v[84:87], v11 offset:21376
    ds_read_b128 v[88:91], v11 offset:42112
    ds_read_b128 v[92:95], v11 offset:62848
    s_waitcnt vmcnt(20) lgkmcnt(4)
    v_mfma_f32_16x16x32_bf16 v[16:19], v[176:179], v[96:99], v[16:19]
    v_mfma_f32_16x16x32_bf16 v[20:23], v[176:179], v[100:103], v[20:23]
    v_mfma_f32_16x16x32_bf16 v[24:27], v[176:179], v[104:107], v[24:27]
    v_mfma_f32_16x16x32_bf16 v[28:31], v[176:179], v[108:111], v[28:31]
    v_mfma_f32_16x16x32_bf16 v[32:35], v[180:183], v[96:99], v[32:35]
    v_mfma_f32_16x16x32_bf16 v[36:39], v[180:183], v[100:103], v[36:39]
    v_mfma_f32_16x16x32_bf16 v[40:43], v[180:183], v[104:107], v[40:43]
    v_mfma_f32_16x16x32_bf16 v[44:47], v[180:183], v[108:111], v[44:47]
    v_mfma_f32_16x16x32_bf16 v[48:51], v[184:187], v[96:99], v[48:51]
    v_mfma_f32_16x16x32_bf16 v[52:55], v[184:187], v[100:103], v[52:55]
    v_mfma_f32_16x16x32_bf16 v[56:59], v[184:187], v[104:107], v[56:59]
    v_mfma_f32_16x16x32_bf16 v[60:63], v[184:187], v[108:111], v[60:63]
    v_mfma_f32_16x16x32_bf16 v[64:67], v[188:191], v[96:99], v[64:67]
    v_mfma_f32_16x16x32_bf16 v[68:71], v[188:191], v[100:103], v[68:71]
    v_mfma_f32_16x16x32_bf16 v[72:75], v[188:191], v[104:107], v[72:75]
    v_mfma_f32_16x16x32_bf16 v[76:79], v[188:191], v[108:111], v[76:79]
    buffer_load_dwordx4 v[176:179], v2, s[8:11], s45 offen offset:0
    buffer_load_dwordx4 v[180:183], v2, s[8:11], s45 offen offset:1024
    buffer_load_dwordx4 v[184:187], v2, s[8:11], s45 offen offset:2048
    buffer_load_dwordx4 v[188:191], v2, s[8:11], s45 offen offset:3072
    s_add_u32 s45, s45, 196608
    ds_read_b128 v[96:99], v11 offset:704
    ds_read_b128 v[100:103], v11 offset:21440
    ds_read_b128 v[104:107], v11 offset:42176
    ds_read_b128 v[108:111], v11 offset:62912
    s_waitcnt vmcnt(20) lgkmcnt(4)
    v_mfma_f32_16x16x32_bf16 v[16:19], v[192:195], v[80:83], v[16:19]
    v_mfma_f32_16x16x32_bf16 v[20:23], v[192:195], v[84:87], v[20:23]
    v_mfma_f32_16x16x32_bf16 v[24:27], v[192:195], v[88:91], v[24:27]
    v_mfma_f32_16x16x32_bf16 v[28:31], v[192:195], v[92:95], v[28:31]
    v_mfma_f32_16x16x32_bf16 v[32:35], v[196:199], v[80:83], v[32:35]
    v_mfma_f32_16x16x32_bf16 v[36:39], v[196:199], v[84:87], v[36:39]
    v_mfma_f32_16x16x32_bf16 v[40:43], v[196:199], v[88:91], v[40:43]
    v_mfma_f32_16x16x32_bf16 v[44:47], v[196:199], v[92:95], v[44:47]
    v_mfma_f32_16x16x32_bf16 v[48:51], v[200:203], v[80:83], v[48:51]
    v_mfma_f32_16x16x32_bf16 v[52:55], v[200:203], v[84:87], v[52:55]
    v_mfma_f32_16x16x32_bf16 v[56:59], v[200:203], v[88:91], v[56:59]
    v_mfma_f32_16x16x32_bf16 v[60:63], v[200:203], v[92:95], v[60:63]
    v_mfma_f32_16x16x32_bf16 v[64:67], v[204:207], v[80:83], v[64:67]
    v_mfma_f32_16x16x32_bf16 v[68:71], v[204:207], v[84:87], v[68:71]
    v_mfma_f32_16x16x32_bf16 v[72:75], v[204:207], v[88:91], v[72:75]
    v_mfma_f32_16x16x32_bf16 v[76:79], v[204:207], v[92:95], v[76:79]
    buffer_load_dwordx4 v[192:195], v2, s[8:11], s45 offen offset:0
    buffer_load_dwordx4 v[196:199], v2, s[8:11], s45 offen offset:1024
    buffer_load_dwordx4 v[200:203], v2, s[8:11], s45 offen offset:2048
    buffer_load_dwordx4 v[204:207], v2, s[8:11], s45 offen offset:3072
    s_add_u32 s45, s45, 196608
    ds_read_b128 v[80:83], v11 offset:768
    ds_read_b128 v[84:87], v11 offset:21504
    ds_read_b128 v[88:91], v11 offset:42240
    ds_read_b128 v[92:95], v11 offset:62976
    s_waitcnt vmcnt(20) lgkmcnt(4)
    v_mfma_f32_16x16x32_bf16 v[16:19], v[208:211], v[96:99], v[16:19]
    v_mfma_f32_16x16x32_bf16 v[20:23], v[208:211], v[100:103], v[20:23]
    v_mfma_f32_16x16x32_bf16 v[24:27], v[208:211], v[104:107], v[24:27]
    v_mfma_f32_16x16x32_bf16 v[28:31], v[208:211], v[108:111], v[28:31]
    v_mfma_f32_16x16x32_bf16 v[32:35], v[212:215], v[96:99], v[32:35]
    v_mfma_f32_16x16x32_bf16 v[36:39], v[212:215], v[100:103], v[36:39]
    v_mfma_f32_16x16x32_bf16 v[40:43], v[212:215], v[104:107], v[40:43]
    v_mfma_f32_16x16x32_bf16 v[44:47], v[212:215], v[108:111], v[44:47]
    v_mfma_f32_16x16x32_bf16 v[48:51], v[216:219], v[96:99], v[48:51]
    v_mfma_f32_16x16x32_bf16 v[52:55], v[216:219], v[100:103], v[52:55]
    v_mfma_f32_16x16x32_bf16 v[56:59], v[216:219], v[104:107], v[56:59]
    v_mfma_f32_16x16x32_bf16 v[60:63], v[216:219], v[108:111], v[60:63]
    v_mfma_f32_16x16x32_bf16 v[64:67], v[220:223], v[96:99], v[64:67]
    v_mfma_f32_16x16x32_bf16 v[68:71], v[220:223], v[100:103], v[68:71]
    v_mfma_f32_16x16x32_bf16 v[72:75], v[220:223], v[104:107], v[72:75]
    v_mfma_f32_16x16x32_bf16 v[76:79], v[220:223], v[108:111], v[76:79]
    buffer_load_dwordx4 v[208:211], v2, s[8:11], s45 offen offset:0
    buffer_load_dwordx4 v[212:215], v2, s[8:11], s45 offen offset:1024
    buffer_load_dwordx4 v[216:219], v2, s[8:11], s45 offen offset:2048
    buffer_load_dwordx4 v[220:223], v2, s[8:11], s45 offen offset:3072
    s_add_u32 s45, s45, 196608
    ds_read_b128 v[96:99], v11 offset:832
    ds_read_b128 v[100:103], v11 offset:21568
    ds_read_b128 v[104:107], v11 offset:42304
    ds_read_b128 v[108:111], v11 offset:63040
    s_waitcnt vmcnt(20) lgkmcnt(4)
    v_mfma_f32_16x16x32_bf16 v[16:19], v[128:131], v[80:83], v[16:19]
    v_mfma_f32_16x16x32_bf16 v[20:23], v[128:131], v[84:87], v[20:23]
    v_mfma_f32_16x16x32_bf16 v[24:27], v[128:131], v[88:91], v[24:27]
    v_mfma_f32_16x16x32_bf16 v[28:31], v[128:131], v[92:95], v[28:31]
    v_mfma_f32_16x16x32_bf16 v[32:35], v[132:135], v[80:83], v[32:35]
    v_mfma_f32_16x16x32_bf16 v[36:39], v[132:135], v[84:87], v[36:39]
    v_mfma_f32_16x16x32_bf16 v[40:43], v[132:135], v[88:91], v[40:43]
    v_mfma_f32_16x16x32_bf16 v[44:47], v[132:135], v[92:95], v[44:47]
    v_mfma_f32_16x16x32_bf16 v[48:51], v[136:139], v[80:83], v[48:51]
    v_mfma_f32_16x16x32_bf16 v[52:55], v[136:139], v[84:87], v[52:55]
    v_mfma_f32_16x16x32_bf16 v[56:59], v[136:139], v[88:91], v[56:59]
    v_mfma_f32_16x16x32_bf16 v[60:63], v[136:139], v[92:95], v[60:63]
    v_mfma_f32_16x16x32_bf16 v[64:67], v[140:143], v[80:83], v[64:67]
    v_mfma_f32_16x16x32_bf16 v[68:71], v[140:143], v[84:87], v[68:71]
    v_mfma_f32_16x16x32_bf16 v[72:75], v[140:143], v[88:91], v[72:75]
    v_mfma_f32_16x16x32_bf16 v[76:79], v[140:143], v[92:95], v[76:79]
    buffer_load_dwordx4 v[128:131], v2, s[8:11], s45 offen offset:0
    buffer_load_dwordx4 v[132:135], v2, s[8:11], s45 offen offset:1024
    buffer_load_dwordx4 v[136:139], v2, s[8:11], s45 offen offset:2048
    buffer_load_dwordx4 v[140:143], v2, s[8:11], s45 offen offset:3072
    s_add_u32 s45, s45, 196608
    ds_read_b128 v[80:83], v11 offset:896
    ds_read_b128 v[84:87], v11 offset:21632
    ds_read_b128 v[88:91], v11 offset:42368
    ds_read_b128 v[92:95], v11 offset:63104
    s_waitcnt vmcnt(20) lgkmcnt(4)
    v_mfma_f32_16x16x32_bf16 v[16:19], v[144:147], v[96:99], v[16:19]
    v_mfma_f32_16x16x32_bf16 v[20:23], v[144:147], v[100:103], v[20:23]
    v_mfma_f32_16x16x32_bf16 v[24:27], v[144:147], v[104:107], v[24:27]
    v_mfma_f32_16x16x32_bf16 v[28:31], v[144:147], v[108:111], v[28:31]
    v_mfma_f32_16x16x32_bf16 v[32:35], v[148:151], v[96:99], v[32:35]
    v_mfma_f32_16x16x32_bf16 v[36:39], v[148:151], v[100:103], v[36:39]
    v_mfma_f32_16x16x32_bf16 v[40:43], v[148:151], v[104:107], v[40:43]
    v_mfma_f32_16x16x32_bf16 v[44:47], v[148:151], v[108:111], v[44:47]
    v_mfma_f32_16x16x32_bf16 v[48:51], v[152:155], v[96:99], v[48:51]
    v_mfma_f32_16x16x32_bf16 v[52:55], v[152:155], v[100:103], v[52:55]
    v_mfma_f32_16x16x32_bf16 v[56:59], v[152:155], v[104:107], v[56:59]
    v_mfma_f32_16x16x32_bf16 v[60:63], v[152:155], v[108:111], v[60:63]
    v_mfma_f32_16x16x32_bf16 v[64:67], v[156:159], v[96:99], v[64:67]
    v_mfma_f32_16x16x32_bf16 v[68:71], v[156:159], v[100:103], v[68:71]
    v_mfma_f32_16x16x32_bf16 v[72:75], v[156:159], v[104:107], v[72:75]
    v_mfma_f32_16x16x32_bf16 v[76:79], v[156:159], v[108:111], v[76:79]
    buffer_load_dwordx4 v[144:147], v2, s[8:11], s45 offen offset:0
    buffer_load_dwordx4 v[148:151], v2, s[8:11], s45 offen offset:1024
    buffer_load_dwordx4 v[152:155], v2, s[8:11], s45 offen offset:2048
    buffer_load_dwordx4 v[156:159], v2, s[8:11], s45 offen offset:3072
    s_add_u32 s45, s45, 196608
    ds_read_b128 v[96:99], v11 offset:960
    ds_read_b128 v[100:103], v11 offset:21696
    ds_read_b128 v[104:107], v11 offset:42432
    ds_read_b128 v[108:111], v11 offset:63168
    s_waitcnt vmcnt(20) lgkmcnt(4)
    v_mfma_f32_16x16x32_bf16 v[16:19], v[160:163], v[80:83], v[16:19]
    v_mfma_f32_16x16x32_bf16 v[20:23], v[160:163], v[84:87], v[20:23]
    v_mfma_f32_16x16x32_bf16 v[24:27], v[160:163], v[88:91], v[24:27]
    v_mfma_f32_16x16x32_bf16 v[28:31], v[160:163], v[92:95], v[28:31]
    v_mfma_f32_16x16x32_bf16 v[32:35], v[164:167], v[80:83], v[32:35]
    v_mfma_f32_16x16x32_bf16 v[36:39], v[164:167], v[84:87], v[36:39]
    v_mfma_f32_16x16x32_bf16 v[40:43], v[164:167], v[88:91], v[40:43]
    v_mfma_f32_16x16x32_bf16 v[44:47], v[164:167], v[92:95], v[44:47]
    v_mfma_f32_16x16x32_bf16 v[48:51], v[168:171], v[80:83], v[48:51]
    v_mfma_f32_16x16x32_bf16 v[52:55], v[168:171], v[84:87], v[52:55]
    v_mfma_f32_16x16x32_bf16 v[56:59], v[168:171], v[88:91], v[56:59]
    v_mfma_f32_16x16x32_bf16 v[60:63], v[168:171], v[92:95], v[60:63]
    v_mfma_f32_16x16x32_bf16 v[64:67], v[172:175], v[80:83], v[64:67]
    v_mfma_f32_16x16x32_bf16 v[68:71], v[172:175], v[84:87], v[68:71]
    v_mfma_f32_16x16x32_bf16 v[72:75], v[172:175], v[88:91], v[72:75]
    v_mfma_f32_16x16x32_bf16 v[76:79], v[172:175], v[92:95], v[76:79]
    ds_read_b128 v[80:83], v11 offset:1024
    ds_read_b128 v[84:87], v11 offset:21760
    ds_read_b128 v[88:91], v11 offset:42496
    ds_read_b128 v[92:95], v11 offset:63232
    s_waitcnt vmcnt(16) lgkmcnt(4)
    v_mfma_f32_16x16x32_bf16 v[16:19], v[176:179], v[96:99], v[16:19]
    v_mfma_f32_16x16x32_bf16 v[20:23], v[176:179], v[100:103], v[20:23]
    v_mfma_f32_16x16x32_bf16 v[24:27], v[176:179], v[104:107], v[24:27]
    v_mfma_f32_16x16x32_bf16 v[28:31], v[176:179], v[108:111], v[28:31]
    v_mfma_f32_16x16x32_bf16 v[32:35], v[180:183], v[96:99], v[32:35]
    v_mfma_f32_16x16x32_bf16 v[36:39], v[180:183], v[100:103], v[36:39]
    v_mfma_f32_16x16x32_bf16 v[40:43], v[180:183], v[104:107], v[40:43]
    v_mfma_f32_16x16x32_bf16 v[44:47], v[180:183], v[108:111], v[44:47]
    v_mfma_f32_16x16x32_bf16 v[48:51], v[184:187], v[96:99], v[48:51]
    v_mfma_f32_16x16x32_bf16 v[52:55], v[184:187], v[100:103], v[52:55]
    v_mfma_f32_16x16x32_bf16 v[56:59], v[184:187], v[104:107], v[56:59]
    v_mfma_f32_16x16x32_bf16 v[60:63], v[184:187], v[108:111], v[60:63]
    v_mfma_f32_16x16x32_bf16 v[64:67], v[188:191], v[96:99], v[64:67]
    v_mfma_f32_16x16x32_bf16 v[68:71], v[188:191], v[100:103], v[68:71]
    v_mfma_f32_16x16x32_bf16 v[72:75], v[188:191], v[104:107], v[72:75]
    v_mfma_f32_16x16x32_bf16 v[76:79], v[188:191], v[108:111], v[76:79]
    ds_read_b128 v[96:99], v11 offset:1088
    ds_read_b128 v[100:103], v11 offset:21824
    ds_read_b128 v[104:107], v11 offset:42560
    ds_read_b128 v[108:111], v11 offset:63296
    s_waitcnt vmcnt(12) lgkmcnt(4)
    v_mfma_f32_16x16x32_bf16 v[16:19], v[192:195], v[80:83], v[16:19]
    v_mfma_f32_16x16x32_bf16 v[20:23], v[192:195], v[84:87], v[20:23]
    v_mfma_f32_16x16x32_bf16 v[24:27], v[192:195], v[88:91], v[24:27]
    v_mfma_f32_16x16x32_bf16 v[28:31], v[192:195], v[92:95], v[28:31]
    v_mfma_f32_16x16x32_bf16 v[32:35], v[196:199], v[80:83], v[32:35]
    v_mfma_f32_16x16x32_bf16 v[36:39], v[196:199], v[84:87], v[36:39]
    v_mfma_f32_16x16x32_bf16 v[40:43], v[196:199], v[88:91], v[40:43]
    v_mfma_f32_16x16x32_bf16 v[44:47], v[196:199], v[92:95], v[44:47]
    v_mfma_f32_16x16x32_bf16 v[48:51], v[200:203], v[80:83], v[48:51]
    v_mfma_f32_16x16x32_bf16 v[52:55], v[200:203], v[84:87], v[52:55]
    v_mfma_f32_16x16x32_bf16 v[56:59], v[200:203], v[88:91], v[56:59]
    v_mfma_f32_16x16x32_bf16 v[60:63], v[200:203], v[92:95], v[60:63]
    v_mfma_f32_16x16x32_bf16 v[64:67], v[204:207], v[80:83], v[64:67]
    v_mfma_f32_16x16x32_bf16 v[68:71], v[204:207], v[84:87], v[68:71]
    v_mfma_f32_16x16x32_bf16 v[72:75], v[204:207], v[88:91], v[72:75]
    v_mfma_f32_16x16x32_bf16 v[76:79], v[204:207], v[92:95], v[76:79]
    ds_read_b128 v[80:83], v11 offset:1152
    ds_read_b128 v[84:87], v11 offset:21888
    ds_read_b128 v[88:91], v11 offset:42624
    ds_read_b128 v[92:95], v11 offset:63360
    s_waitcnt vmcnt(8) lgkmcnt(4)
    v_mfma_f32_16x16x32_bf16 v[16:19], v[208:211], v[96:99], v[16:19]
    v_mfma_f32_16x16x32_bf16 v[20:23], v[208:211], v[100:103], v[20:23]
    v_mfma_f32_16x16x32_bf16 v[24:27], v[208:211], v[104:107], v[24:27]
    v_mfma_f32_16x16x32_bf16 v[28:31], v[208:211], v[108:111], v[28:31]
    v_mfma_f32_16x16x32_bf16 v[32:35], v[212:215], v[96:99], v[32:35]
    v_mfma_f32_16x16x32_bf16 v[36:39], v[212:215], v[100:103], v[36:39]
    v_mfma_f32_16x16x32_bf16 v[40:43], v[212:215], v[104:107], v[40:43]
    v_mfma_f32_16x16x32_bf16 v[44:47], v[212:215], v[108:111], v[44:47]
    v_mfma_f32_16x16x32_bf16 v[48:51], v[216:219], v[96:99], v[48:51]
    v_mfma_f32_16x16x32_bf16 v[52:55], v[216:219], v[100:103], v[52:55]
    v_mfma_f32_16x16x32_bf16 v[56:59], v[216:219], v[104:107], v[56:59]
    v_mfma_f32_16x16x32_bf16 v[60:63], v[216:219], v[108:111], v[60:63]
    v_mfma_f32_16x16x32_bf16 v[64:67], v[220:223], v[96:99], v[64:67]
    v_mfma_f32_16x16x32_bf16 v[68:71], v[220:223], v[100:103], v[68:71]
    v_mfma_f32_16x16x32_bf16 v[72:75], v[220:223], v[104:107], v[72:75]
    v_mfma_f32_16x16x32_bf16 v[76:79], v[220:223], v[108:111], v[76:79]
    ds_read_b128 v[96:99], v11 offset:1216
    ds_read_b128 v[100:103], v11 offset:21952
    ds_read_b128 v[104:107], v11 offset:42688
    ds_read_b128 v[108:111], v11 offset:63424
    s_waitcnt vmcnt(4) lgkmcnt(4)
    v_mfma_f32_16x16x32_bf16 v[16:19], v[128:131], v[80:83], v[16:19]
    v_mfma_f32_16x16x32_bf16 v[20:23], v[128:131], v[84:87], v[20:23]
    v_mfma_f32_16x16x32_bf16 v[24:27], v[128:131], v[88:91], v[24:27]
    v_mfma_f32_16x16x32_bf16 v[28:31], v[128:131], v[92:95], v[28:31]
    v_mfma_f32_16x16x32_bf16 v[32:35], v[132:135], v[80:83], v[32:35]
    v_mfma_f32_16x16x32_bf16 v[36:39], v[132:135], v[84:87], v[36:39]
    v_mfma_f32_16x16x32_bf16 v[40:43], v[132:135], v[88:91], v[40:43]
    v_mfma_f32_16x16x32_bf16 v[44:47], v[132:135], v[92:95], v[44:47]
    v_mfma_f32_16x16x32_bf16 v[48:51], v[136:139], v[80:83], v[48:51]
    v_mfma_f32_16x16x32_bf16 v[52:55], v[136:139], v[84:87], v[52:55]
    v_mfma_f32_16x16x32_bf16 v[56:59], v[136:139], v[88:91], v[56:59]
    v_mfma_f32_16x16x32_bf16 v[60:63], v[136:139], v[92:95], v[60:63]
    v_mfma_f32_16x16x32_bf16 v[64:67], v[140:143], v[80:83], v[64:67]
    v_mfma_f32_16x16x32_bf16 v[68:71], v[140:143], v[84:87], v[68:71]
    v_mfma_f32_16x16x32_bf16 v[72:75], v[140:143], v[88:91], v[72:75]
    v_mfma_f32_16x16x32_bf16 v[76:79], v[140:143], v[92:95], v[76:79]
    s_waitcnt vmcnt(0) lgkmcnt(0)
    v_mfma_f32_16x16x32_bf16 v[16:19], v[144:147], v[96:99], v[16:19]
    v_mfma_f32_16x16x32_bf16 v[20:23], v[144:147], v[100:103], v[20:23]
    v_mfma_f32_16x16x32_bf16 v[24:27], v[144:147], v[104:107], v[24:27]
    v_mfma_f32_16x16x32_bf16 v[28:31], v[144:147], v[108:111], v[28:31]
    v_mfma_f32_16x16x32_bf16 v[32:35], v[148:151], v[96:99], v[32:35]
    v_mfma_f32_16x16x32_bf16 v[36:39], v[148:151], v[100:103], v[36:39]
    v_mfma_f32_16x16x32_bf16 v[40:43], v[148:151], v[104:107], v[40:43]
    v_mfma_f32_16x16x32_bf16 v[44:47], v[148:151], v[108:111], v[44:47]
    v_mfma_f32_16x16x32_bf16 v[48:51], v[152:155], v[96:99], v[48:51]
    v_mfma_f32_16x16x32_bf16 v[52:55], v[152:155], v[100:103], v[52:55]
    v_mfma_f32_16x16x32_bf16 v[56:59], v[152:155], v[104:107], v[56:59]
    v_mfma_f32_16x16x32_bf16 v[60:63], v[152:155], v[108:111], v[60:63]
    v_mfma_f32_16x16x32_bf16 v[64:67], v[156:159], v[96:99], v[64:67]
    v_mfma_f32_16x16x32_bf16 v[68:71], v[156:159], v[100:103], v[68:71]
    v_mfma_f32_16x16x32_bf16 v[72:75], v[156:159], v[104:107], v[72:75]
    v_mfma_f32_16x16x32_bf16 v[76:79], v[156:159], v[108:111], v[76:79]
    v_mul_u32_u24 v10, 3072, v8
    v_lshl_add_u32 v10, v9, 3, v10
    s_mul_i32 s44, s41, 196608
    s_lshl_b32 s46, s42, 9
    s_add_u32 s44, s44, s46
    s_lshl_b32 s46, s40, 6
    s_add_u32 s44, s44, s46
    s_add_u32 s44, s44, 125829120
    s_nop 7
    v_cvt_pk_bf16_f32 v3, v16, v17
    v_cvt_pk_bf16_f32 v4, v32, v33
    s_nop 0
    v_lshlrev_b32 v5, 16, v3
    v_and_b32 v3, 0xffff0000, v3
    v_lshlrev_b32 v6, 16, v4
    v_and_b32 v4, 0xffff0000, v4
    v_mul_f32 v5, v5, v6
    v_mul_f32 v3, v3, v4
    v_cvt_pk_bf16_f32 v112, v5, v3
    v_cvt_pk_bf16_f32 v3, v18, v19
    v_cvt_pk_bf16_f32 v4, v34, v35
    s_nop 0
    v_lshlrev_b32 v5, 16, v3
    v_and_b32 v3, 0xffff0000, v3
    v_lshlrev_b32 v6, 16, v4
    v_and_b32 v4, 0xffff0000, v4
    v_mul_f32 v5, v5, v6
    v_mul_f32 v3, v3, v4
    v_cvt_pk_bf16_f32 v113, v5, v3
    s_nop 0
    buffer_store_dwordx2 v[112:113], v10, s[8:11], s44 offen offset:0 sc1
    v_cvt_pk_bf16_f32 v3, v48, v49
    v_cvt_pk_bf16_f32 v4, v64, v65
    s_nop 0
    v_lshlrev_b32 v5, 16, v3
    v_and_b32 v3, 0xffff0000, v3
    v_lshlrev_b32 v6, 16, v4
    v_and_b32 v4, 0xffff0000, v4
    v_mul_f32 v5, v5, v6
    v_mul_f32 v3, v3, v4
    v_cvt_pk_bf16_f32 v114, v5, v3
    v_cvt_pk_bf16_f32 v3, v50, v51
    v_cvt_pk_bf16_f32 v4, v66, v67
    s_nop 0
    v_lshlrev_b32 v5, 16, v3
    v_and_b32 v3, 0xffff0000, v3
    v_lshlrev_b32 v6, 16, v4
    v_and_b32 v4, 0xffff0000, v4
    v_mul_f32 v5, v5, v6
    v_mul_f32 v3, v3, v4
    v_cvt_pk_bf16_f32 v115, v5, v3
    s_nop 0
    buffer_store_dwordx2 v[114:115], v10, s[8:11], s44 offen offset:32 sc1
    s_add_u32 s44, s44, 49152
    v_cvt_pk_bf16_f32 v3, v20, v21
    v_cvt_pk_bf16_f32 v4, v36, v37
    s_nop 0
    v_lshlrev_b32 v5, 16, v3
    v_and_b32 v3, 0xffff0000, v3
    v_lshlrev_b32 v6, 16, v4
    v_and_b32 v4, 0xffff0000, v4
    v_mul_f32 v5, v5, v6
    v_mul_f32 v3, v3, v4
    v_cvt_pk_bf16_f32 v112, v5, v3
    v_cvt_pk_bf16_f32 v3, v22, v23
    v_cvt_pk_bf16_f32 v4, v38, v39
    s_nop 0
    v_lshlrev_b32 v5, 16, v3
    v_and_b32 v3, 0xffff0000, v3
    v_lshlrev_b32 v6, 16, v4
    v_and_b32 v4, 0xffff0000, v4
    v_mul_f32 v5, v5, v6
    v_mul_f32 v3, v3, v4
    v_cvt_pk_bf16_f32 v113, v5, v3
    s_nop 0
    buffer_store_dwordx2 v[112:113], v10, s[8:11], s44 offen offset:0 sc1
    v_cvt_pk_bf16_f32 v3, v52, v53
    v_cvt_pk_bf16_f32 v4, v68, v69
    s_nop 0
    v_lshlrev_b32 v5, 16, v3
    v_and_b32 v3, 0xffff0000, v3
    v_lshlrev_b32 v6, 16, v4
    v_and_b32 v4, 0xffff0000, v4
    v_mul_f32 v5, v5, v6
    v_mul_f32 v3, v3, v4
    v_cvt_pk_bf16_f32 v114, v5, v3
    v_cvt_pk_bf16_f32 v3, v54, v55
    v_cvt_pk_bf16_f32 v4, v70, v71
    s_nop 0
    v_lshlrev_b32 v5, 16, v3
    v_and_b32 v3, 0xffff0000, v3
    v_lshlrev_b32 v6, 16, v4
    v_and_b32 v4, 0xffff0000, v4
    v_mul_f32 v5, v5, v6
    v_mul_f32 v3, v3, v4
    v_cvt_pk_bf16_f32 v115, v5, v3
    s_nop 0
    buffer_store_dwordx2 v[114:115], v10, s[8:11], s44 offen offset:32 sc1
    s_add_u32 s44, s44, 49152
    v_cvt_pk_bf16_f32 v3, v24, v25
    v_cvt_pk_bf16_f32 v4, v40, v41
    s_nop 0
    v_lshlrev_b32 v5, 16, v3
    v_and_b32 v3, 0xffff0000, v3
    v_lshlrev_b32 v6, 16, v4
    v_and_b32 v4, 0xffff0000, v4
    v_mul_f32 v5, v5, v6
    v_mul_f32 v3, v3, v4
    v_cvt_pk_bf16_f32 v112, v5, v3
    v_cvt_pk_bf16_f32 v3, v26, v27
    v_cvt_pk_bf16_f32 v4, v42, v43
    s_nop 0
    v_lshlrev_b32 v5, 16, v3
    v_and_b32 v3, 0xffff0000, v3
    v_lshlrev_b32 v6, 16, v4
    v_and_b32 v4, 0xffff0000, v4
    v_mul_f32 v5, v5, v6
    v_mul_f32 v3, v3, v4
    v_cvt_pk_bf16_f32 v113, v5, v3
    s_nop 0
    buffer_store_dwordx2 v[112:113], v10, s[8:11], s44 offen offset:0 sc1
    v_cvt_pk_bf16_f32 v3, v56, v57
    v_cvt_pk_bf16_f32 v4, v72, v73
    s_nop 0
    v_lshlrev_b32 v5, 16, v3
    v_and_b32 v3, 0xffff0000, v3
    v_lshlrev_b32 v6, 16, v4
    v_and_b32 v4, 0xffff0000, v4
    v_mul_f32 v5, v5, v6
    v_mul_f32 v3, v3, v4
    v_cvt_pk_bf16_f32 v114, v5, v3
    v_cvt_pk_bf16_f32 v3, v58, v59
    v_cvt_pk_bf16_f32 v4, v74, v75
    s_nop 0
    v_lshlrev_b32 v5, 16, v3
    v_and_b32 v3, 0xffff0000, v3
    v_lshlrev_b32 v6, 16, v4
    v_and_b32 v4, 0xffff0000, v4
    v_mul_f32 v5, v5, v6
    v_mul_f32 v3, v3, v4
    v_cvt_pk_bf16_f32 v115, v5, v3
    s_nop 0
    buffer_store_dwordx2 v[114:115], v10, s[8:11], s44 offen offset:32 sc1
    s_add_u32 s44, s44, 49152
    v_cvt_pk_bf16_f32 v3, v28, v29
    v_cvt_pk_bf16_f32 v4, v44, v45
    s_nop 0
    v_lshlrev_b32 v5, 16, v3
    v_and_b32 v3, 0xffff0000, v3
    v_lshlrev_b32 v6, 16, v4
    v_and_b32 v4, 0xffff0000, v4
    v_mul_f32 v5, v5, v6
    v_mul_f32 v3, v3, v4
    v_cvt_pk_bf16_f32 v112, v5, v3
    v_cvt_pk_bf16_f32 v3, v30, v31
    v_cvt_pk_bf16_f32 v4, v46, v47
    s_nop 0
    v_lshlrev_b32 v5, 16, v3
    v_and_b32 v3, 0xffff0000, v3
    v_lshlrev_b32 v6, 16, v4
    v_and_b32 v4, 0xffff0000, v4
    v_mul_f32 v5, v5, v6
    v_mul_f32 v3, v3, v4
    v_cvt_pk_bf16_f32 v113, v5, v3
    s_nop 0
    buffer_store_dwordx2 v[112:113], v10, s[8:11], s44 offen offset:0 sc1
    v_cvt_pk_bf16_f32 v3, v60, v61
    v_cvt_pk_bf16_f32 v4, v76, v77
    s_nop 0
    v_lshlrev_b32 v5, 16, v3
    v_and_b32 v3, 0xffff0000, v3
    v_lshlrev_b32 v6, 16, v4
    v_and_b32 v4, 0xffff0000, v4
    v_mul_f32 v5, v5, v6
    v_mul_f32 v3, v3, v4
    v_cvt_pk_bf16_f32 v114, v5, v3
    v_cvt_pk_bf16_f32 v3, v62, v63
    v_cvt_pk_bf16_f32 v4, v78, v79
    s_nop 0
    v_lshlrev_b32 v5, 16, v3
    v_and_b32 v3, 0xffff0000, v3
    v_lshlrev_b32 v6, 16, v4
    v_and_b32 v4, 0xffff0000, v4
    v_mul_f32 v5, v5, v6
    v_mul_f32 v3, v3, v4
    v_cvt_pk_bf16_f32 v115, v5, v3
    s_nop 0
    buffer_store_dwordx2 v[114:115], v10, s[8:11], s44 offen offset:32 sc1
    s_add_u32 s44, s44, 49152
    s_waitcnt vmcnt(0)
    s_barrier
    s_cmp_lg_u32 s40, 0
    s_cbranch_scc1 L_nosig_85
    v_mov_b32 v3, 1
    v_mov_b32 v4, 256
    s_mov_b64 exec, 1
    buffer_atomic_add v3, v4, s[8:11], s70 offen
    s_mov_b64 exec, -1
L_nosig_85:
L_noglu_82:
    s_lshr_b32 s41, s2, 2
    s_and_b32 s42, s2, 3
    s_and_b32 s47, s40, 1
    s_lshr_b32 s48, s40, 1
    s_mul_i32 s44, s41, 98304
    s_add_u32 s44, s44, 125829120
    s_mul_i32 s45, s48, 491520
    s_mul_i32 s46, s42, 10240
    s_add_u32 s45, s45, s46
    s_mul_i32 s46, s47, 5120
    s_add_u32 s45, s45, s46
    s_add_u32 s45, s45, 225968128
    s_add_u32 s46, s45, 4096
    buffer_load_dwordx4 v[80:83], v2, s[8:11], s45 offen offset:0
    buffer_load_dwordx4 v[84:87], v2, s[8:11], s45 offen offset:1024
    buffer_load_dwordx4 v[88:91], v2, s[8:11], s45 offen offset:2048
    buffer_load_dwordx4 v[92:95], v2, s[8:11], s45 offen offset:3072
    buffer_load_dwordx4 v[96:99], v2, s[8:11], s46 offen offset:0
    s_add_u32 s45, s45, 40960
    s_add_u32 s46, s46, 40960
    buffer_load_dwordx4 v[100:103], v2, s[8:11], s45 offen offset:0
    buffer_load_dwordx4 v[104:107], v2, s[8:11], s45 offen offset:1024
    buffer_load_dwordx4 v[108:111], v2, s[8:11], s45 offen offset:2048
    buffer_load_dwordx4 v[112:115], v2, s[8:11], s45 offen offset:3072
    buffer_load_dwordx4 v[116:119], v2, s[8:11], s46 offen offset:0
    s_add_u32 s45, s45, 40960
    s_add_u32 s46, s46, 40960
    buffer_load_dwordx4 v[120:123], v2, s[8:11], s45 offen offset:0
    buffer_load_dwordx4 v[124:127], v2, s[8:11], s45 offen offset:1024
    buffer_load_dwordx4 v[128:131], v2, s[8:11], s45 offen offset:2048
    buffer_load_dwordx4 v[132:135], v2, s[8:11], s45 offen offset:3072
    buffer_load_dwordx4 v[136:139], v2, s[8:11], s46 offen offset:0
    s_add_u32 s45, s45, 40960
    s_add_u32 s46, s46, 40960
    buffer_load_dwordx4 v[140:143], v2, s[8:11], s45 offen offset:0
    buffer_load_dwordx4 v[144:147], v2, s[8:11], s45 offen offset:1024
    buffer_load_dwordx4 v[148:151], v2, s[8:11], s45 offen offset:2048
    buffer_load_dwordx4 v[152:155], v2, s[8:11], s45 offen offset:3072
    buffer_load_dwordx4 v[156:159], v2, s[8:11], s46 offen offset:0
    s_add_u32 s45, s45, 40960
    s_add_u32 s46, s46, 40960
    buffer_load_dwordx4 v[160:163], v2, s[8:11], s45 offen offset:0
    buffer_load_dwordx4 v[164:167], v2, s[8:11], s45 offen offset:1024
    buffer_load_dwordx4 v[168:171], v2, s[8:11], s45 offen offset:2048
    buffer_load_dwordx4 v[172:175], v2, s[8:11], s45 offen offset:3072
    buffer_load_dwordx4 v[176:179], v2, s[8:11], s46 offen offset:0
    s_add_u32 s45, s45, 40960
    s_add_u32 s46, s46, 40960
    buffer_load_dwordx4 v[180:183], v2, s[8:11], s45 offen offset:0
    buffer_load_dwordx4 v[184:187], v2, s[8:11], s45 offen offset:1024
    buffer_load_dwordx4 v[188:191], v2, s[8:11], s45 offen offset:2048
    buffer_load_dwordx4 v[192:195], v2, s[8:11], s45 offen offset:3072
    buffer_load_dwordx4 v[196:199], v2, s[8:11], s46 offen offset:0
    s_add_u32 s45, s45, 40960
    s_add_u32 s46, s46, 40960
    buffer_load_dwordx4 v[200:203], v2, s[8:11], s45 offen offset:0
    buffer_load_dwordx4 v[204:207], v2, s[8:11], s45 offen offset:1024
    buffer_load_dwordx4 v[208:211], v2, s[8:11], s45 offen offset:2048
    buffer_load_dwordx4 v[212:215], v2, s[8:11], s45 offen offset:3072
    buffer_load_dwordx4 v[216:219], v2, s[8:11], s46 offen offset:0
    s_add_u32 s45, s45, 40960
    s_add_u32 s46, s46, 40960
    buffer_load_dwordx4 v[220:223], v2, s[8:11], s45 offen offset:0
    buffer_load_dwordx4 v[224:227], v2, s[8:11], s45 offen offset:1024
    buffer_load_dwordx4 v[228:231], v2, s[8:11], s45 offen offset:2048
    buffer_load_dwordx4 v[232:235], v2, s[8:11], s45 offen offset:3072
    buffer_load_dwordx4 v[236:239], v2, s[8:11], s46 offen offset:0
    s_add_u32 s45, s45, 40960
    s_add_u32 s46, s46, 40960
    v_mul_u32_u24 v11, 3088, v8
    v_lshl_add_u32 v11, v9, 4, v11
    s_mul_i32 s49, s48, 768
    v_add_u32 v11, s49, v11
    s_cmp_lg_u32 s40, 0
    s_cbranch_scc1 L_gws_86
    v_mov_b32 v4, 256
    s_mov_b32 s71, 0
L_gwp_87:
    s_mov_b64 exec, 1
    buffer_load_dword v3, v4, s[8:11], s70 offen sc1
    s_mov_b64 exec, -1
    s_waitcnt vmcnt(0)
    v_readfirstlane_b32 s72, v3
    s_cmp_ge_u32 s72, 6
    s_cbranch_scc1 L_gws_86
    s_sleep 2
    s_add_u32 s71, s71, 1
    s_cmp_lt_u32 s71, 1048576
    s_cbranch_scc1 L_gwp_87
L_gws_86:
    s_barrier
    v_mov_b32 v7, 22369622
    v_lshlrev_b32 v3, 4, v0
    buffer_load_dwordx4 v[16:19], v3, s[8:11], s44 offen sc1
    s_add_u32 s44, s44, 8192
    buffer_load_dwordx4 v[20:23], v3, s[8:11], s44 offen sc1
    s_add_u32 s44, s44, 8192
    buffer_load_dwordx4 v[24:27], v3, s[8:11], s44 offen sc1
    s_add_u32 s44, s44, 8192
    buffer_load_dwordx4 v[28:31], v3, s[8:11], s44 offen sc1
    s_add_u32 s44, s44, 8192
    buffer_load_dwordx4 v[32:35], v3, s[8:11], s44 offen sc1
    s_add_u32 s44, s44, 8192
    buffer_load_dwordx4 v[36:39], v3, s[8:11], s44 offen sc1
    s_add_u32 s44, s44, 8192
    buffer_load_dwordx4 v[40:43], v3, s[8:11], s44 offen sc1
    s_add_u32 s44, s44, 8192
    buffer_load_dwordx4 v[44:47], v3, s[8:11], s44 offen sc1
    s_add_u32 s44, s44, 8192
    buffer_load_dwordx4 v[48:51], v3, s[8:11], s44 offen sc1
    s_add_u32 s44, s44, 8192
    buffer_load_dwordx4 v[52:55], v3, s[8:11], s44 offen sc1
    s_add_u32 s44, s44, 8192
    buffer_load_dwordx4 v[56:59], v3, s[8:11], s44 offen sc1
    s_add_u32 s44, s44, 8192
    buffer_load_dwordx4 v[60:63], v3, s[8:11], s44 offen sc1
    v_add_u32 v3, 0, v0
    v_mul_hi_u32 v4, v3, v7
    v_mul_u32_u24 v4, 16, v4
    v_lshl_add_u32 v4, v3, 4, v4
    s_waitcnt vmcnt(11)
    ds_write_b128 v4, v[16:19]
    v_add_u32 v3, 512, v0
    v_mul_hi_u32 v4, v3, v7
    v_mul_u32_u24 v4, 16, v4
    v_lshl_add_u32 v4, v3, 4, v4
    s_waitcnt vmcnt(10)
    ds_write_b128 v4, v[20:23]
    v_add_u32 v3, 1024, v0
    v_mul_hi_u32 v4, v3, v7
    v_mul_u32_u24 v4, 16, v4
    v_lshl_add_u32 v4, v3, 4, v4
    s_waitcnt vmcnt(9)
    ds_write_b128 v4, v[24:27]
    v_add_u32 v3, 1536, v0
    v_mul_hi_u32 v4, v3, v7
    v_mul_u32_u24 v4, 16, v4
    v_lshl_add_u32 v4, v3, 4, v4
    s_waitcnt vmcnt(8)
    ds_write_b128 v4, v[28:31]
    v_add_u32 v3, 2048, v0
    v_mul_hi_u32 v4, v3, v7
    v_mul_u32_u24 v4, 16, v4
    v_lshl_add_u32 v4, v3, 4, v4
    s_waitcnt vmcnt(7)
    ds_write_b128 v4, v[32:35]
    v_add_u32 v3, 2560, v0
    v_mul_hi_u32 v4, v3, v7
    v_mul_u32_u24 v4, 16, v4
    v_lshl_add_u32 v4, v3, 4, v4
    s_waitcnt vmcnt(6)
    ds_write_b128 v4, v[36:39]
    v_add_u32 v3, 3072, v0
    v_mul_hi_u32 v4, v3, v7
    v_mul_u32_u24 v4, 16, v4
    v_lshl_add_u32 v4, v3, 4, v4
    s_waitcnt vmcnt(5)
    ds_write_b128 v4, v[40:43]
    v_add_u32 v3, 3584, v0
    v_mul_hi_u32 v4, v3, v7
    v_mul_u32_u24 v4, 16, v4
    v_lshl_add_u32 v4, v3, 4, v4
    s_waitcnt vmcnt(4)
    ds_write_b128 v4, v[44:47]
    v_add_u32 v3, 4096, v0
    v_mul_hi_u32 v4, v3, v7
    v_mul_u32_u24 v4, 16, v4
    v_lshl_add_u32 v4, v3, 4, v4
    s_waitcnt vmcnt(3)
    ds_write_b128 v4, v[48:51]
    v_add_u32 v3, 4608, v0
    v_mul_hi_u32 v4, v3, v7
    v_mul_u32_u24 v4, 16, v4
    v_lshl_add_u32 v4, v3, 4, v4
    s_waitcnt vmcnt(2)
    ds_write_b128 v4, v[52:55]
    v_add_u32 v3, 5120, v0
    v_mul_hi_u32 v4, v3, v7
    v_mul_u32_u24 v4, 16, v4
    v_lshl_add_u32 v4, v3, 4, v4
    s_waitcnt vmcnt(1)
    ds_write_b128 v4, v[56:59]
    v_add_u32 v3, 5632, v0
    v_mul_hi_u32 v4, v3, v7
    v_mul_u32_u24 v4, 16, v4
    v_lshl_add_u32 v4, v3, 4, v4
    s_waitcnt vmcnt(0)
    ds_write_b128 v4, v[60:63]
    s_waitcnt lgkmcnt(0)
    s_barrier
    ds_read_b128 v[64:67], v11 offset:0
    ds_read_b128 v[68:71], v11 offset:49408
    ds_read_b128 v[72:75], v11 offset:64
    ds_read_b128 v[76:79], v11 offset:49472
    s_waitcnt vmcnt(35) lgkmcnt(2)
    v_mfma_f32_16x16x32_bf16 v[16:19], v[80:83], v[64:67], 0
    v_mfma_f32_16x16x32_bf16 v[20:23], v[80:83], v[68:71], 0
    v_mfma_f32_16x16x32_bf16 v[24:27], v[84:87], v[64:67], 0
    v_mfma_f32_16x16x32_bf16 v[28:31], v[84:87], v[68:71], 0
    v_mfma_f32_16x16x32_bf16 v[32:35], v[88:91], v[64:67], 0
    v_mfma_f32_16x16x32_bf16 v[36:39], v[88:91], v[68:71], 0
    v_mfma_f32_16x16x32_bf16 v[40:43], v[92:95], v[64:67], 0
    v_mfma_f32_16x16x32_bf16 v[44:47], v[92:95], v[68:71], 0
    v_mfma_f32_16x16x32_bf16 v[48:51], v[96:99], v[64:67], 0
    v_mfma_f32_16x16x32_bf16 v[52:55], v[96:99], v[68:71], 0
    buffer_load_dwordx4 v[80:83], v2, s[8:11], s45 offen offset:0
    buffer_load_dwordx4 v[84:87], v2, s[8:11], s45 offen offset:1024
    buffer_load_dwordx4 v[88:91], v2, s[8:11], s45 offen offset:2048
    buffer_load_dwordx4 v[92:95], v2, s[8:11], s45 offen offset:3072
    buffer_load_dwordx4 v[96:99], v2, s[8:11], s46 offen offset:0
    s_add_u32 s45, s45, 40960
    s_add_u32 s46, s46, 40960
    ds_read_b128 v[64:67], v11 offset:128
    ds_read_b128 v[68:71], v11 offset:49536
    s_waitcnt vmcnt(35) lgkmcnt(2)
    v_mfma_f32_16x16x32_bf16 v[16:19], v[100:103], v[72:75], v[16:19]
    v_mfma_f32_16x16x32_bf16 v[20:23], v[100:103], v[76:79], v[20:23]
    v_mfma_f32_16x16x32_bf16 v[24:27], v[104:107], v[72:75], v[24:27]
    v_mfma_f32_16x16x32_bf16 v[28:31], v[104:107], v[76:79], v[28:31]
    v_mfma_f32_16x16x32_bf16 v[32:35], v[108:111], v[72:75], v[32:35]
    v_mfma_f32_16x16x32_bf16 v[36:39], v[108:111], v[76:79], v[36:39]
    v_mfma_f32_16x16x32_bf16 v[40:43], v[112:115], v[72:75], v[40:43]
    v_mfma_f32_16x16x32_bf16 v[44:47], v[112:115], v[76:79], v[44:47]
    v_mfma_f32_16x16x32_bf16 v[48:51], v[116:119], v[72:75], v[48:51]
    v_mfma_f32_16x16x32_bf16 v[52:55], v[116:119], v[76:79], v[52:55]
    buffer_load_dwordx4 v[100:103], v2, s[8:11], s45 offen offset:0
    buffer_load_dwordx4 v[104:107], v2, s[8:11], s45 offen offset:1024
    buffer_load_dwordx4 v[108:111], v2, s[8:11], s45 offen offset:2048
    buffer_load_dwordx4 v[112:115], v2, s[8:11], s45 offen offset:3072
    buffer_load_dwordx4 v[116:119], v2, s[8:11], s46 offen offset:0
    s_add_u32 s45, s45, 40960
    s_add_u32 s46, s46, 40960
    ds_read_b128 v[72:75], v11 offset:192
    ds_read_b128 v[76:79], v11 offset:49600
    s_waitcnt vmcnt(35) lgkmcnt(2)
    v_mfma_f32_16x16x32_bf16 v[16:19], v[120:123], v[64:67], v[16:19]
    v_mfma_f32_16x16x32_bf16 v[20:23], v[120:123], v[68:71], v[20:23]
    v_mfma_f32_16x16x32_bf16 v[24:27], v[124:127], v[64:67], v[24:27]
    v_mfma_f32_16x16x32_bf16 v[28:31], v[124:127], v[68:71], v[28:31]
    v_mfma_f32_16x16x32_bf16 v[32:35], v[128:131], v[64:67], v[32:35]
    v_mfma_f32_16x16x32_bf16 v[36:39], v[128:131], v[68:71], v[36:39]
    v_mfma_f32_16x16x32_bf16 v[40:43], v[132:135], v[64:67], v[40:43]
    v_mfma_f32_16x16x32_bf16 v[44:47], v[132:135], v[68:71], v[44:47]
    v_mfma_f32_16x16x32_bf16 v[48:51], v[136:139], v[64:67], v[48:51]
    v_mfma_f32_16x16x32_bf16 v[52:55], v[136:139], v[68:71], v[52:55]
    buffer_load_dwordx4 v[120:123], v2, s[8:11], s45 offen offset:0
    buffer_load_dwordx4 v[124:127], v2, s[8:11], s45 offen offset:1024
    buffer_load_dwordx4 v[128:131], v2, s[8:11], s45 offen offset:2048
    buffer_load_dwordx4 v[132:135], v2, s[8:11], s45 offen offset:3072
    buffer_load_dwordx4 v[136:139], v2, s[8:11], s46 offen offset:0
    s_add_u32 s45, s45, 40960
    s_add_u32 s46, s46, 40960
    ds_read_b128 v[64:67], v11 offset:256
    ds_read_b128 v[68:71], v11 offset:49664
    s_waitcnt vmcnt(35) lgkmcnt(2)
    v_mfma_f32_16x16x32_bf16 v[16:19], v[140:143], v[72:75], v[16:19]
    v_mfma_f32_16x16x32_bf16 v[20:23], v[140:143], v[76:79], v[20:23]
    v_mfma_f32_16x16x32_bf16 v[24:27], v[144:147], v[72:75], v[24:27]
    v_mfma_f32_16x16x32_bf16 v[28:31], v[144:147], v[76:79], v[28:31]
    v_mfma_f32_16x16x32_bf16 v[32:35], v[148:151], v[72:75], v[32:35]
    v_mfma_f32_16x16x32_bf16 v[36:39], v[148:151], v[76:79], v[36:39]
    v_mfma_f32_16x16x32_bf16 v[40:43], v[152:155], v[72:75], v[40:43]
    v_mfma_f32_16x16x32_bf16 v[44:47], v[152:155], v[76:79], v[44:47]
    v_mfma_f32_16x16x32_bf16 v[48:51], v[156:159], v[72:75], v[48:51]
    v_mfma_f32_16x16x32_bf16 v[52:55], v[156:159], v[76:79], v[52:55]
    buffer_load_dwordx4 v[140:143], v2, s[8:11], s45 offen offset:0
    buffer_load_dwordx4 v[144:147], v2, s[8:11], s45 offen offset:1024
    buffer_load_dwordx4 v[148:151], v2, s[8:11], s45 offen offset:2048
    buffer_load_dwordx4 v[152:155], v2, s[8:11], s45 offen offset:3072
    buffer_load_dwordx4 v[156:159], v2, s[8:11], s46 offen offset:0
    s_add_u32 s45, s45, 40960
    s_add_u32 s46, s46, 40960
    ds_read_b128 v[72:75], v11 offset:320
    ds_read_b128 v[76:79], v11 offset:49728
    s_waitcnt vmcnt(35) lgkmcnt(2)
    v_mfma_f32_16x16x32_bf16 v[16:19], v[160:163], v[64:67], v[16:19]
    v_mfma_f32_16x16x32_bf16 v[20:23], v[160:163], v[68:71], v[20:23]
    v_mfma_f32_16x16x32_bf16 v[24:27], v[164:167], v[64:67], v[24:27]
    v_mfma_f32_16x16x32_bf16 v[28:31], v[164:167], v[68:71], v[28:31]
    v_mfma_f32_16x16x32_bf16 v[32:35], v[168:171], v[64:67], v[32:35]
    v_mfma_f32_16x16x32_bf16 v[36:39], v[168:171], v[68:71], v[36:39]
    v_mfma_f32_16x16x32_bf16 v[40:43], v[172:175], v[64:67], v[40:43]
    v_mfma_f32_16x16x32_bf16 v[44:47], v[172:175], v[68:71], v[44:47]
    v_mfma_f32_16x16x32_bf16 v[48:51], v[176:179], v[64:67], v[48:51]
    v_mfma_f32_16x16x32_bf16 v[52:55], v[176:179], v[68:71], v[52:55]
    ds_read_b128 v[64:67], v11 offset:384
    ds_read_b128 v[68:71], v11 offset:49792
    s_waitcnt vmcnt(30) lgkmcnt(2)
    v_mfma_f32_16x16x32_bf16 v[16:19], v[180:183], v[72:75], v[16:19]
    v_mfma_f32_16x16x32_bf16 v[20:23], v[180:183], v[76:79], v[20:23]
    v_mfma_f32_16x16x32_bf16 v[24:27], v[184:187], v[72:75], v[24:27]
    v_mfma_f32_16x16x32_bf16 v[28:31], v[184:187], v[76:79], v[28:31]
    v_mfma_f32_16x16x32_bf16 v[32:35], v[188:191], v[72:75], v[32:35]
    v_mfma_f32_16x16x32_bf16 v[36:39], v[188:191], v[76:79], v[36:39]
    v_mfma_f32_16x16x32_bf16 v[40:43], v[192:195], v[72:75], v[40:43]
    v_mfma_f32_16x16x32_bf16 v[44:47], v[192:195], v[76:79], v[44:47]
    v_mfma_f32_16x16x32_bf16 v[48:51], v[196:199], v[72:75], v[48:51]
    v_mfma_f32_16x16x32_bf16 v[52:55], v[196:199], v[76:79], v[52:55]
    ds_read_b128 v[72:75], v11 offset:448
    ds_read_b128 v[76:79], v11 offset:49856
    s_waitcnt vmcnt(25) lgkmcnt(2)
    v_mfma_f32_16x16x32_bf16 v[16:19], v[200:203], v[64:67], v[16:19]
    v_mfma_f32_16x16x32_bf16 v[20:23], v[200:203], v[68:71], v[20:23]
    v_mfma_f32_16x16x32_bf16 v[24:27], v[204:207], v[64:67], v[24:27]
    v_mfma_f32_16x16x32_bf16 v[28:31], v[204:207], v[68:71], v[28:31]
    v_mfma_f32_16x16x32_bf16 v[32:35], v[208:211], v[64:67], v[32:35]
    v_mfma_f32_16x16x32_bf16 v[36:39], v[208:211], v[68:71], v[36:39]
    v_mfma_f32_16x16x32_bf16 v[40:43], v[212:215], v[64:67], v[40:43]
    v_mfma_f32_16x16x32_bf16 v[44:47], v[212:215], v[68:71], v[44:47]
    v_mfma_f32_16x16x32_bf16 v[48:51], v[216:219], v[64:67], v[48:51]
    v_mfma_f32_16x16x32_bf16 v[52:55], v[216:219], v[68:71], v[52:55]
    ds_read_b128 v[64:67], v11 offset:512
    ds_read_b128 v[68:71], v11 offset:49920
    s_waitcnt vmcnt(20) lgkmcnt(2)
    v_mfma_f32_16x16x32_bf16 v[16:19], v[220:223], v[72:75], v[16:19]
    v_mfma_f32_16x16x32_bf16 v[20:23], v[220:223], v[76:79], v[20:23]
    v_mfma_f32_16x16x32_bf16 v[24:27], v[224:227], v[72:75], v[24:27]
    v_mfma_f32_16x16x32_bf16 v[28:31], v[224:227], v[76:79], v[28:31]
    v_mfma_f32_16x16x32_bf16 v[32:35], v[228:231], v[72:75], v[32:35]
    v_mfma_f32_16x16x32_bf16 v[36:39], v[228:231], v[76:79], v[36:39]
    v_mfma_f32_16x16x32_bf16 v[40:43], v[232:235], v[72:75], v[40:43]
    v_mfma_f32_16x16x32_bf16 v[44:47], v[232:235], v[76:79], v[44:47]
    v_mfma_f32_16x16x32_bf16 v[48:51], v[236:239], v[72:75], v[48:51]
    v_mfma_f32_16x16x32_bf16 v[52:55], v[236:239], v[76:79], v[52:55]
    ds_read_b128 v[72:75], v11 offset:576
    ds_read_b128 v[76:79], v11 offset:49984
    s_waitcnt vmcnt(15) lgkmcnt(2)
    v_mfma_f32_16x16x32_bf16 v[16:19], v[80:83], v[64:67], v[16:19]
    v_mfma_f32_16x16x32_bf16 v[20:23], v[80:83], v[68:71], v[20:23]
    v_mfma_f32_16x16x32_bf16 v[24:27], v[84:87], v[64:67], v[24:27]
    v_mfma_f32_16x16x32_bf16 v[28:31], v[84:87], v[68:71], v[28:31]
    v_mfma_f32_16x16x32_bf16 v[32:35], v[88:91], v[64:67], v[32:35]
    v_mfma_f32_16x16x32_bf16 v[36:39], v[88:91], v[68:71], v[36:39]
    v_mfma_f32_16x16x32_bf16 v[40:43], v[92:95], v[64:67], v[40:43]
    v_mfma_f32_16x16x32_bf16 v[44:47], v[92:95], v[68:71], v[44:47]
    v_mfma_f32_16x16x32_bf16 v[48:51], v[96:99], v[64:67], v[48:51]
    v_mfma_f32_16x16x32_bf16 v[52:55], v[96:99], v[68:71], v[52:55]
    ds_read_b128 v[64:67], v11 offset:640
    ds_read_b128 v[68:71], v11 offset:50048
    s_waitcnt vmcnt(10) lgkmcnt(2)
    v_mfma_f32_16x16x32_bf16 v[16:19], v[100:103], v[72:75], v[16:19]
    v_mfma_f32_16x16x32_bf16 v[20:23], v[100:103], v[76:79], v[20:23]
    v_mfma_f32_16x16x32_bf16 v[24:27], v[104:107], v[72:75], v[24:27]
    v_mfma_f32_16x16x32_bf16 v[28:31], v[104:107], v[76:79], v[28:31]
    v_mfma_f32_16x16x32_bf16 v[32:35], v[108:111], v[72:75], v[32:35]
    v_mfma_f32_16x16x32_bf16 v[36:39], v[108:111], v[76:79], v[36:39]
    v_mfma_f32_16x16x32_bf16 v[40:43], v[112:115], v[72:75], v[40:43]
    v_mfma_f32_16x16x32_bf16 v[44:47], v[112:115], v[76:79], v[44:47]
    v_mfma_f32_16x16x32_bf16 v[48:51], v[116:119], v[72:75], v[48:51]
    v_mfma_f32_16x16x32_bf16 v[52:55], v[116:119], v[76:79], v[52:55]
    ds_read_b128 v[72:75], v11 offset:704
    ds_read_b128 v[76:79], v11 offset:50112
    s_waitcnt vmcnt(5) lgkmcnt(2)
    v_mfma_f32_16x16x32_bf16 v[16:19], v[120:123], v[64:67], v[16:19]
    v_mfma_f32_16x16x32_bf16 v[20:23], v[120:123], v[68:71], v[20:23]
    v_mfma_f32_16x16x32_bf16 v[24:27], v[124:127], v[64:67], v[24:27]
    v_mfma_f32_16x16x32_bf16 v[28:31], v[124:127], v[68:71], v[28:31]
    v_mfma_f32_16x16x32_bf16 v[32:35], v[128:131], v[64:67], v[32:35]
    v_mfma_f32_16x16x32_bf16 v[36:39], v[128:131], v[68:71], v[36:39]
    v_mfma_f32_16x16x32_bf16 v[40:43], v[132:135], v[64:67], v[40:43]
    v_mfma_f32_16x16x32_bf16 v[44:47], v[132:135], v[68:71], v[44:47]
    v_mfma_f32_16x16x32_bf16 v[48:51], v[136:139], v[64:67], v[48:51]
    v_mfma_f32_16x16x32_bf16 v[52:55], v[136:139], v[68:71], v[52:55]
    s_waitcnt vmcnt(0) lgkmcnt(0)
    v_mfma_f32_16x16x32_bf16 v[16:19], v[140:143], v[72:75], v[16:19]
    v_mfma_f32_16x16x32_bf16 v[20:23], v[140:143], v[76:79], v[20:23]
    v_mfma_f32_16x16x32_bf16 v[24:27], v[144:147], v[72:75], v[24:27]
    v_mfma_f32_16x16x32_bf16 v[28:31], v[144:147], v[76:79], v[28:31]
    v_mfma_f32_16x16x32_bf16 v[32:35], v[148:151], v[72:75], v[32:35]
    v_mfma_f32_16x16x32_bf16 v[36:39], v[148:151], v[76:79], v[36:39]
    v_mfma_f32_16x16x32_bf16 v[40:43], v[152:155], v[72:75], v[40:43]
    v_mfma_f32_16x16x32_bf16 v[44:47], v[152:155], v[76:79], v[44:47]
    v_mfma_f32_16x16x32_bf16 v[48:51], v[156:159], v[72:75], v[48:51]
    v_mfma_f32_16x16x32_bf16 v[52:55], v[156:159], v[76:79], v[52:55]
    v_mul_u32_u24 v10, 1280, v8
    v_lshl_add_u32 v10, v9, 3, v10
    s_mul_i32 s44, s41, 40960
    s_mul_i32 s46, s42, 320
    s_add_u32 s44, s44, s46
    s_add_u32 s50, s40, 0
    s_min_u32 s50, s50, 19
    s_lshr_b32 s51, s50, 1
    s_lshl_b32 s51, s51, 5
    s_and_b32 s52, s50, 1
    s_mul_i32 s52, s52, 20480
    s_add_u32 s51, s51, s52
    s_add_u32 s56, s51, s44
    s_add_u32 s51, s56, 117440512
    buffer_load_dwordx2 v[72:73], v10, s[8:11], s51 offen sc1
    s_lshl_b32 s60, s50, 10
    s_add_u32 s50, s40, 8
    s_min_u32 s50, s50, 19
    s_lshr_b32 s51, s50, 1
    s_lshl_b32 s51, s51, 5
    s_and_b32 s52, s50, 1
    s_mul_i32 s52, s52, 20480
    s_add_u32 s51, s51, s52
    s_add_u32 s57, s51, s44
    s_add_u32 s51, s57, 117440512
    buffer_load_dwordx2 v[74:75], v10, s[8:11], s51 offen sc1
    s_lshl_b32 s61, s50, 10
    s_add_u32 s50, s40, 16
    s_min_u32 s50, s50, 19
    s_lshr_b32 s51, s50, 1
    s_lshl_b32 s51, s51, 5
    s_and_b32 s52, s50, 1
    s_mul_i32 s52, s52, 20480
    s_add_u32 s51, s51, s52
    s_add_u32 s58, s51, s44
    s_add_u32 s51, s58, 117440512
    buffer_load_dwordx2 v[76:77], v10, s[8:11], s51 offen sc1
    s_lshl_b32 s62, s50, 10
    s_barrier
    s_mul_i32 s49, s48, 20480
    s_mul_i32 s50, s47, 10240
    s_add_u32 s49, s49, s50
    v_add_u32 v3, s49, v2
    ds_write_b128 v3, v[16:19] offset:0
    ds_write_b128 v3, v[20:23] offset:1024
    ds_write_b128 v3, v[24:27] offset:2048
    ds_write_b128 v3, v[28:31] offset:3072
    ds_write_b128 v3, v[32:35] offset:4096
    ds_write_b128 v3, v[36:39] offset:5120
    ds_write_b128 v3, v[40:43] offset:6144
    ds_write_b128 v3, v[44:47] offset:7168
    ds_write_b128 v3, v[48:51] offset:8192
    ds_write_b128 v3, v[52:55] offset:9216
    s_waitcnt lgkmcnt(0)
    s_barrier
    v_add_u32 v3, s60, v2
    ds_read_b128 v[80:83], v3 offset:0
    ds_read_b128 v[84:87], v3 offset:20480
    ds_read_b128 v[88:91], v3 offset:40960
    ds_read_b128 v[92:95], v3 offset:61440
    v_add_u32 v3, s61, v2
    ds_read_b128 v[96:99], v3 offset:0
    ds_read_b128 v[100:103], v3 offset:20480
    ds_read_b128 v[104:107], v3 offset:40960
    ds_read_b128 v[108:111], v3 offset:61440
    v_add_u32 v3, s62, v2
    ds_read_b128 v[112:115], v3 offset:0
    ds_read_b128 v[116:119], v3 offset:20480
    ds_read_b128 v[120:123], v3 offset:40960
    ds_read_b128 v[124:127], v3 offset:61440
    s_waitcnt vmcnt(2) lgkmcnt(8)
    v_pk_add_f32 v[80:81], v[80:81], v[84:85]
    v_pk_add_f32 v[88:89], v[88:89], v[92:93]
    v_pk_add_f32 v[80:81], v[80:81], v[88:89]
    v_pk_add_f32 v[82:83], v[82:83], v[86:87]
    v_pk_add_f32 v[90:91], v[90:91], v[94:95]
    v_pk_add_f32 v[82:83], v[82:83], v[90:91]
    v_cvt_pk_bf16_f32 v3, v80, v81
    s_nop 0
    v_lshlrev_b32 v5, 16, v3
    v_and_b32 v3, 0xffff0000, v3
    v_lshlrev_b32 v6, 16, v72
    v_and_b32 v4, 0xffff0000, v72
    v_add_f32 v5, v5, v6
    v_add_f32 v3, v3, v4
    v_cvt_pk_bf16_f32 v84, v5, v3
    v_cvt_pk_bf16_f32 v3, v82, v83
    s_nop 0
    v_lshlrev_b32 v5, 16, v3
    v_and_b32 v3, 0xffff0000, v3
    v_lshlrev_b32 v6, 16, v73
    v_and_b32 v4, 0xffff0000, v73
    v_add_f32 v5, v5, v6
    v_add_f32 v3, v3, v4
    v_cvt_pk_bf16_f32 v85, v5, v3
    s_nop 0
    buffer_store_dwordx2 v[84:85], v10, s[12:15], s56 offen
    s_waitcnt vmcnt(1) lgkmcnt(4)
    v_pk_add_f32 v[96:97], v[96:97], v[100:101]
    v_pk_add_f32 v[104:105], v[104:105], v[108:109]
    v_pk_add_f32 v[96:97], v[96:97], v[104:105]
    v_pk_add_f32 v[98:99], v[98:99], v[102:103]
    v_pk_add_f32 v[106:107], v[106:107], v[110:111]
    v_pk_add_f32 v[98:99], v[98:99], v[106:107]
    v_cvt_pk_bf16_f32 v3, v96, v97
    s_nop 0
    v_lshlrev_b32 v5, 16, v3
    v_and_b32 v3, 0xffff0000, v3
    v_lshlrev_b32 v6, 16, v74
    v_and_b32 v4, 0xffff0000, v74
    v_add_f32 v5, v5, v6
    v_add_f32 v3, v3, v4
    v_cvt_pk_bf16_f32 v100, v5, v3
    v_cvt_pk_bf16_f32 v3, v98, v99
    s_nop 0
    v_lshlrev_b32 v5, 16, v3
    v_and_b32 v3, 0xffff0000, v3
    v_lshlrev_b32 v6, 16, v75
    v_and_b32 v4, 0xffff0000, v75
    v_add_f32 v5, v5, v6
    v_add_f32 v3, v3, v4
    v_cvt_pk_bf16_f32 v101, v5, v3
    s_nop 0
    buffer_store_dwordx2 v[100:101], v10, s[12:15], s57 offen
    s_cmp_ge_u32 s40, 4
    s_cbranch_scc1 L_done_77
    s_waitcnt vmcnt(0) lgkmcnt(0)
    v_pk_add_f32 v[112:113], v[112:113], v[116:117]
    v_pk_add_f32 v[120:121], v[120:121], v[124:125]
    v_pk_add_f32 v[112:113], v[112:113], v[120:121]
    v_pk_add_f32 v[114:115], v[114:115], v[118:119]
    v_pk_add_f32 v[122:123], v[122:123], v[126:127]
    v_pk_add_f32 v[114:115], v[114:115], v[122:123]
    v_cvt_pk_bf16_f32 v3, v112, v113
    s_nop 0
    v_lshlrev_b32 v5, 16, v3
    v_and_b32 v3, 0xffff0000, v3
    v_lshlrev_b32 v6, 16, v76
    v_and_b32 v4, 0xffff0000, v76
    v_add_f32 v5, v5, v6
    v_add_f32 v3, v3, v4
    v_cvt_pk_bf16_f32 v116, v5, v3
    v_cvt_pk_bf16_f32 v3, v114, v115
    s_nop 0
    v_lshlrev_b32 v5, 16, v3
    v_and_b32 v3, 0xffff0000, v3
    v_lshlrev_b32 v6, 16, v77
    v_and_b32 v4, 0xffff0000, v77
    v_add_f32 v5, v5, v6
    v_add_f32 v3, v3, v4
    v_cvt_pk_bf16_f32 v117, v5, v3
    s_nop 0
    buffer_store_dwordx2 v[116:117], v10, s[12:15], s58 offen
L_done_77:
    s_endpgm
.section .rodata,"a"
.p2align 6
.amdhsa_kernel xo_kernel
  .amdhsa_next_free_vgpr 256
  .amdhsa_next_free_sgpr 96
  .amdhsa_accum_offset 256
  .amdhsa_group_segment_fixed_size 0
  .amdhsa_kernarg_size 112
  .amdhsa_user_sgpr_count 2
  .amdhsa_user_sgpr_kernarg_segment_ptr 1
  .amdhsa_system_sgpr_workgroup_id_x 1
.end_amdhsa_kernel
```
